```python
import torch

def _softmax(x, axis=-1):
    return torch.softmax(x, dim=axis)
def _gelu(x):
    return torch.nn.functional.gelu(x, approximate="tanh")
def _silu(x):
    return torch.nn.functional.silu(x)
def _sigmoid(x):
    return torch.sigmoid(x)
def _layernorm(x, axis=-1, eps=1e-5):
    m = x.mean(dim=axis, keepdim=True)
    v = x.var(dim=axis, keepdim=True, unbiased=False)
    return (x - m) / torch.sqrt(v + eps)
def _scatter_add(tgt, idx, src, axis=0):
    return tgt.clone().index_add_(axis, idx, src)
def _segment_sum(src, seg, n):
    out = torch.zeros((n,) + src.shape[1:], dtype=src.dtype)
    return out.index_add_(0, seg, src)
def _pad(x, pw):
    flat = tuple(v for pair in reversed(pw) for v in pair)
    return torch.nn.functional.pad(x, flat)

kernel_name = 'standalone__mha_block_cached__near_ridge'

def setup_inputs():

    _w = (lambda a: (lambda t: t.to(torch.bfloat16) if t.is_floating_point() else t)(torch.as_tensor(a)))
    B, Sq, D = 8, 256, 640
    H, Sk, Dh = 32, 1024, 192
    return {
        "x": _w((lambda *s: torch.randn(*s, dtype=torch.bfloat16) * 0.8)(B, Sq, D)),
        "k_cache": _w((lambda *s: torch.randn(*s, dtype=torch.bfloat16) * 0.8)(B, H, Sk, Dh)),
        "v_cache": _w((lambda *s: torch.randn(*s, dtype=torch.bfloat16) * 0.05)(B, H, Sk, Dh)),
        "wq": _w((lambda *s: torch.randn(*s, dtype=torch.bfloat16) * 0.8)(D, H * Dh) * (D ** -0.5)),
        "wo": _w((lambda *s: torch.randn(*s, dtype=torch.bfloat16) * 0.05)(H * Dh, D) * ((H * Dh) ** -0.5)),
    }

def reference(x, k_cache, v_cache, wq, wo):
    B, Sq, D = x.shape
    H, Dh = 32, 192
    q = (lambda x, *d: x.permute(*d))((x @ wq).reshape(B, Sq, H, Dh), 0, 2, 1, 3)
    scores = torch.einsum("bhqd,bhkd->bhqk", q, k_cache) * (Dh ** -0.5)
    p = _softmax(scores, axis=-1)
    o = torch.einsum("bhqk,bhkd->bhqd", p, v_cache)
    return (lambda x, *d: x.permute(*d))(o, 0, 2, 1, 3).reshape(B, Sq, H * Dh) @ wo
```

```asm
; @launch kernel=attn_kernel grid=(256,1,1) block=(256,1,1) lds=163840
; @launch kernel=oproj_kernel grid=(256,1,1) block=(256,1,1) lds=81920
.amdgcn_target "amdgcn-amd-amdhsa--gfx950"
.text
.globl attn_kernel
.p2align 8
.type attn_kernel,@function
attn_kernel:
  s_cmp_ge_u32 s2, 256
  s_cbranch_scc1 A_END
  s_load_dwordx8 s[48:55], s[0:1], 0
  s_load_dwordx2 s[56:57], s[0:1], 56
  s_load_dwordx2 s[96:97], s[0:1], 32
  v_lshrrev_b32 v1, 6, v0
  v_and_b32 v0, 63, v0
  s_nop 0
  v_readfirstlane_b32 s28, v1
  s_lshr_b32 s29, s2, 5
  s_and_b32 s30, s2, 31
  s_mul_i32 s43, s28, 3072
  s_mov_b32 s44, 0xaaab
  s_mul_i32 s39, s28, 192
  s_add_u32 s39, s39, 0
  v_add_u32 v228, s39, v0
  v_mul_lo_u32 v229, v228, s44
  v_lshrrev_b32 v229, 20, v229
  v_mul_u32_u24 v230, 24, v229
  v_sub_u32 v230, v228, v230
  v_bfe_u32 v231, v229, 1, 3
  v_xor_b32 v231, v230, v231
  v_lshlrev_b32 v231, 4, v231
  v_mul_u32_u24 v1, 384, v229
  v_add_u32 v1, v1, v231
  v_bfe_u32 v231, v229, 1, 1
  v_lshlrev_b32 v231, 2, v231
  v_xor_b32 v231, v230, v231
  v_lshlrev_b32 v231, 4, v231
  v_mul_u32_u24 v4, 384, v229
  v_add_u32 v4, v4, v231
  v_mul_u32_u24 v7, 12288, v229
  v_add_u32 v7, v7, v231
  s_mul_i32 s39, s28, 192
  s_add_u32 s39, s39, 64
  v_add_u32 v228, s39, v0
  v_mul_lo_u32 v229, v228, s44
  v_lshrrev_b32 v229, 20, v229
  v_mul_u32_u24 v230, 24, v229
  v_sub_u32 v230, v228, v230
  v_bfe_u32 v231, v229, 1, 3
  v_xor_b32 v231, v230, v231
  v_lshlrev_b32 v231, 4, v231
  v_mul_u32_u24 v2, 384, v229
  v_add_u32 v2, v2, v231
  v_bfe_u32 v231, v229, 1, 1
  v_lshlrev_b32 v231, 2, v231
  v_xor_b32 v231, v230, v231
  v_lshlrev_b32 v231, 4, v231
  v_mul_u32_u24 v5, 384, v229
  v_add_u32 v5, v5, v231
  v_mul_u32_u24 v8, 12288, v229
  v_add_u32 v8, v8, v231
  v_subrev_u32 v2, 1024, v2
  v_subrev_u32 v5, 1024, v5
  v_subrev_u32 v8, 1024, v8
  s_mul_i32 s39, s28, 192
  s_add_u32 s39, s39, 128
  v_add_u32 v228, s39, v0
  v_mul_lo_u32 v229, v228, s44
  v_lshrrev_b32 v229, 20, v229
  v_mul_u32_u24 v230, 24, v229
  v_sub_u32 v230, v228, v230
  v_bfe_u32 v231, v229, 1, 3
  v_xor_b32 v231, v230, v231
  v_lshlrev_b32 v231, 4, v231
  v_mul_u32_u24 v3, 384, v229
  v_add_u32 v3, v3, v231
  v_bfe_u32 v231, v229, 1, 1
  v_lshlrev_b32 v231, 2, v231
  v_xor_b32 v231, v230, v231
  v_lshlrev_b32 v231, 4, v231
  v_mul_u32_u24 v6, 384, v229
  v_add_u32 v6, v6, v231
  v_mul_u32_u24 v9, 12288, v229
  v_add_u32 v9, v9, v231
  v_subrev_u32 v3, 2048, v3
  v_subrev_u32 v6, 2048, v6
  v_subrev_u32 v9, 2048, v9
  v_and_b32 v228, 31, v0
  v_and_b32 v229, 19, v228
  v_bfe_u32 v230, v228, 2, 1
  v_lshlrev_b32 v230, 3, v230
  v_or_b32 v229, v229, v230
  v_bfe_u32 v230, v228, 3, 1
  v_lshlrev_b32 v230, 2, v230
  v_or_b32 v229, v229, v230
  v_bfe_u32 v230, v229, 1, 3
  v_lshrrev_b32 v231, 5, v0
  v_xor_b32 v230, v230, v231
  v_mul_u32_u24 v229, 384, v229
  v_xor_b32 v228, 0, v230
  v_lshlrev_b32 v228, 4, v228
  v_add_u32 v10, v229, v228
  v_xor_b32 v228, 2, v230
  v_lshlrev_b32 v228, 4, v228
  v_add_u32 v11, v229, v228
  v_xor_b32 v228, 4, v230
  v_lshlrev_b32 v228, 4, v228
  v_add_u32 v12, v229, v228
  v_xor_b32 v228, 6, v230
  v_lshlrev_b32 v228, 4, v228
  v_add_u32 v13, v229, v228
  v_bfe_u32 v228, v0, 2, 2
  v_lshl_add_u32 v229, v231, 3, v228
  v_mul_u32_u24 v229, 384, v229
  v_bfe_u32 v230, v0, 4, 1
  v_lshl_add_u32 v229, v230, 5, v229
  v_and_b32 v230, 1, v0
  v_lshl_add_u32 v229, v230, 4, v229
  v_bfe_u32 v230, v0, 1, 1
  v_lshl_add_u32 v229, v230, 3, v229
  v_bfe_u32 v230, v0, 3, 1
  v_lshl_add_u32 v14, v230, 6, v229
  v_xor_b32 v230, 1, v230
  v_lshl_add_u32 v15, v230, 6, v229
  v_lshrrev_b32 v228, 3, v0
  s_lshl_b32 s39, s28, 6
  v_add_u32 v228, s39, v228
  v_mul_u32_u24 v228, 1280, v228
  v_lshrrev_b32 v229, 4, v0
  v_and_b32 v230, 7, v0
  v_xor_b32 v230, v230, v229
  v_lshl_add_u32 v28, v230, 4, v228
  v_xor_b32 v230, 4, v230
  v_lshl_add_u32 v29, v230, 4, v228
  v_add_u32 v29, 9216, v29
  s_lshl_b32 s39, s28, 13
  s_add_u32 s58, s39, 24576
  s_mov_b32 s44, 57344
  s_cmp_lt_u32 s28, 2
  s_cselect_b32 s44, s44, 131072
  s_add_u32 s59, s39, s44
  v_and_b32 v228, 31, v0
  v_bfe_u32 v229, v228, 1, 3
  v_xor_b32 v229, v229, v231
  v_lshlrev_b32 v228, 7, v228
  v_xor_b32 v230, 0, v229
  v_lshl_add_u32 v230, v230, 4, v228
  v_add_u32 v56, s58, v230
  v_add_u32 v60, s59, v230
  v_xor_b32 v230, 2, v229
  v_lshl_add_u32 v230, v230, 4, v228
  v_add_u32 v57, s58, v230
  v_add_u32 v61, s59, v230
  v_xor_b32 v230, 4, v229
  v_lshl_add_u32 v230, v230, 4, v228
  v_add_u32 v58, s58, v230
  v_add_u32 v62, s59, v230
  v_xor_b32 v230, 6, v229
  v_lshl_add_u32 v230, v230, 4, v228
  v_add_u32 v59, s58, v230
  v_add_u32 v63, s59, v230
  s_mov_b32 s31, 0
  s_mov_b32 s32, 0
  s_add_u32 s33, s43, 0
  s_add_u32 s34, s43, 73728
  s_add_u32 s45, s33, 73728
  s_add_u32 s46, s34, 73728
  s_waitcnt lgkmcnt(0)
  s_mul_i32 s39, s29, 327680
  s_add_u32 s48, s48, s39
  s_addc_u32 s49, s49, 0
  s_mul_i32 s39, s2, 393216
  s_add_u32 s50, s50, s39
  s_addc_u32 s51, s51, 0
  s_add_u32 s52, s52, s39
  s_addc_u32 s53, s53, 0
  s_mul_i32 s39, s30, 384
  s_add_u32 s54, s54, s39
  s_addc_u32 s55, s55, 0
  s_mov_b32 s8, s48
  s_and_b32 s9, s49, 0xffff
  s_mov_b32 s10, 327680
  s_mov_b32 s11, 0x20000
  s_mov_b32 s20, s54
  s_and_b32 s21, s55, 0xffff
  s_mov_b32 s22, 0
  s_mov_b32 s23, 0x20000
  s_sub_u32 s22, 7864320, s39
  s_mov_b32 m0, s34
  s_nop 0
  buffer_load_dwordx4 v7, s[20:23], s32 offen lds
  buffer_load_dwordx4 v8, s[20:23], s32 offen offset:1024 lds
  buffer_load_dwordx4 v9, s[20:23], s32 offen offset:2048 lds
  s_add_u32 s32, s32, 393216
  s_add_u32 s34, s34, 12288
  s_cmp_ge_u32 s34, s46
  s_cselect_b32 s39, 73728, 0
  s_sub_u32 s34, s34, s39
  s_add_u32 m0, s58, 0
  s_mov_b32 s42, 0
  buffer_load_dwordx4 v28, s[8:11], s42 offen lds
  buffer_load_dwordx4 v29, s[8:11], s42 offen offset:1024 lds
  s_add_u32 m0, s58, 2048
  s_mov_b32 s42, 20480
  buffer_load_dwordx4 v28, s[8:11], s42 offen lds
  buffer_load_dwordx4 v29, s[8:11], s42 offen offset:1024 lds
  s_add_u32 m0, s58, 4096
  s_mov_b32 s42, 40960
  buffer_load_dwordx4 v28, s[8:11], s42 offen lds
  buffer_load_dwordx4 v29, s[8:11], s42 offen offset:1024 lds
  s_add_u32 m0, s58, 6144
  s_mov_b32 s42, 61440
  buffer_load_dwordx4 v28, s[8:11], s42 offen lds
  buffer_load_dwordx4 v29, s[8:11], s42 offen offset:1024 lds
  s_mov_b32 m0, s34
  s_nop 0
  buffer_load_dwordx4 v7, s[20:23], s32 offen lds
  buffer_load_dwordx4 v8, s[20:23], s32 offen offset:1024 lds
  buffer_load_dwordx4 v9, s[20:23], s32 offen offset:2048 lds
  s_add_u32 s32, s32, 393216
  s_add_u32 s34, s34, 12288
  s_cmp_ge_u32 s34, s46
  s_cselect_b32 s39, 73728, 0
  s_sub_u32 s34, s34, s39
  s_mov_b32 s12, s50
  s_and_b32 s13, s51, 0xffff
  s_mov_b32 s14, 393216
  s_mov_b32 s15, 0x20000
  s_mov_b32 s16, s52
  s_and_b32 s17, s53, 0xffff
  s_mov_b32 s18, 393216
  s_mov_b32 s19, 0x20000
  s_mov_b32 s24, s56
  s_and_b32 s25, s57, 0xffff
  s_mov_b32 s26, 402653184
  s_mov_b32 s27, 0x20000
  s_mov_b32 s92, s96
  s_and_b32 s93, s97, 0xffff
  s_mov_b32 s94, 7864320
  s_mov_b32 s95, 0x20000
  s_cmp_ge_u32 s2, 240
  s_cselect_b32 s94, 0, s94
  s_lshl_b32 s39, s2, 2
  s_add_u32 s39, s39, s28
  s_mul_hi_u32 s44, s39, 0x33333334
  s_mul_i32 s98, s44, 5
  s_sub_u32 s39, s39, s98
  s_mul_i32 s98, s44, 40960
  s_lshl_b32 s99, s39, 8
  s_add_u32 s98, s98, s99
  s_mul_i32 s99, s39, 1572864
  s_lshl_b32 s44, s44, 10
  s_add_u32 s99, s99, s44
  s_add_u32 s99, s99, 25165824
  s_lshl_b32 s100, s28, 13
  s_mov_b32 s40, 0x3dd53b95
  s_mov_b32 s41, 0x3dd53b95
  s_mov_b32 s38, 0x47800000
  v_accvgpr_write_b32 a0, 0
  v_accvgpr_write_b32 a1, 0
  v_accvgpr_write_b32 a2, 0
  v_accvgpr_write_b32 a3, 0
  v_accvgpr_write_b32 a4, 0
  v_accvgpr_write_b32 a5, 0
  v_accvgpr_write_b32 a6, 0
  v_accvgpr_write_b32 a7, 0
  v_accvgpr_write_b32 a8, 0
  v_accvgpr_write_b32 a9, 0
  v_accvgpr_write_b32 a10, 0
  v_accvgpr_write_b32 a11, 0
  v_accvgpr_write_b32 a12, 0
  v_accvgpr_write_b32 a13, 0
  v_accvgpr_write_b32 a14, 0
  v_accvgpr_write_b32 a15, 0
  v_accvgpr_write_b32 a16, 0
  v_accvgpr_write_b32 a17, 0
  v_accvgpr_write_b32 a18, 0
  v_accvgpr_write_b32 a19, 0
  v_accvgpr_write_b32 a20, 0
  v_accvgpr_write_b32 a21, 0
  v_accvgpr_write_b32 a22, 0
  v_accvgpr_write_b32 a23, 0
  v_accvgpr_write_b32 a24, 0
  v_accvgpr_write_b32 a25, 0
  v_accvgpr_write_b32 a26, 0
  v_accvgpr_write_b32 a27, 0
  v_accvgpr_write_b32 a28, 0
  v_accvgpr_write_b32 a29, 0
  v_accvgpr_write_b32 a30, 0
  v_accvgpr_write_b32 a31, 0
  v_accvgpr_write_b32 a32, 0
  v_accvgpr_write_b32 a33, 0
  v_accvgpr_write_b32 a34, 0
  v_accvgpr_write_b32 a35, 0
  v_accvgpr_write_b32 a36, 0
  v_accvgpr_write_b32 a37, 0
  v_accvgpr_write_b32 a38, 0
  v_accvgpr_write_b32 a39, 0
  v_accvgpr_write_b32 a40, 0
  v_accvgpr_write_b32 a41, 0
  v_accvgpr_write_b32 a42, 0
  v_accvgpr_write_b32 a43, 0
  v_accvgpr_write_b32 a44, 0
  v_accvgpr_write_b32 a45, 0
  v_accvgpr_write_b32 a46, 0
  v_accvgpr_write_b32 a47, 0
  v_accvgpr_write_b32 a48, 0
  v_accvgpr_write_b32 a49, 0
  v_accvgpr_write_b32 a50, 0
  v_accvgpr_write_b32 a51, 0
  v_accvgpr_write_b32 a52, 0
  v_accvgpr_write_b32 a53, 0
  v_accvgpr_write_b32 a54, 0
  v_accvgpr_write_b32 a55, 0
  v_accvgpr_write_b32 a56, 0
  v_accvgpr_write_b32 a57, 0
  v_accvgpr_write_b32 a58, 0
  v_accvgpr_write_b32 a59, 0
  v_accvgpr_write_b32 a60, 0
  v_accvgpr_write_b32 a61, 0
  v_accvgpr_write_b32 a62, 0
  v_accvgpr_write_b32 a63, 0
  v_accvgpr_write_b32 a64, 0
  v_accvgpr_write_b32 a65, 0
  v_accvgpr_write_b32 a66, 0
  v_accvgpr_write_b32 a67, 0
  v_accvgpr_write_b32 a68, 0
  v_accvgpr_write_b32 a69, 0
  v_accvgpr_write_b32 a70, 0
  v_accvgpr_write_b32 a71, 0
  v_accvgpr_write_b32 a72, 0
  v_accvgpr_write_b32 a73, 0
  v_accvgpr_write_b32 a74, 0
  v_accvgpr_write_b32 a75, 0
  v_accvgpr_write_b32 a76, 0
  v_accvgpr_write_b32 a77, 0
  v_accvgpr_write_b32 a78, 0
  v_accvgpr_write_b32 a79, 0
  v_accvgpr_write_b32 a80, 0
  v_accvgpr_write_b32 a81, 0
  v_accvgpr_write_b32 a82, 0
  v_accvgpr_write_b32 a83, 0
  v_accvgpr_write_b32 a84, 0
  v_accvgpr_write_b32 a85, 0
  v_accvgpr_write_b32 a86, 0
  v_accvgpr_write_b32 a87, 0
  v_accvgpr_write_b32 a88, 0
  v_accvgpr_write_b32 a89, 0
  v_accvgpr_write_b32 a90, 0
  v_accvgpr_write_b32 a91, 0
  v_accvgpr_write_b32 a92, 0
  v_accvgpr_write_b32 a93, 0
  v_accvgpr_write_b32 a94, 0
  v_accvgpr_write_b32 a95, 0
  v_accvgpr_write_b32 a96, 0
  v_accvgpr_write_b32 a97, 0
  v_accvgpr_write_b32 a98, 0
  v_accvgpr_write_b32 a99, 0
  v_accvgpr_write_b32 a100, 0
  v_accvgpr_write_b32 a101, 0
  v_accvgpr_write_b32 a102, 0
  v_accvgpr_write_b32 a103, 0
  v_accvgpr_write_b32 a104, 0
  v_accvgpr_write_b32 a105, 0
  v_accvgpr_write_b32 a106, 0
  v_accvgpr_write_b32 a107, 0
  v_accvgpr_write_b32 a108, 0
  v_accvgpr_write_b32 a109, 0
  v_accvgpr_write_b32 a110, 0
  v_accvgpr_write_b32 a111, 0
  v_accvgpr_write_b32 a112, 0
  v_accvgpr_write_b32 a113, 0
  v_accvgpr_write_b32 a114, 0
  v_accvgpr_write_b32 a115, 0
  v_accvgpr_write_b32 a116, 0
  v_accvgpr_write_b32 a117, 0
  v_accvgpr_write_b32 a118, 0
  v_accvgpr_write_b32 a119, 0
  v_accvgpr_write_b32 a120, 0
  v_accvgpr_write_b32 a121, 0
  v_accvgpr_write_b32 a122, 0
  v_accvgpr_write_b32 a123, 0
  v_accvgpr_write_b32 a124, 0
  v_accvgpr_write_b32 a125, 0
  v_accvgpr_write_b32 a126, 0
  v_accvgpr_write_b32 a127, 0
  v_accvgpr_write_b32 a128, 0
  v_accvgpr_write_b32 a129, 0
  v_accvgpr_write_b32 a130, 0
  v_accvgpr_write_b32 a131, 0
  v_accvgpr_write_b32 a132, 0
  v_accvgpr_write_b32 a133, 0
  v_accvgpr_write_b32 a134, 0
  v_accvgpr_write_b32 a135, 0
  v_accvgpr_write_b32 a136, 0
  v_accvgpr_write_b32 a137, 0
  v_accvgpr_write_b32 a138, 0
  v_accvgpr_write_b32 a139, 0
  v_accvgpr_write_b32 a140, 0
  v_accvgpr_write_b32 a141, 0
  v_accvgpr_write_b32 a142, 0
  v_accvgpr_write_b32 a143, 0
  v_accvgpr_write_b32 a144, 0
  v_accvgpr_write_b32 a145, 0
  v_accvgpr_write_b32 a146, 0
  v_accvgpr_write_b32 a147, 0
  v_accvgpr_write_b32 a148, 0
  v_accvgpr_write_b32 a149, 0
  v_accvgpr_write_b32 a150, 0
  v_accvgpr_write_b32 a151, 0
  v_accvgpr_write_b32 a152, 0
  v_accvgpr_write_b32 a153, 0
  v_accvgpr_write_b32 a154, 0
  v_accvgpr_write_b32 a155, 0
  v_accvgpr_write_b32 a156, 0
  v_accvgpr_write_b32 a157, 0
  v_accvgpr_write_b32 a158, 0
  v_accvgpr_write_b32 a159, 0
  v_accvgpr_write_b32 a160, 0
  v_accvgpr_write_b32 a161, 0
  v_accvgpr_write_b32 a162, 0
  v_accvgpr_write_b32 a163, 0
  v_accvgpr_write_b32 a164, 0
  v_accvgpr_write_b32 a165, 0
  v_accvgpr_write_b32 a166, 0
  v_accvgpr_write_b32 a167, 0
  v_accvgpr_write_b32 a168, 0
  v_accvgpr_write_b32 a169, 0
  v_accvgpr_write_b32 a170, 0
  v_accvgpr_write_b32 a171, 0
  v_accvgpr_write_b32 a172, 0
  v_accvgpr_write_b32 a173, 0
  v_accvgpr_write_b32 a174, 0
  v_accvgpr_write_b32 a175, 0
  v_accvgpr_write_b32 a176, 0
  v_accvgpr_write_b32 a177, 0
  v_accvgpr_write_b32 a178, 0
  v_accvgpr_write_b32 a179, 0
  v_accvgpr_write_b32 a180, 0
  v_accvgpr_write_b32 a181, 0
  v_accvgpr_write_b32 a182, 0
  v_accvgpr_write_b32 a183, 0
  v_accvgpr_write_b32 a184, 0
  v_accvgpr_write_b32 a185, 0
  v_accvgpr_write_b32 a186, 0
  v_accvgpr_write_b32 a187, 0
  v_accvgpr_write_b32 a188, 0
  v_accvgpr_write_b32 a189, 0
  v_accvgpr_write_b32 a190, 0
  v_accvgpr_write_b32 a191, 0
  s_mov_b32 s36, 135168
  s_add_u32 s36, s36, 12288
  s_cmp_ge_u32 s36, 147456
  s_cselect_b32 s36, 73728, s36
  v_add_u32 v20, s36, v14
  v_add_u32 v21, s36, v15
  s_waitcnt vmcnt(3)
  s_barrier
  ds_read_b128 a[192:195], v56 offset:0
  ds_read_b128 a[196:199], v56 offset:4096
  ds_read_b128 a[200:203], v57 offset:0
  ds_read_b128 a[204:207], v57 offset:4096
  ds_read_b128 a[208:211], v58 offset:0
  ds_read_b128 a[212:215], v58 offset:4096
  ds_read_b128 a[216:219], v59 offset:0
  ds_read_b128 a[220:223], v59 offset:4096
  ds_read_b64_tr_b16 v[32:33], v20 offset:0
  ds_read_b64_tr_b16 v[34:35], v20 offset:1536
  ds_read_b64_tr_b16 v[36:37], v21 offset:0
  ds_read_b64_tr_b16 v[38:39], v21 offset:1536
  ds_read_b64_tr_b16 v[40:41], v20 offset:128
  ds_read_b64_tr_b16 v[42:43], v20 offset:1664
  s_waitcnt lgkmcnt(6)
  s_waitcnt lgkmcnt(4)
  v_mfma_f32_32x32x16_bf16 v[64:79], v[32:35], a[192:195], 0
  ds_read_b64_tr_b16 v[44:45], v21 offset:128
  ds_read_b64_tr_b16 v[46:47], v21 offset:1664
  v_mfma_f32_32x32x16_bf16 v[80:95], v[32:35], a[196:199], 0
  s_waitcnt lgkmcnt(4)
  v_mfma_f32_32x32x16_bf16 v[96:111], v[36:39], a[192:195], 0
  ds_read_b64_tr_b16 v[48:49], v20 offset:256
  ds_read_b64_tr_b16 v[50:51], v20 offset:1792
  v_mfma_f32_32x32x16_bf16 v[112:127], v[36:39], a[196:199], 0
  s_waitcnt vmcnt(0)
  s_barrier
  s_waitcnt lgkmcnt(4)
  v_mfma_f32_32x32x16_bf16 v[128:143], v[40:43], a[192:195], 0
  ds_read_b64_tr_b16 v[52:53], v21 offset:256
  ds_read_b64_tr_b16 v[54:55], v21 offset:1792
  s_add_u32 m0, s59, 0
  s_mov_b32 s42, 128
  buffer_load_dwordx4 v28, s[8:11], s42 offen lds
  v_mfma_f32_32x32x16_bf16 v[144:159], v[40:43], a[196:199], 0
  s_add_u32 m0, s59, 0
  s_mov_b32 s42, 128
  buffer_load_dwordx4 v29, s[8:11], s42 offen offset:1024 lds
  s_waitcnt lgkmcnt(4)
  v_mfma_f32_32x32x16_bf16 v[160:175], v[44:47], a[192:195], 0
  ds_read_b64_tr_b16 v[32:33], v20 offset:6144
  ds_read_b64_tr_b16 v[34:35], v20 offset:7680
  s_add_u32 m0, s59, 2048
  s_mov_b32 s42, 20608
  buffer_load_dwordx4 v28, s[8:11], s42 offen lds
  v_mfma_f32_32x32x16_bf16 v[176:191], v[44:47], a[196:199], 0
  s_waitcnt lgkmcnt(4)
  v_mfma_f32_32x32x16_bf16 v[192:207], v[48:51], a[192:195], 0
  ds_read_b64_tr_b16 v[36:37], v21 offset:6144
  ds_read_b64_tr_b16 v[38:39], v21 offset:7680
  s_add_u32 m0, s59, 2048
  s_mov_b32 s42, 20608
  buffer_load_dwordx4 v29, s[8:11], s42 offen offset:1024 lds
  v_mfma_f32_32x32x16_bf16 v[208:223], v[48:51], a[196:199], 0
  s_add_u32 m0, s59, 4096
  s_mov_b32 s42, 41088
  buffer_load_dwordx4 v28, s[8:11], s42 offen lds
  s_waitcnt lgkmcnt(4)
  v_mfma_f32_32x32x16_bf16 v[224:239], v[52:55], a[192:195], 0
  ds_read_b64_tr_b16 v[40:41], v20 offset:6272
  ds_read_b64_tr_b16 v[42:43], v20 offset:7808
  v_mfma_f32_32x32x16_bf16 v[240:255], v[52:55], a[196:199], 0
  s_add_u32 m0, s59, 4096
  s_mov_b32 s42, 41088
  buffer_load_dwordx4 v29, s[8:11], s42 offen offset:1024 lds
  s_waitcnt lgkmcnt(4)
  v_mfma_f32_32x32x16_bf16 v[64:79], v[32:35], a[200:203], v[64:79]
  ds_read_b64_tr_b16 v[44:45], v21 offset:6272
  ds_read_b64_tr_b16 v[46:47], v21 offset:7808
  s_add_u32 m0, s59, 6144
  s_mov_b32 s42, 61568
  buffer_load_dwordx4 v28, s[8:11], s42 offen lds
  v_mfma_f32_32x32x16_bf16 v[80:95], v[32:35], a[204:207], v[80:95]
  s_waitcnt lgkmcnt(4)
  v_mfma_f32_32x32x16_bf16 v[96:111], v[36:39], a[200:203], v[96:111]
  ds_read_b64_tr_b16 v[48:49], v20 offset:6400
  ds_read_b64_tr_b16 v[50:51], v20 offset:7936
  s_add_u32 m0, s59, 6144
  s_mov_b32 s42, 61568
  buffer_load_dwordx4 v29, s[8:11], s42 offen offset:1024 lds
  s_add_u32 s36, s36, 12288
  s_cmp_ge_u32 s36, 147456
  s_cselect_b32 s36, 73728, s36
  v_add_u32 v26, s36, v14
  v_add_u32 v27, s36, v15
  v_mfma_f32_32x32x16_bf16 v[112:127], v[36:39], a[204:207], v[112:127]
  s_mov_b32 m0, s34
  s_nop 0
  buffer_load_dwordx4 v7, s[20:23], s32 offen lds
  s_waitcnt lgkmcnt(4)
  v_mfma_f32_32x32x16_bf16 v[128:143], v[40:43], a[200:203], v[128:143]
  ds_read_b64_tr_b16 v[52:53], v21 offset:6400
  ds_read_b64_tr_b16 v[54:55], v21 offset:7936
  s_mov_b32 m0, s34
  s_nop 0
  buffer_load_dwordx4 v8, s[20:23], s32 offen offset:1024 lds
  v_mfma_f32_32x32x16_bf16 v[144:159], v[40:43], a[204:207], v[144:159]
  s_waitcnt lgkmcnt(4)
  v_mfma_f32_32x32x16_bf16 v[160:175], v[44:47], a[200:203], v[160:175]
  ds_read_b64_tr_b16 v[32:33], v26 offset:0
  ds_read_b64_tr_b16 v[34:35], v26 offset:1536
  s_mov_b32 m0, s34
  s_nop 0
  buffer_load_dwordx4 v9, s[20:23], s32 offen offset:2048 lds
  s_add_u32 s32, s32, 393216
  s_add_u32 s34, s34, 12288
  s_cmp_ge_u32 s34, s46
  s_cselect_b32 s39, 73728, 0
  s_sub_u32 s34, s34, s39
  v_mfma_f32_32x32x16_bf16 v[176:191], v[44:47], a[204:207], v[176:191]
  s_mov_b32 m0, s34
  s_nop 0
  buffer_load_dwordx4 v7, s[20:23], s32 offen lds
  s_waitcnt lgkmcnt(4)
  v_mfma_f32_32x32x16_bf16 v[192:207], v[48:51], a[200:203], v[192:207]
  ds_read_b64_tr_b16 v[36:37], v27 offset:0
  ds_read_b64_tr_b16 v[38:39], v27 offset:1536
  v_mfma_f32_32x32x16_bf16 v[208:223], v[48:51], a[204:207], v[208:223]
  s_mov_b32 m0, s34
  s_nop 0
  buffer_load_dwordx4 v8, s[20:23], s32 offen offset:1024 lds
  s_waitcnt lgkmcnt(4)
  v_mfma_f32_32x32x16_bf16 v[224:239], v[52:55], a[200:203], v[224:239]
  ds_read_b64_tr_b16 v[40:41], v26 offset:128
  ds_read_b64_tr_b16 v[42:43], v26 offset:1664
  s_mov_b32 m0, s34
  s_nop 0
  buffer_load_dwordx4 v9, s[20:23], s32 offen offset:2048 lds
  s_add_u32 s32, s32, 393216
  s_add_u32 s34, s34, 12288
  s_cmp_ge_u32 s34, s46
  s_cselect_b32 s39, 73728, 0
  s_sub_u32 s34, s34, s39
  v_mfma_f32_32x32x16_bf16 v[240:255], v[52:55], a[204:207], v[240:255]
  s_waitcnt lgkmcnt(4)
  v_mfma_f32_32x32x16_bf16 v[64:79], v[32:35], a[208:211], v[64:79]
  ds_read_b64_tr_b16 v[44:45], v27 offset:128
  ds_read_b64_tr_b16 v[46:47], v27 offset:1664
  v_mfma_f32_32x32x16_bf16 v[80:95], v[32:35], a[212:215], v[80:95]
  s_waitcnt lgkmcnt(4)
  v_mfma_f32_32x32x16_bf16 v[96:111], v[36:39], a[208:211], v[96:111]
  ds_read_b64_tr_b16 v[48:49], v26 offset:256
  ds_read_b64_tr_b16 v[50:51], v26 offset:1792
  v_mfma_f32_32x32x16_bf16 v[112:127], v[36:39], a[212:215], v[112:127]
  s_waitcnt vmcnt(3)
  s_barrier
  s_waitcnt lgkmcnt(4)
  v_mfma_f32_32x32x16_bf16 v[128:143], v[40:43], a[208:211], v[128:143]
  ds_read_b64_tr_b16 v[52:53], v27 offset:256
  ds_read_b64_tr_b16 v[54:55], v27 offset:1792
  s_mov_b32 m0, s34
  s_nop 0
  buffer_load_dwordx4 v7, s[20:23], s32 offen lds
  v_mfma_f32_32x32x16_bf16 v[144:159], v[40:43], a[212:215], v[144:159]
  s_add_u32 m0, s58, 0
  s_mov_b32 s42, 256
  buffer_load_dwordx4 v28, s[8:11], s42 offen lds
  s_waitcnt lgkmcnt(4)
  v_mfma_f32_32x32x16_bf16 v[160:175], v[44:47], a[208:211], v[160:175]
  ds_read_b64_tr_b16 v[32:33], v26 offset:6144
  ds_read_b64_tr_b16 v[34:35], v26 offset:7680
  s_mov_b32 m0, s34
  s_nop 0
  buffer_load_dwordx4 v8, s[20:23], s32 offen offset:1024 lds
  v_mfma_f32_32x32x16_bf16 v[176:191], v[44:47], a[212:215], v[176:191]
  s_waitcnt lgkmcnt(4)
  v_mfma_f32_32x32x16_bf16 v[192:207], v[48:51], a[208:211], v[192:207]
  ds_read_b64_tr_b16 v[36:37], v27 offset:6144
  ds_read_b64_tr_b16 v[38:39], v27 offset:7680
  s_add_u32 m0, s58, 0
  s_mov_b32 s42, 256
  buffer_load_dwordx4 v29, s[8:11], s42 offen offset:1024 lds
  v_mfma_f32_32x32x16_bf16 v[208:223], v[48:51], a[212:215], v[208:223]
  s_mov_b32 m0, s34
  s_nop 0
  buffer_load_dwordx4 v9, s[20:23], s32 offen offset:2048 lds
  s_add_u32 s32, s32, 393216
  s_add_u32 s34, s34, 12288
  s_cmp_ge_u32 s34, s46
  s_cselect_b32 s39, 73728, 0
  s_sub_u32 s34, s34, s39
  s_waitcnt lgkmcnt(4)
  v_mfma_f32_32x32x16_bf16 v[224:239], v[52:55], a[208:211], v[224:239]
  ds_read_b64_tr_b16 v[40:41], v26 offset:6272
  ds_read_b64_tr_b16 v[42:43], v26 offset:7808
  v_mfma_f32_32x32x16_bf16 v[240:255], v[52:55], a[212:215], v[240:255]
  s_add_u32 m0, s58, 2048
  s_mov_b32 s42, 20736
  buffer_load_dwordx4 v28, s[8:11], s42 offen lds
  s_waitcnt lgkmcnt(4)
  v_mfma_f32_32x32x16_bf16 v[64:79], v[32:35], a[216:219], v[64:79]
  ds_read_b64_tr_b16 v[44:45], v27 offset:6272
  ds_read_b64_tr_b16 v[46:47], v27 offset:7808
  s_mov_b32 m0, s34
  s_nop 0
  buffer_load_dwordx4 v7, s[20:23], s32 offen lds
  s_waitcnt vmcnt(13)
  ds_read_b128 a[224:227], v60 offset:0
  ds_read_b128 a[228:231], v60 offset:4096
  ds_read_b128 a[232:235], v61 offset:0
  ds_read_b128 a[236:239], v61 offset:4096
  ds_read_b128 a[240:243], v62 offset:0
  ds_read_b128 a[244:247], v62 offset:4096
  ds_read_b128 a[248:251], v63 offset:0
  ds_read_b128 a[252:255], v63 offset:4096
  v_mfma_f32_32x32x16_bf16 v[80:95], v[32:35], a[220:223], v[80:95]
  s_waitcnt lgkmcnt(12)
  v_mfma_f32_32x32x16_bf16 v[96:111], v[36:39], a[216:219], v[96:111]
  ds_read_b64_tr_b16 v[48:49], v26 offset:6400
  ds_read_b64_tr_b16 v[50:51], v26 offset:7936
  s_add_u32 m0, s58, 2048
  s_mov_b32 s42, 20736
  buffer_load_dwordx4 v29, s[8:11], s42 offen offset:1024 lds
  s_add_u32 s36, s36, 12288
  s_cmp_ge_u32 s36, 147456
  s_cselect_b32 s36, 73728, s36
  v_add_u32 v20, s36, v14
  v_add_u32 v21, s36, v15
  v_mfma_f32_32x32x16_bf16 v[112:127], v[36:39], a[220:223], v[112:127]
  s_mov_b32 m0, s34
  s_nop 0
  buffer_load_dwordx4 v8, s[20:23], s32 offen offset:1024 lds
  s_waitcnt lgkmcnt(12)
  v_mfma_f32_32x32x16_bf16 v[128:143], v[40:43], a[216:219], v[128:143]
  ds_read_b64_tr_b16 v[52:53], v27 offset:6400
  ds_read_b64_tr_b16 v[54:55], v27 offset:7936
  s_add_u32 m0, s58, 4096
  s_mov_b32 s42, 41216
  buffer_load_dwordx4 v28, s[8:11], s42 offen lds
  v_mfma_f32_32x32x16_bf16 v[144:159], v[40:43], a[220:223], v[144:159]
  s_waitcnt lgkmcnt(12)
  v_mfma_f32_32x32x16_bf16 v[160:175], v[44:47], a[216:219], v[160:175]
  ds_read_b64_tr_b16 v[32:33], v20 offset:0
  ds_read_b64_tr_b16 v[34:35], v20 offset:1536
  s_mov_b32 m0, s34
  s_nop 0
  buffer_load_dwordx4 v9, s[20:23], s32 offen offset:2048 lds
  s_add_u32 s32, s32, 393216
  s_add_u32 s34, s34, 12288
  s_cmp_ge_u32 s34, s46
  s_cselect_b32 s39, 73728, 0
  s_sub_u32 s34, s34, s39
  v_mfma_f32_32x32x16_bf16 v[176:191], v[44:47], a[220:223], v[176:191]
  s_add_u32 m0, s58, 4096
  s_mov_b32 s42, 41216
  buffer_load_dwordx4 v29, s[8:11], s42 offen offset:1024 lds
  s_waitcnt lgkmcnt(4)
  v_mfma_f32_32x32x16_bf16 v[192:207], v[48:51], a[216:219], v[192:207]
  ds_read_b64_tr_b16 v[36:37], v21 offset:0
  ds_read_b64_tr_b16 v[38:39], v21 offset:1536
  v_mfma_f32_32x32x16_bf16 v[208:223], v[48:51], a[220:223], v[208:223]
  s_add_u32 m0, s58, 6144
  s_mov_b32 s42, 61696
  buffer_load_dwordx4 v28, s[8:11], s42 offen lds
  s_waitcnt lgkmcnt(4)
  v_mfma_f32_32x32x16_bf16 v[224:239], v[52:55], a[216:219], v[224:239]
  ds_read_b64_tr_b16 v[40:41], v20 offset:128
  ds_read_b64_tr_b16 v[42:43], v20 offset:1664
  s_add_u32 m0, s58, 6144
  s_mov_b32 s42, 61696
  buffer_load_dwordx4 v29, s[8:11], s42 offen offset:1024 lds
  v_mfma_f32_32x32x16_bf16 v[240:255], v[52:55], a[220:223], v[240:255]
  s_waitcnt lgkmcnt(10)
  s_waitcnt lgkmcnt(4)
  v_mfma_f32_32x32x16_bf16 v[64:79], v[32:35], a[224:227], v[64:79]
  ds_read_b64_tr_b16 v[44:45], v21 offset:128
  ds_read_b64_tr_b16 v[46:47], v21 offset:1664
  v_mfma_f32_32x32x16_bf16 v[80:95], v[32:35], a[228:231], v[80:95]
  s_waitcnt lgkmcnt(4)
  v_mfma_f32_32x32x16_bf16 v[96:111], v[36:39], a[224:227], v[96:111]
  ds_read_b64_tr_b16 v[48:49], v20 offset:256
  ds_read_b64_tr_b16 v[50:51], v20 offset:1792
  v_mfma_f32_32x32x16_bf16 v[112:127], v[36:39], a[228:231], v[112:127]
  s_waitcnt vmcnt(14)
  s_barrier
  s_waitcnt lgkmcnt(4)
  v_mfma_f32_32x32x16_bf16 v[128:143], v[40:43], a[224:227], v[128:143]
  ds_read_b64_tr_b16 v[52:53], v21 offset:256
  ds_read_b64_tr_b16 v[54:55], v21 offset:1792
  s_mov_b32 m0, s34
  s_nop 0
  buffer_load_dwordx4 v7, s[20:23], s32 offen lds
  v_mfma_f32_32x32x16_bf16 v[144:159], v[40:43], a[228:231], v[144:159]
  s_waitcnt lgkmcnt(4)
  v_mfma_f32_32x32x16_bf16 v[160:175], v[44:47], a[224:227], v[160:175]
  ds_read_b64_tr_b16 v[32:33], v20 offset:6144
  ds_read_b64_tr_b16 v[34:35], v20 offset:7680
  s_add_u32 m0, s59, 0
  s_mov_b32 s42, 384
  buffer_load_dwordx4 v28, s[8:11], s42 offen lds
  v_mfma_f32_32x32x16_bf16 v[176:191], v[44:47], a[228:231], v[176:191]
  s_waitcnt lgkmcnt(4)
  v_mfma_f32_32x32x16_bf16 v[192:207], v[48:51], a[224:227], v[192:207]
  ds_read_b64_tr_b16 v[36:37], v21 offset:6144
  ds_read_b64_tr_b16 v[38:39], v21 offset:7680
  s_mov_b32 m0, s34
  s_nop 0
  buffer_load_dwordx4 v8, s[20:23], s32 offen offset:1024 lds
  v_mfma_f32_32x32x16_bf16 v[208:223], v[48:51], a[228:231], v[208:223]
  s_waitcnt lgkmcnt(4)
  v_mfma_f32_32x32x16_bf16 v[224:239], v[52:55], a[224:227], v[224:239]
  ds_read_b64_tr_b16 v[40:41], v20 offset:6272
  ds_read_b64_tr_b16 v[42:43], v20 offset:7808
  s_add_u32 m0, s59, 0
  s_mov_b32 s42, 384
  buffer_load_dwordx4 v29, s[8:11], s42 offen offset:1024 lds
  v_mfma_f32_32x32x16_bf16 v[240:255], v[52:55], a[228:231], v[240:255]
  s_waitcnt lgkmcnt(4)
  v_mfma_f32_32x32x16_bf16 v[64:79], v[32:35], a[232:235], v[64:79]
  ds_read_b64_tr_b16 v[44:45], v21 offset:6272
  ds_read_b64_tr_b16 v[46:47], v21 offset:7808
  s_mov_b32 m0, s34
  s_nop 0
  buffer_load_dwordx4 v9, s[20:23], s32 offen offset:2048 lds
  s_add_u32 s32, s32, 393216
  s_add_u32 s34, s34, 12288
  s_cmp_ge_u32 s34, s46
  s_cselect_b32 s39, 73728, 0
  s_sub_u32 s34, s34, s39
  v_mfma_f32_32x32x16_bf16 v[80:95], v[32:35], a[236:239], v[80:95]
  s_waitcnt lgkmcnt(4)
  v_mfma_f32_32x32x16_bf16 v[96:111], v[36:39], a[232:235], v[96:111]
  ds_read_b64_tr_b16 v[48:49], v20 offset:6400
  ds_read_b64_tr_b16 v[50:51], v20 offset:7936
  s_add_u32 m0, s59, 2048
  s_mov_b32 s42, 20864
  buffer_load_dwordx4 v28, s[8:11], s42 offen lds
  s_add_u32 s36, s36, 12288
  s_cmp_ge_u32 s36, 147456
  s_cselect_b32 s36, 73728, s36
  v_add_u32 v26, s36, v14
  v_add_u32 v27, s36, v15
  v_mfma_f32_32x32x16_bf16 v[112:127], v[36:39], a[236:239], v[112:127]
  s_waitcnt lgkmcnt(4)
  v_mfma_f32_32x32x16_bf16 v[128:143], v[40:43], a[232:235], v[128:143]
  ds_read_b64_tr_b16 v[52:53], v21 offset:6400
  ds_read_b64_tr_b16 v[54:55], v21 offset:7936
  s_mov_b32 m0, s34
  s_nop 0
  buffer_load_dwordx4 v7, s[20:23], s32 offen lds
  v_mfma_f32_32x32x16_bf16 v[144:159], v[40:43], a[236:239], v[144:159]
  s_waitcnt lgkmcnt(4)
  v_mfma_f32_32x32x16_bf16 v[160:175], v[44:47], a[232:235], v[160:175]
  ds_read_b64_tr_b16 v[32:33], v26 offset:0
  ds_read_b64_tr_b16 v[34:35], v26 offset:1536
  s_add_u32 m0, s59, 2048
  s_mov_b32 s42, 20864
  buffer_load_dwordx4 v29, s[8:11], s42 offen offset:1024 lds
  v_mfma_f32_32x32x16_bf16 v[176:191], v[44:47], a[236:239], v[176:191]
  s_waitcnt lgkmcnt(4)
  v_mfma_f32_32x32x16_bf16 v[192:207], v[48:51], a[232:235], v[192:207]
  ds_read_b64_tr_b16 v[36:37], v27 offset:0
  ds_read_b64_tr_b16 v[38:39], v27 offset:1536
  s_mov_b32 m0, s34
  s_nop 0
  buffer_load_dwordx4 v8, s[20:23], s32 offen offset:1024 lds
  v_mfma_f32_32x32x16_bf16 v[208:223], v[48:51], a[236:239], v[208:223]
  s_waitcnt lgkmcnt(4)
  v_mfma_f32_32x32x16_bf16 v[224:239], v[52:55], a[232:235], v[224:239]
  ds_read_b64_tr_b16 v[40:41], v26 offset:128
  ds_read_b64_tr_b16 v[42:43], v26 offset:1664
  s_mov_b32 m0, s34
  s_nop 0
  buffer_load_dwordx4 v9, s[20:23], s32 offen offset:2048 lds
  s_add_u32 s32, s32, 393216
  s_add_u32 s34, s34, 12288
  s_cmp_ge_u32 s34, s46
  s_cselect_b32 s39, 73728, 0
  s_sub_u32 s34, s34, s39
  v_mfma_f32_32x32x16_bf16 v[240:255], v[52:55], a[236:239], v[240:255]
  s_waitcnt lgkmcnt(4)
  v_mfma_f32_32x32x16_bf16 v[64:79], v[32:35], a[240:243], v[64:79]
  ds_read_b64_tr_b16 v[44:45], v27 offset:128
  ds_read_b64_tr_b16 v[46:47], v27 offset:1664
  v_mfma_f32_32x32x16_bf16 v[80:95], v[32:35], a[244:247], v[80:95]
  s_waitcnt lgkmcnt(4)
  v_mfma_f32_32x32x16_bf16 v[96:111], v[36:39], a[240:243], v[96:111]
  ds_read_b64_tr_b16 v[48:49], v26 offset:256
  ds_read_b64_tr_b16 v[50:51], v26 offset:1792
  v_mfma_f32_32x32x16_bf16 v[112:127], v[36:39], a[244:247], v[112:127]
  s_waitcnt vmcnt(19)
  s_barrier
  s_waitcnt lgkmcnt(4)
  v_mfma_f32_32x32x16_bf16 v[128:143], v[40:43], a[240:243], v[128:143]
  ds_read_b64_tr_b16 v[52:53], v27 offset:256
  ds_read_b64_tr_b16 v[54:55], v27 offset:1792
  s_mov_b32 m0, s34
  s_nop 0
  buffer_load_dwordx4 v7, s[20:23], s32 offen lds
  v_mfma_f32_32x32x16_bf16 v[144:159], v[40:43], a[244:247], v[144:159]
  s_waitcnt lgkmcnt(4)
  v_mfma_f32_32x32x16_bf16 v[160:175], v[44:47], a[240:243], v[160:175]
  ds_read_b64_tr_b16 v[32:33], v26 offset:6144
  ds_read_b64_tr_b16 v[34:35], v26 offset:7680
  s_add_u32 m0, s59, 4096
  s_mov_b32 s42, 41344
  buffer_load_dwordx4 v28, s[8:11], s42 offen lds
  v_mfma_f32_32x32x16_bf16 v[176:191], v[44:47], a[244:247], v[176:191]
  s_waitcnt lgkmcnt(4)
  v_mfma_f32_32x32x16_bf16 v[192:207], v[48:51], a[240:243], v[192:207]
  ds_read_b64_tr_b16 v[36:37], v27 offset:6144
  ds_read_b64_tr_b16 v[38:39], v27 offset:7680
  v_mfma_f32_32x32x16_bf16 v[208:223], v[48:51], a[244:247], v[208:223]
  s_mov_b32 m0, s34
  s_nop 0
  buffer_load_dwordx4 v8, s[20:23], s32 offen offset:1024 lds
  s_waitcnt lgkmcnt(4)
  v_mfma_f32_32x32x16_bf16 v[224:239], v[52:55], a[240:243], v[224:239]
  ds_read_b64_tr_b16 v[40:41], v26 offset:6272
  ds_read_b64_tr_b16 v[42:43], v26 offset:7808
  v_mfma_f32_32x32x16_bf16 v[240:255], v[52:55], a[244:247], v[240:255]
  s_waitcnt lgkmcnt(4)
  v_mfma_f32_32x32x16_bf16 v[64:79], v[32:35], a[248:251], v[64:79]
  ds_read_b64_tr_b16 v[44:45], v27 offset:6272
  ds_read_b64_tr_b16 v[46:47], v27 offset:7808
  s_add_u32 m0, s59, 4096
  s_mov_b32 s42, 41344
  buffer_load_dwordx4 v29, s[8:11], s42 offen offset:1024 lds
  s_waitcnt vmcnt(14)
  ds_read_b128 a[192:195], v56 offset:0
  ds_read_b128 a[196:199], v56 offset:4096
  ds_read_b128 a[200:203], v57 offset:0
  ds_read_b128 a[204:207], v57 offset:4096
  ds_read_b128 a[208:211], v58 offset:0
  ds_read_b128 a[212:215], v58 offset:4096
  ds_read_b128 a[216:219], v59 offset:0
  ds_read_b128 a[220:223], v59 offset:4096
  v_mfma_f32_32x32x16_bf16 v[80:95], v[32:35], a[252:255], v[80:95]
  s_waitcnt lgkmcnt(12)
  v_mfma_f32_32x32x16_bf16 v[96:111], v[36:39], a[248:251], v[96:111]
  ds_read_b64_tr_b16 v[48:49], v26 offset:6400
  ds_read_b64_tr_b16 v[50:51], v26 offset:7936
  s_add_u32 s36, s36, 12288
  s_cmp_ge_u32 s36, 147456
  s_cselect_b32 s36, 73728, s36
  v_add_u32 v20, s36, v14
  v_add_u32 v21, s36, v15
  v_mfma_f32_32x32x16_bf16 v[112:127], v[36:39], a[252:255], v[112:127]
  s_mov_b32 m0, s34
  s_nop 0
  buffer_load_dwordx4 v9, s[20:23], s32 offen offset:2048 lds
  s_add_u32 s32, s32, 393216
  s_add_u32 s34, s34, 12288
  s_cmp_ge_u32 s34, s46
  s_cselect_b32 s39, 73728, 0
  s_sub_u32 s34, s34, s39
  s_waitcnt lgkmcnt(12)
  v_mfma_f32_32x32x16_bf16 v[128:143], v[40:43], a[248:251], v[128:143]
  ds_read_b64_tr_b16 v[52:53], v27 offset:6400
  ds_read_b64_tr_b16 v[54:55], v27 offset:7936
  v_mfma_f32_32x32x16_bf16 v[144:159], v[40:43], a[252:255], v[144:159]
  s_waitcnt lgkmcnt(12)
  v_mfma_f32_32x32x16_bf16 v[160:175], v[44:47], a[248:251], v[160:175]
  ds_read_b64_tr_b16 v[32:33], v20 offset:0
  ds_read_b64_tr_b16 v[34:35], v20 offset:1536
  s_add_u32 m0, s59, 6144
  s_mov_b32 s42, 61824
  buffer_load_dwordx4 v28, s[8:11], s42 offen lds
  v_mfma_f32_32x32x16_bf16 v[176:191], v[44:47], a[252:255], v[176:191]
  s_waitcnt lgkmcnt(4)
  v_mfma_f32_32x32x16_bf16 v[192:207], v[48:51], a[248:251], v[192:207]
  ds_read_b64_tr_b16 v[36:37], v21 offset:0
  ds_read_b64_tr_b16 v[38:39], v21 offset:1536
  v_mfma_f32_32x32x16_bf16 v[208:223], v[48:51], a[252:255], v[208:223]
  s_add_u32 m0, s59, 6144
  s_mov_b32 s42, 61824
  buffer_load_dwordx4 v29, s[8:11], s42 offen offset:1024 lds
  s_waitcnt lgkmcnt(4)
  v_mfma_f32_32x32x16_bf16 v[224:239], v[52:55], a[248:251], v[224:239]
  ds_read_b64_tr_b16 v[40:41], v20 offset:128
  ds_read_b64_tr_b16 v[42:43], v20 offset:1664
  v_mfma_f32_32x32x16_bf16 v[240:255], v[52:55], a[252:255], v[240:255]
  s_waitcnt lgkmcnt(10)
  s_waitcnt lgkmcnt(4)
  v_mfma_f32_32x32x16_bf16 v[64:79], v[32:35], a[192:195], v[64:79]
  ds_read_b64_tr_b16 v[44:45], v21 offset:128
  ds_read_b64_tr_b16 v[46:47], v21 offset:1664
  v_mfma_f32_32x32x16_bf16 v[80:95], v[32:35], a[196:199], v[80:95]
  s_waitcnt lgkmcnt(4)
  v_mfma_f32_32x32x16_bf16 v[96:111], v[36:39], a[192:195], v[96:111]
  ds_read_b64_tr_b16 v[48:49], v20 offset:256
  ds_read_b64_tr_b16 v[50:51], v20 offset:1792
  v_mfma_f32_32x32x16_bf16 v[112:127], v[36:39], a[196:199], v[112:127]
  s_waitcnt vmcnt(20)
  s_barrier
  s_waitcnt lgkmcnt(4)
  v_mfma_f32_32x32x16_bf16 v[128:143], v[40:43], a[192:195], v[128:143]
  ds_read_b64_tr_b16 v[52:53], v21 offset:256
  ds_read_b64_tr_b16 v[54:55], v21 offset:1792
  s_mov_b32 m0, s34
  s_nop 0
  buffer_load_dwordx4 v7, s[20:23], s32 offen lds
  v_mfma_f32_32x32x16_bf16 v[144:159], v[40:43], a[196:199], v[144:159]
  s_waitcnt lgkmcnt(4)
  v_mfma_f32_32x32x16_bf16 v[160:175], v[44:47], a[192:195], v[160:175]
  ds_read_b64_tr_b16 v[32:33], v20 offset:6144
  ds_read_b64_tr_b16 v[34:35], v20 offset:7680
  s_add_u32 m0, s58, 0
  s_mov_b32 s42, 512
  buffer_load_dwordx4 v28, s[8:11], s42 offen lds
  v_mfma_f32_32x32x16_bf16 v[176:191], v[44:47], a[196:199], v[176:191]
  s_waitcnt lgkmcnt(4)
  v_mfma_f32_32x32x16_bf16 v[192:207], v[48:51], a[192:195], v[192:207]
  ds_read_b64_tr_b16 v[36:37], v21 offset:6144
  ds_read_b64_tr_b16 v[38:39], v21 offset:7680
  v_mfma_f32_32x32x16_bf16 v[208:223], v[48:51], a[196:199], v[208:223]
  s_mov_b32 m0, s34
  s_nop 0
  buffer_load_dwordx4 v8, s[20:23], s32 offen offset:1024 lds
  s_waitcnt lgkmcnt(4)
  v_mfma_f32_32x32x16_bf16 v[224:239], v[52:55], a[192:195], v[224:239]
  ds_read_b64_tr_b16 v[40:41], v20 offset:6272
  ds_read_b64_tr_b16 v[42:43], v20 offset:7808
  v_mfma_f32_32x32x16_bf16 v[240:255], v[52:55], a[196:199], v[240:255]
  s_waitcnt lgkmcnt(4)
  v_mfma_f32_32x32x16_bf16 v[64:79], v[32:35], a[200:203], v[64:79]
  ds_read_b64_tr_b16 v[44:45], v21 offset:6272
  ds_read_b64_tr_b16 v[46:47], v21 offset:7808
  s_add_u32 m0, s58, 0
  s_mov_b32 s42, 512
  buffer_load_dwordx4 v29, s[8:11], s42 offen offset:1024 lds
  v_mfma_f32_32x32x16_bf16 v[80:95], v[32:35], a[204:207], v[80:95]
  s_waitcnt lgkmcnt(4)
  v_mfma_f32_32x32x16_bf16 v[96:111], v[36:39], a[200:203], v[96:111]
  ds_read_b64_tr_b16 v[48:49], v20 offset:6400
  ds_read_b64_tr_b16 v[50:51], v20 offset:7936
  s_add_u32 s36, s36, 12288
  s_cmp_ge_u32 s36, 147456
  s_cselect_b32 s36, 73728, s36
  v_add_u32 v26, s36, v14
  v_add_u32 v27, s36, v15
  v_mfma_f32_32x32x16_bf16 v[112:127], v[36:39], a[204:207], v[112:127]
  s_mov_b32 m0, s34
  s_nop 0
  buffer_load_dwordx4 v9, s[20:23], s32 offen offset:2048 lds
  s_add_u32 s32, s32, 393216
  s_add_u32 s34, s34, 12288
  s_cmp_ge_u32 s34, s46
  s_cselect_b32 s39, 73728, 0
  s_sub_u32 s34, s34, s39
  s_waitcnt lgkmcnt(4)
  v_mfma_f32_32x32x16_bf16 v[128:143], v[40:43], a[200:203], v[128:143]
  ds_read_b64_tr_b16 v[52:53], v21 offset:6400
  ds_read_b64_tr_b16 v[54:55], v21 offset:7936
  v_mfma_f32_32x32x16_bf16 v[144:159], v[40:43], a[204:207], v[144:159]
  s_waitcnt lgkmcnt(4)
  v_mfma_f32_32x32x16_bf16 v[160:175], v[44:47], a[200:203], v[160:175]
  ds_read_b64_tr_b16 v[32:33], v26 offset:0
  ds_read_b64_tr_b16 v[34:35], v26 offset:1536
  s_add_u32 m0, s58, 2048
  s_mov_b32 s42, 20992
  buffer_load_dwordx4 v28, s[8:11], s42 offen lds
  v_mfma_f32_32x32x16_bf16 v[176:191], v[44:47], a[204:207], v[176:191]
  s_waitcnt lgkmcnt(4)
  v_mfma_f32_32x32x16_bf16 v[192:207], v[48:51], a[200:203], v[192:207]
  ds_read_b64_tr_b16 v[36:37], v27 offset:0
  ds_read_b64_tr_b16 v[38:39], v27 offset:1536
  v_mfma_f32_32x32x16_bf16 v[208:223], v[48:51], a[204:207], v[208:223]
  s_add_u32 m0, s58, 2048
  s_mov_b32 s42, 20992
  buffer_load_dwordx4 v29, s[8:11], s42 offen offset:1024 lds
  s_waitcnt lgkmcnt(4)
  v_mfma_f32_32x32x16_bf16 v[224:239], v[52:55], a[200:203], v[224:239]
  ds_read_b64_tr_b16 v[40:41], v26 offset:128
  ds_read_b64_tr_b16 v[42:43], v26 offset:1664
  v_mfma_f32_32x32x16_bf16 v[240:255], v[52:55], a[204:207], v[240:255]
  s_waitcnt lgkmcnt(4)
  v_mfma_f32_32x32x16_bf16 v[64:79], v[32:35], a[208:211], v[64:79]
  ds_read_b64_tr_b16 v[44:45], v27 offset:128
  ds_read_b64_tr_b16 v[46:47], v27 offset:1664
  v_mfma_f32_32x32x16_bf16 v[80:95], v[32:35], a[212:215], v[80:95]
  s_waitcnt lgkmcnt(4)
  v_mfma_f32_32x32x16_bf16 v[96:111], v[36:39], a[208:211], v[96:111]
  ds_read_b64_tr_b16 v[48:49], v26 offset:256
  ds_read_b64_tr_b16 v[50:51], v26 offset:1792
  v_mfma_f32_32x32x16_bf16 v[112:127], v[36:39], a[212:215], v[112:127]
  s_waitcnt vmcnt(19)
  s_barrier
  s_waitcnt lgkmcnt(4)
  v_mfma_f32_32x32x16_bf16 v[128:143], v[40:43], a[208:211], v[128:143]
  ds_read_b64_tr_b16 v[52:53], v27 offset:256
  ds_read_b64_tr_b16 v[54:55], v27 offset:1792
  s_mov_b32 m0, s34
  s_nop 0
  buffer_load_dwordx4 v7, s[20:23], s32 offen lds
  v_mfma_f32_32x32x16_bf16 v[144:159], v[40:43], a[212:215], v[144:159]
  s_waitcnt lgkmcnt(4)
  v_mfma_f32_32x32x16_bf16 v[160:175], v[44:47], a[208:211], v[160:175]
  ds_read_b64_tr_b16 v[32:33], v26 offset:6144
  ds_read_b64_tr_b16 v[34:35], v26 offset:7680
  s_add_u32 m0, s58, 4096
  s_mov_b32 s42, 41472
  buffer_load_dwordx4 v28, s[8:11], s42 offen lds
  v_mfma_f32_32x32x16_bf16 v[176:191], v[44:47], a[212:215], v[176:191]
  s_waitcnt lgkmcnt(4)
  v_mfma_f32_32x32x16_bf16 v[192:207], v[48:51], a[208:211], v[192:207]
  ds_read_b64_tr_b16 v[36:37], v27 offset:6144
  ds_read_b64_tr_b16 v[38:39], v27 offset:7680
  v_mfma_f32_32x32x16_bf16 v[208:223], v[48:51], a[212:215], v[208:223]
  s_mov_b32 m0, s34
  s_nop 0
  buffer_load_dwordx4 v8, s[20:23], s32 offen offset:1024 lds
  s_waitcnt lgkmcnt(4)
  v_mfma_f32_32x32x16_bf16 v[224:239], v[52:55], a[208:211], v[224:239]
  ds_read_b64_tr_b16 v[40:41], v26 offset:6272
  ds_read_b64_tr_b16 v[42:43], v26 offset:7808
  v_mfma_f32_32x32x16_bf16 v[240:255], v[52:55], a[212:215], v[240:255]
  s_waitcnt lgkmcnt(4)
  v_mfma_f32_32x32x16_bf16 v[64:79], v[32:35], a[216:219], v[64:79]
  ds_read_b64_tr_b16 v[44:45], v27 offset:6272
  ds_read_b64_tr_b16 v[46:47], v27 offset:7808
  s_add_u32 m0, s58, 4096
  s_mov_b32 s42, 41472
  buffer_load_dwordx4 v29, s[8:11], s42 offen offset:1024 lds
  s_waitcnt vmcnt(11)
  ds_read_b128 a[224:227], v60 offset:0
  ds_read_b128 a[228:231], v60 offset:4096
  ds_read_b128 a[232:235], v61 offset:0
  ds_read_b128 a[236:239], v61 offset:4096
  ds_read_b128 a[240:243], v62 offset:0
  ds_read_b128 a[244:247], v62 offset:4096
  ds_read_b128 a[248:251], v63 offset:0
  ds_read_b128 a[252:255], v63 offset:4096
  v_mfma_f32_32x32x16_bf16 v[80:95], v[32:35], a[220:223], v[80:95]
  s_waitcnt lgkmcnt(12)
  v_mfma_f32_32x32x16_bf16 v[96:111], v[36:39], a[216:219], v[96:111]
  ds_read_b64_tr_b16 v[48:49], v26 offset:6400
  ds_read_b64_tr_b16 v[50:51], v26 offset:7936
  s_add_u32 s36, s36, 12288
  s_cmp_ge_u32 s36, 147456
  s_cselect_b32 s36, 73728, s36
  v_add_u32 v20, s36, v14
  v_add_u32 v21, s36, v15
  v_mfma_f32_32x32x16_bf16 v[112:127], v[36:39], a[220:223], v[112:127]
  s_mov_b32 m0, s34
  s_nop 0
  buffer_load_dwordx4 v9, s[20:23], s32 offen offset:2048 lds
  s_add_u32 s32, s32, 393216
  s_add_u32 s34, s34, 12288
  s_cmp_ge_u32 s34, s46
  s_cselect_b32 s39, 73728, 0
  s_sub_u32 s34, s34, s39
  s_waitcnt lgkmcnt(12)
  v_mfma_f32_32x32x16_bf16 v[128:143], v[40:43], a[216:219], v[128:143]
  ds_read_b64_tr_b16 v[52:53], v27 offset:6400
  ds_read_b64_tr_b16 v[54:55], v27 offset:7936
  v_mfma_f32_32x32x16_bf16 v[144:159], v[40:43], a[220:223], v[144:159]
  s_waitcnt lgkmcnt(12)
  v_mfma_f32_32x32x16_bf16 v[160:175], v[44:47], a[216:219], v[160:175]
  ds_read_b64_tr_b16 v[32:33], v20 offset:0
  ds_read_b64_tr_b16 v[34:35], v20 offset:1536
  s_add_u32 m0, s58, 6144
  s_mov_b32 s42, 61952
  buffer_load_dwordx4 v28, s[8:11], s42 offen lds
  v_mfma_f32_32x32x16_bf16 v[176:191], v[44:47], a[220:223], v[176:191]
  s_waitcnt lgkmcnt(4)
  v_mfma_f32_32x32x16_bf16 v[192:207], v[48:51], a[216:219], v[192:207]
  ds_read_b64_tr_b16 v[36:37], v21 offset:0
  ds_read_b64_tr_b16 v[38:39], v21 offset:1536
  v_mfma_f32_32x32x16_bf16 v[208:223], v[48:51], a[220:223], v[208:223]
  s_add_u32 m0, s58, 6144
  s_mov_b32 s42, 61952
  buffer_load_dwordx4 v29, s[8:11], s42 offen offset:1024 lds
  s_waitcnt lgkmcnt(4)
  v_mfma_f32_32x32x16_bf16 v[224:239], v[52:55], a[216:219], v[224:239]
  ds_read_b64_tr_b16 v[40:41], v20 offset:128
  ds_read_b64_tr_b16 v[42:43], v20 offset:1664
  v_mfma_f32_32x32x16_bf16 v[240:255], v[52:55], a[220:223], v[240:255]
  s_waitcnt lgkmcnt(10)
  s_waitcnt lgkmcnt(4)
  v_mfma_f32_32x32x16_bf16 v[64:79], v[32:35], a[224:227], v[64:79]
  ds_read_b64_tr_b16 v[44:45], v21 offset:128
  ds_read_b64_tr_b16 v[46:47], v21 offset:1664
  v_mfma_f32_32x32x16_bf16 v[80:95], v[32:35], a[228:231], v[80:95]
  s_waitcnt lgkmcnt(4)
  v_mfma_f32_32x32x16_bf16 v[96:111], v[36:39], a[224:227], v[96:111]
  ds_read_b64_tr_b16 v[48:49], v20 offset:256
  ds_read_b64_tr_b16 v[50:51], v20 offset:1792
  v_mfma_f32_32x32x16_bf16 v[112:127], v[36:39], a[228:231], v[112:127]
  s_waitcnt vmcnt(21)
  s_barrier
  s_waitcnt lgkmcnt(4)
  v_mfma_f32_32x32x16_bf16 v[128:143], v[40:43], a[224:227], v[128:143]
  ds_read_b64_tr_b16 v[52:53], v21 offset:256
  ds_read_b64_tr_b16 v[54:55], v21 offset:1792
  s_mov_b32 m0, s34
  s_nop 0
  buffer_load_dwordx4 v7, s[20:23], s32 offen lds
  v_mfma_f32_32x32x16_bf16 v[144:159], v[40:43], a[228:231], v[144:159]
  s_waitcnt lgkmcnt(4)
  v_mfma_f32_32x32x16_bf16 v[160:175], v[44:47], a[224:227], v[160:175]
  ds_read_b64_tr_b16 v[32:33], v20 offset:6144
  ds_read_b64_tr_b16 v[34:35], v20 offset:7680
  s_add_u32 m0, s59, 0
  s_mov_b32 s42, 640
  buffer_load_dwordx4 v28, s[8:11], s42 offen lds
  v_mfma_f32_32x32x16_bf16 v[176:191], v[44:47], a[228:231], v[176:191]
  s_waitcnt lgkmcnt(4)
  v_mfma_f32_32x32x16_bf16 v[192:207], v[48:51], a[224:227], v[192:207]
  ds_read_b64_tr_b16 v[36:37], v21 offset:6144
  ds_read_b64_tr_b16 v[38:39], v21 offset:7680
  v_mfma_f32_32x32x16_bf16 v[208:223], v[48:51], a[228:231], v[208:223]
  s_mov_b32 m0, s34
  s_nop 0
  buffer_load_dwordx4 v8, s[20:23], s32 offen offset:1024 lds
  s_waitcnt lgkmcnt(4)
  v_mfma_f32_32x32x16_bf16 v[224:239], v[52:55], a[224:227], v[224:239]
  ds_read_b64_tr_b16 v[40:41], v20 offset:6272
  ds_read_b64_tr_b16 v[42:43], v20 offset:7808
  v_mfma_f32_32x32x16_bf16 v[240:255], v[52:55], a[228:231], v[240:255]
  s_waitcnt lgkmcnt(4)
  v_mfma_f32_32x32x16_bf16 v[64:79], v[32:35], a[232:235], v[64:79]
  ds_read_b64_tr_b16 v[44:45], v21 offset:6272
  ds_read_b64_tr_b16 v[46:47], v21 offset:7808
  s_add_u32 m0, s59, 0
  s_mov_b32 s42, 640
  buffer_load_dwordx4 v29, s[8:11], s42 offen offset:1024 lds
  v_mfma_f32_32x32x16_bf16 v[80:95], v[32:35], a[236:239], v[80:95]
  s_waitcnt lgkmcnt(4)
  v_mfma_f32_32x32x16_bf16 v[96:111], v[36:39], a[232:235], v[96:111]
  ds_read_b64_tr_b16 v[48:49], v20 offset:6400
  ds_read_b64_tr_b16 v[50:51], v20 offset:7936
  s_add_u32 s36, s36, 12288
  s_cmp_ge_u32 s36, 147456
  s_cselect_b32 s36, 73728, s36
  v_add_u32 v26, s36, v14
  v_add_u32 v27, s36, v15
  v_mfma_f32_32x32x16_bf16 v[112:127], v[36:39], a[236:239], v[112:127]
  s_mov_b32 m0, s34
  s_nop 0
  buffer_load_dwordx4 v9, s[20:23], s32 offen offset:2048 lds
  s_add_u32 s32, s32, 393216
  s_add_u32 s34, s34, 12288
  s_cmp_ge_u32 s34, s46
  s_cselect_b32 s39, 73728, 0
  s_sub_u32 s34, s34, s39
  s_waitcnt lgkmcnt(4)
  v_mfma_f32_32x32x16_bf16 v[128:143], v[40:43], a[232:235], v[128:143]
  ds_read_b64_tr_b16 v[52:53], v21 offset:6400
  ds_read_b64_tr_b16 v[54:55], v21 offset:7936
  v_mfma_f32_32x32x16_bf16 v[144:159], v[40:43], a[236:239], v[144:159]
  s_waitcnt lgkmcnt(4)
  v_mfma_f32_32x32x16_bf16 v[160:175], v[44:47], a[232:235], v[160:175]
  ds_read_b64_tr_b16 v[32:33], v26 offset:0
  ds_read_b64_tr_b16 v[34:35], v26 offset:1536
  s_add_u32 m0, s59, 2048
  s_mov_b32 s42, 21120
  buffer_load_dwordx4 v28, s[8:11], s42 offen lds
  v_mfma_f32_32x32x16_bf16 v[176:191], v[44:47], a[236:239], v[176:191]
  s_waitcnt lgkmcnt(4)
  v_mfma_f32_32x32x16_bf16 v[192:207], v[48:51], a[232:235], v[192:207]
  ds_read_b64_tr_b16 v[36:37], v27 offset:0
  ds_read_b64_tr_b16 v[38:39], v27 offset:1536
  v_mfma_f32_32x32x16_bf16 v[208:223], v[48:51], a[236:239], v[208:223]
  s_add_u32 m0, s59, 2048
  s_mov_b32 s42, 21120
  buffer_load_dwordx4 v29, s[8:11], s42 offen offset:1024 lds
  s_waitcnt lgkmcnt(4)
  v_mfma_f32_32x32x16_bf16 v[224:239], v[52:55], a[232:235], v[224:239]
  ds_read_b64_tr_b16 v[40:41], v26 offset:128
  ds_read_b64_tr_b16 v[42:43], v26 offset:1664
  v_mfma_f32_32x32x16_bf16 v[240:255], v[52:55], a[236:239], v[240:255]
  s_waitcnt lgkmcnt(4)
  v_mfma_f32_32x32x16_bf16 v[64:79], v[32:35], a[240:243], v[64:79]
  ds_read_b64_tr_b16 v[44:45], v27 offset:128
  ds_read_b64_tr_b16 v[46:47], v27 offset:1664
  v_mfma_f32_32x32x16_bf16 v[80:95], v[32:35], a[244:247], v[80:95]
  s_waitcnt lgkmcnt(4)
  v_mfma_f32_32x32x16_bf16 v[96:111], v[36:39], a[240:243], v[96:111]
  ds_read_b64_tr_b16 v[48:49], v26 offset:256
  ds_read_b64_tr_b16 v[50:51], v26 offset:1792
  v_mfma_f32_32x32x16_bf16 v[112:127], v[36:39], a[244:247], v[112:127]
  s_waitcnt vmcnt(23)
  s_barrier
  s_waitcnt lgkmcnt(4)
  v_mfma_f32_32x32x16_bf16 v[128:143], v[40:43], a[240:243], v[128:143]
  ds_read_b64_tr_b16 v[52:53], v27 offset:256
  ds_read_b64_tr_b16 v[54:55], v27 offset:1792
  s_mov_b32 m0, s34
  s_nop 0
  buffer_load_dwordx4 v7, s[20:23], s32 offen lds
  v_mfma_f32_32x32x16_bf16 v[144:159], v[40:43], a[244:247], v[144:159]
  s_waitcnt lgkmcnt(4)
  v_mfma_f32_32x32x16_bf16 v[160:175], v[44:47], a[240:243], v[160:175]
  ds_read_b64_tr_b16 v[32:33], v26 offset:6144
  ds_read_b64_tr_b16 v[34:35], v26 offset:7680
  s_add_u32 m0, s59, 4096
  s_mov_b32 s42, 41600
  buffer_load_dwordx4 v28, s[8:11], s42 offen lds
  v_mfma_f32_32x32x16_bf16 v[176:191], v[44:47], a[244:247], v[176:191]
  s_waitcnt lgkmcnt(4)
  v_mfma_f32_32x32x16_bf16 v[192:207], v[48:51], a[240:243], v[192:207]
  ds_read_b64_tr_b16 v[36:37], v27 offset:6144
  ds_read_b64_tr_b16 v[38:39], v27 offset:7680
  v_mfma_f32_32x32x16_bf16 v[208:223], v[48:51], a[244:247], v[208:223]
  s_mov_b32 m0, s34
  s_nop 0
  buffer_load_dwordx4 v8, s[20:23], s32 offen offset:1024 lds
  s_waitcnt lgkmcnt(4)
  v_mfma_f32_32x32x16_bf16 v[224:239], v[52:55], a[240:243], v[224:239]
  ds_read_b64_tr_b16 v[40:41], v26 offset:6272
  ds_read_b64_tr_b16 v[42:43], v26 offset:7808
  v_mfma_f32_32x32x16_bf16 v[240:255], v[52:55], a[244:247], v[240:255]
  s_waitcnt lgkmcnt(4)
  v_mfma_f32_32x32x16_bf16 v[64:79], v[32:35], a[248:251], v[64:79]
  ds_read_b64_tr_b16 v[44:45], v27 offset:6272
  ds_read_b64_tr_b16 v[46:47], v27 offset:7808
  s_add_u32 m0, s59, 4096
  s_mov_b32 s42, 41600
  buffer_load_dwordx4 v29, s[8:11], s42 offen offset:1024 lds
  s_waitcnt vmcnt(11)
  ds_read_b128 a[192:195], v56 offset:0
  ds_read_b128 a[196:199], v56 offset:4096
  ds_read_b128 a[200:203], v57 offset:0
  ds_read_b128 a[204:207], v57 offset:4096
  ds_read_b128 a[208:211], v58 offset:0
  ds_read_b128 a[212:215], v58 offset:4096
  ds_read_b128 a[216:219], v59 offset:0
  ds_read_b128 a[220:223], v59 offset:4096
  v_mfma_f32_32x32x16_bf16 v[80:95], v[32:35], a[252:255], v[80:95]
  s_waitcnt lgkmcnt(12)
  v_mfma_f32_32x32x16_bf16 v[96:111], v[36:39], a[248:251], v[96:111]
  ds_read_b64_tr_b16 v[48:49], v26 offset:6400
  ds_read_b64_tr_b16 v[50:51], v26 offset:7936
  s_add_u32 s36, s36, 12288
  s_cmp_ge_u32 s36, 147456
  s_cselect_b32 s36, 73728, s36
  v_add_u32 v20, s36, v14
  v_add_u32 v21, s36, v15
  v_mfma_f32_32x32x16_bf16 v[112:127], v[36:39], a[252:255], v[112:127]
  s_mov_b32 m0, s34
  s_nop 0
  buffer_load_dwordx4 v9, s[20:23], s32 offen offset:2048 lds
  s_add_u32 s32, s32, 393216
  s_add_u32 s34, s34, 12288
  s_cmp_ge_u32 s34, s46
  s_cselect_b32 s39, 73728, 0
  s_sub_u32 s34, s34, s39
  s_waitcnt lgkmcnt(12)
  v_mfma_f32_32x32x16_bf16 v[128:143], v[40:43], a[248:251], v[128:143]
  ds_read_b64_tr_b16 v[52:53], v27 offset:6400
  ds_read_b64_tr_b16 v[54:55], v27 offset:7936
  v_mfma_f32_32x32x16_bf16 v[144:159], v[40:43], a[252:255], v[144:159]
  s_waitcnt lgkmcnt(12)
  v_mfma_f32_32x32x16_bf16 v[160:175], v[44:47], a[248:251], v[160:175]
  ds_read_b64_tr_b16 v[32:33], v20 offset:0
  ds_read_b64_tr_b16 v[34:35], v20 offset:1536
  s_add_u32 m0, s59, 6144
  s_mov_b32 s42, 62080
  buffer_load_dwordx4 v28, s[8:11], s42 offen lds
  v_mfma_f32_32x32x16_bf16 v[176:191], v[44:47], a[252:255], v[176:191]
  s_waitcnt lgkmcnt(4)
  v_mfma_f32_32x32x16_bf16 v[192:207], v[48:51], a[248:251], v[192:207]
  ds_read_b64_tr_b16 v[36:37], v21 offset:0
  ds_read_b64_tr_b16 v[38:39], v21 offset:1536
  v_mfma_f32_32x32x16_bf16 v[208:223], v[48:51], a[252:255], v[208:223]
  s_add_u32 m0, s59, 6144
  s_mov_b32 s42, 62080
  buffer_load_dwordx4 v29, s[8:11], s42 offen offset:1024 lds
  s_waitcnt lgkmcnt(4)
  v_mfma_f32_32x32x16_bf16 v[224:239], v[52:55], a[248:251], v[224:239]
  ds_read_b64_tr_b16 v[40:41], v20 offset:128
  ds_read_b64_tr_b16 v[42:43], v20 offset:1664
  v_mfma_f32_32x32x16_bf16 v[240:255], v[52:55], a[252:255], v[240:255]
  s_waitcnt lgkmcnt(10)
  s_waitcnt lgkmcnt(4)
  v_mfma_f32_32x32x16_bf16 v[64:79], v[32:35], a[192:195], v[64:79]
  ds_read_b64_tr_b16 v[44:45], v21 offset:128
  ds_read_b64_tr_b16 v[46:47], v21 offset:1664
  v_mfma_f32_32x32x16_bf16 v[80:95], v[32:35], a[196:199], v[80:95]
  s_waitcnt lgkmcnt(4)
  v_mfma_f32_32x32x16_bf16 v[96:111], v[36:39], a[192:195], v[96:111]
  ds_read_b64_tr_b16 v[48:49], v20 offset:256
  ds_read_b64_tr_b16 v[50:51], v20 offset:1792
  v_mfma_f32_32x32x16_bf16 v[112:127], v[36:39], a[196:199], v[112:127]
  s_waitcnt vmcnt(23)
  s_barrier
  s_waitcnt lgkmcnt(4)
  v_mfma_f32_32x32x16_bf16 v[128:143], v[40:43], a[192:195], v[128:143]
  ds_read_b64_tr_b16 v[52:53], v21 offset:256
  ds_read_b64_tr_b16 v[54:55], v21 offset:1792
  s_mov_b32 m0, s34
  s_nop 0
  buffer_load_dwordx4 v7, s[20:23], s32 offen lds
  v_mfma_f32_32x32x16_bf16 v[144:159], v[40:43], a[196:199], v[144:159]
  s_waitcnt lgkmcnt(4)
  v_mfma_f32_32x32x16_bf16 v[160:175], v[44:47], a[192:195], v[160:175]
  ds_read_b64_tr_b16 v[32:33], v20 offset:6144
  ds_read_b64_tr_b16 v[34:35], v20 offset:7680
  s_add_u32 m0, s58, 0
  s_mov_b32 s42, 768
  buffer_load_dwordx4 v28, s[8:11], s42 offen lds
  v_mfma_f32_32x32x16_bf16 v[176:191], v[44:47], a[196:199], v[176:191]
  s_waitcnt lgkmcnt(4)
  v_mfma_f32_32x32x16_bf16 v[192:207], v[48:51], a[192:195], v[192:207]
  ds_read_b64_tr_b16 v[36:37], v21 offset:6144
  ds_read_b64_tr_b16 v[38:39], v21 offset:7680
  v_mfma_f32_32x32x16_bf16 v[208:223], v[48:51], a[196:199], v[208:223]
  s_mov_b32 m0, s34
  s_nop 0
  buffer_load_dwordx4 v8, s[20:23], s32 offen offset:1024 lds
  s_waitcnt lgkmcnt(4)
  v_mfma_f32_32x32x16_bf16 v[224:239], v[52:55], a[192:195], v[224:239]
  ds_read_b64_tr_b16 v[40:41], v20 offset:6272
  ds_read_b64_tr_b16 v[42:43], v20 offset:7808
  v_mfma_f32_32x32x16_bf16 v[240:255], v[52:55], a[196:199], v[240:255]
  s_waitcnt lgkmcnt(4)
  v_mfma_f32_32x32x16_bf16 v[64:79], v[32:35], a[200:203], v[64:79]
  ds_read_b64_tr_b16 v[44:45], v21 offset:6272
  ds_read_b64_tr_b16 v[46:47], v21 offset:7808
  s_add_u32 m0, s58, 0
  s_mov_b32 s42, 768
  buffer_load_dwordx4 v29, s[8:11], s42 offen offset:1024 lds
  v_mfma_f32_32x32x16_bf16 v[80:95], v[32:35], a[204:207], v[80:95]
  s_waitcnt lgkmcnt(4)
  v_mfma_f32_32x32x16_bf16 v[96:111], v[36:39], a[200:203], v[96:111]
  ds_read_b64_tr_b16 v[48:49], v20 offset:6400
  ds_read_b64_tr_b16 v[50:51], v20 offset:7936
  s_add_u32 s36, s36, 12288
  s_cmp_ge_u32 s36, 147456
  s_cselect_b32 s36, 73728, s36
  v_add_u32 v26, s36, v14
  v_add_u32 v27, s36, v15
  v_mfma_f32_32x32x16_bf16 v[112:127], v[36:39], a[204:207], v[112:127]
  s_mov_b32 m0, s34
  s_nop 0
  buffer_load_dwordx4 v9, s[20:23], s32 offen offset:2048 lds
  s_add_u32 s32, s32, 393216
  s_add_u32 s34, s34, 12288
  s_cmp_ge_u32 s34, s46
  s_cselect_b32 s39, 73728, 0
  s_sub_u32 s34, s34, s39
  s_waitcnt lgkmcnt(4)
  v_mfma_f32_32x32x16_bf16 v[128:143], v[40:43], a[200:203], v[128:143]
  ds_read_b64_tr_b16 v[52:53], v21 offset:6400
  ds_read_b64_tr_b16 v[54:55], v21 offset:7936
  v_mfma_f32_32x32x16_bf16 v[144:159], v[40:43], a[204:207], v[144:159]
  s_waitcnt lgkmcnt(4)
  v_mfma_f32_32x32x16_bf16 v[160:175], v[44:47], a[200:203], v[160:175]
  ds_read_b64_tr_b16 v[32:33], v26 offset:0
  ds_read_b64_tr_b16 v[34:35], v26 offset:1536
  s_add_u32 m0, s58, 2048
  s_mov_b32 s42, 21248
  buffer_load_dwordx4 v28, s[8:11], s42 offen lds
  v_mfma_f32_32x32x16_bf16 v[176:191], v[44:47], a[204:207], v[176:191]
  s_waitcnt lgkmcnt(4)
  v_mfma_f32_32x32x16_bf16 v[192:207], v[48:51], a[200:203], v[192:207]
  ds_read_b64_tr_b16 v[36:37], v27 offset:0
  ds_read_b64_tr_b16 v[38:39], v27 offset:1536
  v_mfma_f32_32x32x16_bf16 v[208:223], v[48:51], a[204:207], v[208:223]
  s_add_u32 m0, s58, 2048
  s_mov_b32 s42, 21248
  buffer_load_dwordx4 v29, s[8:11], s42 offen offset:1024 lds
  s_waitcnt lgkmcnt(4)
  v_mfma_f32_32x32x16_bf16 v[224:239], v[52:55], a[200:203], v[224:239]
  ds_read_b64_tr_b16 v[40:41], v26 offset:128
  ds_read_b64_tr_b16 v[42:43], v26 offset:1664
  v_mfma_f32_32x32x16_bf16 v[240:255], v[52:55], a[204:207], v[240:255]
  s_waitcnt lgkmcnt(4)
  v_mfma_f32_32x32x16_bf16 v[64:79], v[32:35], a[208:211], v[64:79]
  ds_read_b64_tr_b16 v[44:45], v27 offset:128
  ds_read_b64_tr_b16 v[46:47], v27 offset:1664
  v_mfma_f32_32x32x16_bf16 v[80:95], v[32:35], a[212:215], v[80:95]
  s_waitcnt lgkmcnt(4)
  v_mfma_f32_32x32x16_bf16 v[96:111], v[36:39], a[208:211], v[96:111]
  ds_read_b64_tr_b16 v[48:49], v26 offset:256
  ds_read_b64_tr_b16 v[50:51], v26 offset:1792
  v_mfma_f32_32x32x16_bf16 v[112:127], v[36:39], a[212:215], v[112:127]
  s_waitcnt vmcnt(23)
  s_barrier
  s_waitcnt lgkmcnt(4)
  v_mfma_f32_32x32x16_bf16 v[128:143], v[40:43], a[208:211], v[128:143]
  ds_read_b64_tr_b16 v[52:53], v27 offset:256
  ds_read_b64_tr_b16 v[54:55], v27 offset:1792
  s_mov_b32 m0, s34
  s_nop 0
  buffer_load_dwordx4 v7, s[20:23], s32 offen lds
  v_mfma_f32_32x32x16_bf16 v[144:159], v[40:43], a[212:215], v[144:159]
  s_waitcnt lgkmcnt(4)
  v_mfma_f32_32x32x16_bf16 v[160:175], v[44:47], a[208:211], v[160:175]
  ds_read_b64_tr_b16 v[32:33], v26 offset:6144
  ds_read_b64_tr_b16 v[34:35], v26 offset:7680
  s_add_u32 m0, s58, 4096
  s_mov_b32 s42, 41728
  buffer_load_dwordx4 v28, s[8:11], s42 offen lds
  v_mfma_f32_32x32x16_bf16 v[176:191], v[44:47], a[212:215], v[176:191]
  s_waitcnt lgkmcnt(4)
  v_mfma_f32_32x32x16_bf16 v[192:207], v[48:51], a[208:211], v[192:207]
  ds_read_b64_tr_b16 v[36:37], v27 offset:6144
  ds_read_b64_tr_b16 v[38:39], v27 offset:7680
  v_mfma_f32_32x32x16_bf16 v[208:223], v[48:51], a[212:215], v[208:223]
  s_mov_b32 m0, s34
  s_nop 0
  buffer_load_dwordx4 v8, s[20:23], s32 offen offset:1024 lds
  s_waitcnt lgkmcnt(4)
  v_mfma_f32_32x32x16_bf16 v[224:239], v[52:55], a[208:211], v[224:239]
  ds_read_b64_tr_b16 v[40:41], v26 offset:6272
  ds_read_b64_tr_b16 v[42:43], v26 offset:7808
  v_mfma_f32_32x32x16_bf16 v[240:255], v[52:55], a[212:215], v[240:255]
  s_waitcnt lgkmcnt(4)
  v_mfma_f32_32x32x16_bf16 v[64:79], v[32:35], a[216:219], v[64:79]
  ds_read_b64_tr_b16 v[44:45], v27 offset:6272
  ds_read_b64_tr_b16 v[46:47], v27 offset:7808
  s_add_u32 m0, s58, 4096
  s_mov_b32 s42, 41728
  buffer_load_dwordx4 v29, s[8:11], s42 offen offset:1024 lds
  s_waitcnt vmcnt(11)
  ds_read_b128 a[224:227], v60 offset:0
  ds_read_b128 a[228:231], v60 offset:4096
  ds_read_b128 a[232:235], v61 offset:0
  ds_read_b128 a[236:239], v61 offset:4096
  ds_read_b128 a[240:243], v62 offset:0
  ds_read_b128 a[244:247], v62 offset:4096
  ds_read_b128 a[248:251], v63 offset:0
  ds_read_b128 a[252:255], v63 offset:4096
  v_mfma_f32_32x32x16_bf16 v[80:95], v[32:35], a[220:223], v[80:95]
  s_waitcnt lgkmcnt(12)
  v_mfma_f32_32x32x16_bf16 v[96:111], v[36:39], a[216:219], v[96:111]
  ds_read_b64_tr_b16 v[48:49], v26 offset:6400
  ds_read_b64_tr_b16 v[50:51], v26 offset:7936
  s_add_u32 s36, s36, 12288
  s_cmp_ge_u32 s36, 147456
  s_cselect_b32 s36, 73728, s36
  v_add_u32 v20, s36, v14
  v_add_u32 v21, s36, v15
  v_mfma_f32_32x32x16_bf16 v[112:127], v[36:39], a[220:223], v[112:127]
  s_mov_b32 m0, s34
  s_nop 0
  buffer_load_dwordx4 v9, s[20:23], s32 offen offset:2048 lds
  s_add_u32 s32, s32, 393216
  s_add_u32 s34, s34, 12288
  s_cmp_ge_u32 s34, s46
  s_cselect_b32 s39, 73728, 0
  s_sub_u32 s34, s34, s39
  s_waitcnt lgkmcnt(12)
  v_mfma_f32_32x32x16_bf16 v[128:143], v[40:43], a[216:219], v[128:143]
  ds_read_b64_tr_b16 v[52:53], v27 offset:6400
  ds_read_b64_tr_b16 v[54:55], v27 offset:7936
  v_mfma_f32_32x32x16_bf16 v[144:159], v[40:43], a[220:223], v[144:159]
  s_waitcnt lgkmcnt(12)
  v_mfma_f32_32x32x16_bf16 v[160:175], v[44:47], a[216:219], v[160:175]
  ds_read_b64_tr_b16 v[32:33], v20 offset:0
  ds_read_b64_tr_b16 v[34:35], v20 offset:1536
  s_add_u32 m0, s58, 6144
  s_mov_b32 s42, 62208
  buffer_load_dwordx4 v28, s[8:11], s42 offen lds
  v_mfma_f32_32x32x16_bf16 v[176:191], v[44:47], a[220:223], v[176:191]
  s_waitcnt lgkmcnt(4)
  v_mfma_f32_32x32x16_bf16 v[192:207], v[48:51], a[216:219], v[192:207]
  ds_read_b64_tr_b16 v[36:37], v21 offset:0
  ds_read_b64_tr_b16 v[38:39], v21 offset:1536
  v_mfma_f32_32x32x16_bf16 v[208:223], v[48:51], a[220:223], v[208:223]
  s_add_u32 m0, s58, 6144
  s_mov_b32 s42, 62208
  buffer_load_dwordx4 v29, s[8:11], s42 offen offset:1024 lds
  s_waitcnt lgkmcnt(4)
  v_mfma_f32_32x32x16_bf16 v[224:239], v[52:55], a[216:219], v[224:239]
  ds_read_b64_tr_b16 v[40:41], v20 offset:128
  ds_read_b64_tr_b16 v[42:43], v20 offset:1664
  v_mfma_f32_32x32x16_bf16 v[240:255], v[52:55], a[220:223], v[240:255]
  s_waitcnt lgkmcnt(10)
  s_waitcnt lgkmcnt(4)
  v_mfma_f32_32x32x16_bf16 v[64:79], v[32:35], a[224:227], v[64:79]
  ds_read_b64_tr_b16 v[44:45], v21 offset:128
  ds_read_b64_tr_b16 v[46:47], v21 offset:1664
  v_mfma_f32_32x32x16_bf16 v[80:95], v[32:35], a[228:231], v[80:95]
  s_waitcnt lgkmcnt(4)
  v_mfma_f32_32x32x16_bf16 v[96:111], v[36:39], a[224:227], v[96:111]
  ds_read_b64_tr_b16 v[48:49], v20 offset:256
  ds_read_b64_tr_b16 v[50:51], v20 offset:1792
  v_mfma_f32_32x32x16_bf16 v[112:127], v[36:39], a[228:231], v[112:127]
  s_waitcnt vmcnt(23)
  s_barrier
  s_waitcnt lgkmcnt(4)
  v_mfma_f32_32x32x16_bf16 v[128:143], v[40:43], a[224:227], v[128:143]
  ds_read_b64_tr_b16 v[52:53], v21 offset:256
  ds_read_b64_tr_b16 v[54:55], v21 offset:1792
  s_mov_b32 m0, s34
  s_nop 0
  buffer_load_dwordx4 v7, s[20:23], s32 offen lds
  v_mfma_f32_32x32x16_bf16 v[144:159], v[40:43], a[228:231], v[144:159]
  s_waitcnt lgkmcnt(4)
  v_mfma_f32_32x32x16_bf16 v[160:175], v[44:47], a[224:227], v[160:175]
  ds_read_b64_tr_b16 v[32:33], v20 offset:6144
  ds_read_b64_tr_b16 v[34:35], v20 offset:7680
  s_add_u32 m0, s59, 0
  s_mov_b32 s42, 896
  buffer_load_dwordx4 v28, s[8:11], s42 offen lds
  v_mfma_f32_32x32x16_bf16 v[176:191], v[44:47], a[228:231], v[176:191]
  s_waitcnt lgkmcnt(4)
  v_mfma_f32_32x32x16_bf16 v[192:207], v[48:51], a[224:227], v[192:207]
  ds_read_b64_tr_b16 v[36:37], v21 offset:6144
  ds_read_b64_tr_b16 v[38:39], v21 offset:7680
  v_mfma_f32_32x32x16_bf16 v[208:223], v[48:51], a[228:231], v[208:223]
  s_mov_b32 m0, s34
  s_nop 0
  buffer_load_dwordx4 v8, s[20:23], s32 offen offset:1024 lds
  s_waitcnt lgkmcnt(4)
  v_mfma_f32_32x32x16_bf16 v[224:239], v[52:55], a[224:227], v[224:239]
  ds_read_b64_tr_b16 v[40:41], v20 offset:6272
  ds_read_b64_tr_b16 v[42:43], v20 offset:7808
  v_mfma_f32_32x32x16_bf16 v[240:255], v[52:55], a[228:231], v[240:255]
  s_waitcnt lgkmcnt(4)
  v_mfma_f32_32x32x16_bf16 v[64:79], v[32:35], a[232:235], v[64:79]
  ds_read_b64_tr_b16 v[44:45], v21 offset:6272
  ds_read_b64_tr_b16 v[46:47], v21 offset:7808
  s_add_u32 m0, s59, 0
  s_mov_b32 s42, 896
  buffer_load_dwordx4 v29, s[8:11], s42 offen offset:1024 lds
  v_mfma_f32_32x32x16_bf16 v[80:95], v[32:35], a[236:239], v[80:95]
  s_waitcnt lgkmcnt(4)
  v_mfma_f32_32x32x16_bf16 v[96:111], v[36:39], a[232:235], v[96:111]
  ds_read_b64_tr_b16 v[48:49], v20 offset:6400
  ds_read_b64_tr_b16 v[50:51], v20 offset:7936
  s_add_u32 s36, s36, 12288
  s_cmp_ge_u32 s36, 147456
  s_cselect_b32 s36, 73728, s36
  v_add_u32 v26, s36, v14
  v_add_u32 v27, s36, v15
  v_mfma_f32_32x32x16_bf16 v[112:127], v[36:39], a[236:239], v[112:127]
  s_mov_b32 m0, s34
  s_nop 0
  buffer_load_dwordx4 v9, s[20:23], s32 offen offset:2048 lds
  s_add_u32 s32, s32, 393216
  s_add_u32 s34, s34, 12288
  s_cmp_ge_u32 s34, s46
  s_cselect_b32 s39, 73728, 0
  s_sub_u32 s34, s34, s39
  s_waitcnt lgkmcnt(4)
  v_mfma_f32_32x32x16_bf16 v[128:143], v[40:43], a[232:235], v[128:143]
  ds_read_b64_tr_b16 v[52:53], v21 offset:6400
  ds_read_b64_tr_b16 v[54:55], v21 offset:7936
  v_mfma_f32_32x32x16_bf16 v[144:159], v[40:43], a[236:239], v[144:159]
  s_waitcnt lgkmcnt(4)
  v_mfma_f32_32x32x16_bf16 v[160:175], v[44:47], a[232:235], v[160:175]
  ds_read_b64_tr_b16 v[32:33], v26 offset:0
  ds_read_b64_tr_b16 v[34:35], v26 offset:1536
  s_add_u32 m0, s59, 2048
  s_mov_b32 s42, 21376
  buffer_load_dwordx4 v28, s[8:11], s42 offen lds
  v_mfma_f32_32x32x16_bf16 v[176:191], v[44:47], a[236:239], v[176:191]
  s_waitcnt lgkmcnt(4)
  v_mfma_f32_32x32x16_bf16 v[192:207], v[48:51], a[232:235], v[192:207]
  ds_read_b64_tr_b16 v[36:37], v27 offset:0
  ds_read_b64_tr_b16 v[38:39], v27 offset:1536
  v_mfma_f32_32x32x16_bf16 v[208:223], v[48:51], a[236:239], v[208:223]
  s_add_u32 m0, s59, 2048
  s_mov_b32 s42, 21376
  buffer_load_dwordx4 v29, s[8:11], s42 offen offset:1024 lds
  s_waitcnt lgkmcnt(4)
  v_mfma_f32_32x32x16_bf16 v[224:239], v[52:55], a[232:235], v[224:239]
  ds_read_b64_tr_b16 v[40:41], v26 offset:128
  ds_read_b64_tr_b16 v[42:43], v26 offset:1664
  v_mfma_f32_32x32x16_bf16 v[240:255], v[52:55], a[236:239], v[240:255]
  s_waitcnt lgkmcnt(4)
  v_mfma_f32_32x32x16_bf16 v[64:79], v[32:35], a[240:243], v[64:79]
  ds_read_b64_tr_b16 v[44:45], v27 offset:128
  ds_read_b64_tr_b16 v[46:47], v27 offset:1664
  v_mfma_f32_32x32x16_bf16 v[80:95], v[32:35], a[244:247], v[80:95]
  s_waitcnt lgkmcnt(4)
  v_mfma_f32_32x32x16_bf16 v[96:111], v[36:39], a[240:243], v[96:111]
  ds_read_b64_tr_b16 v[48:49], v26 offset:256
  ds_read_b64_tr_b16 v[50:51], v26 offset:1792
  v_mfma_f32_32x32x16_bf16 v[112:127], v[36:39], a[244:247], v[112:127]
  s_waitcnt vmcnt(23)
  s_barrier
  s_waitcnt lgkmcnt(4)
  v_mfma_f32_32x32x16_bf16 v[128:143], v[40:43], a[240:243], v[128:143]
  ds_read_b64_tr_b16 v[52:53], v27 offset:256
  ds_read_b64_tr_b16 v[54:55], v27 offset:1792
  s_mov_b32 m0, s34
  s_nop 0
  buffer_load_dwordx4 v7, s[20:23], s32 offen lds
  v_mfma_f32_32x32x16_bf16 v[144:159], v[40:43], a[244:247], v[144:159]
  s_waitcnt lgkmcnt(4)
  v_mfma_f32_32x32x16_bf16 v[160:175], v[44:47], a[240:243], v[160:175]
  ds_read_b64_tr_b16 v[32:33], v26 offset:6144
  ds_read_b64_tr_b16 v[34:35], v26 offset:7680
  s_add_u32 m0, s59, 4096
  s_mov_b32 s42, 41856
  buffer_load_dwordx4 v28, s[8:11], s42 offen lds
  v_mfma_f32_32x32x16_bf16 v[176:191], v[44:47], a[244:247], v[176:191]
  s_waitcnt lgkmcnt(4)
  v_mfma_f32_32x32x16_bf16 v[192:207], v[48:51], a[240:243], v[192:207]
  ds_read_b64_tr_b16 v[36:37], v27 offset:6144
  ds_read_b64_tr_b16 v[38:39], v27 offset:7680
  v_mfma_f32_32x32x16_bf16 v[208:223], v[48:51], a[244:247], v[208:223]
  s_mov_b32 m0, s34
  s_nop 0
  buffer_load_dwordx4 v8, s[20:23], s32 offen offset:1024 lds
  s_waitcnt lgkmcnt(4)
  v_mfma_f32_32x32x16_bf16 v[224:239], v[52:55], a[240:243], v[224:239]
  ds_read_b64_tr_b16 v[40:41], v26 offset:6272
  ds_read_b64_tr_b16 v[42:43], v26 offset:7808
  v_mfma_f32_32x32x16_bf16 v[240:255], v[52:55], a[244:247], v[240:255]
  s_waitcnt lgkmcnt(4)
  v_mfma_f32_32x32x16_bf16 v[64:79], v[32:35], a[248:251], v[64:79]
  ds_read_b64_tr_b16 v[44:45], v27 offset:6272
  ds_read_b64_tr_b16 v[46:47], v27 offset:7808
  s_add_u32 m0, s59, 4096
  s_mov_b32 s42, 41856
  buffer_load_dwordx4 v29, s[8:11], s42 offen offset:1024 lds
  s_waitcnt vmcnt(11)
  ds_read_b128 a[192:195], v56 offset:0
  ds_read_b128 a[196:199], v56 offset:4096
  ds_read_b128 a[200:203], v57 offset:0
  ds_read_b128 a[204:207], v57 offset:4096
  ds_read_b128 a[208:211], v58 offset:0
  ds_read_b128 a[212:215], v58 offset:4096
  ds_read_b128 a[216:219], v59 offset:0
  ds_read_b128 a[220:223], v59 offset:4096
  v_mfma_f32_32x32x16_bf16 v[80:95], v[32:35], a[252:255], v[80:95]
  s_waitcnt lgkmcnt(12)
  v_mfma_f32_32x32x16_bf16 v[96:111], v[36:39], a[248:251], v[96:111]
  ds_read_b64_tr_b16 v[48:49], v26 offset:6400
  ds_read_b64_tr_b16 v[50:51], v26 offset:7936
  s_add_u32 s36, s36, 12288
  s_cmp_ge_u32 s36, 147456
  s_cselect_b32 s36, 73728, s36
  v_add_u32 v20, s36, v14
  v_add_u32 v21, s36, v15
  v_mfma_f32_32x32x16_bf16 v[112:127], v[36:39], a[252:255], v[112:127]
  s_mov_b32 m0, s34
  s_nop 0
  buffer_load_dwordx4 v9, s[20:23], s32 offen offset:2048 lds
  s_add_u32 s32, s32, 393216
  s_add_u32 s34, s34, 12288
  s_cmp_ge_u32 s34, s46
  s_cselect_b32 s39, 73728, 0
  s_sub_u32 s34, s34, s39
  s_waitcnt lgkmcnt(12)
  v_mfma_f32_32x32x16_bf16 v[128:143], v[40:43], a[248:251], v[128:143]
  ds_read_b64_tr_b16 v[52:53], v27 offset:6400
  ds_read_b64_tr_b16 v[54:55], v27 offset:7936
  v_mfma_f32_32x32x16_bf16 v[144:159], v[40:43], a[252:255], v[144:159]
  s_waitcnt lgkmcnt(12)
  v_mfma_f32_32x32x16_bf16 v[160:175], v[44:47], a[248:251], v[160:175]
  ds_read_b64_tr_b16 v[32:33], v20 offset:0
  ds_read_b64_tr_b16 v[34:35], v20 offset:1536
  s_add_u32 m0, s59, 6144
  s_mov_b32 s42, 62336
  buffer_load_dwordx4 v28, s[8:11], s42 offen lds
  v_mfma_f32_32x32x16_bf16 v[176:191], v[44:47], a[252:255], v[176:191]
  s_waitcnt lgkmcnt(4)
  v_mfma_f32_32x32x16_bf16 v[192:207], v[48:51], a[248:251], v[192:207]
  ds_read_b64_tr_b16 v[36:37], v21 offset:0
  ds_read_b64_tr_b16 v[38:39], v21 offset:1536
  v_mfma_f32_32x32x16_bf16 v[208:223], v[48:51], a[252:255], v[208:223]
  s_add_u32 m0, s59, 6144
  s_mov_b32 s42, 62336
  buffer_load_dwordx4 v29, s[8:11], s42 offen offset:1024 lds
  s_waitcnt lgkmcnt(4)
  v_mfma_f32_32x32x16_bf16 v[224:239], v[52:55], a[248:251], v[224:239]
  ds_read_b64_tr_b16 v[40:41], v20 offset:128
  ds_read_b64_tr_b16 v[42:43], v20 offset:1664
  v_mfma_f32_32x32x16_bf16 v[240:255], v[52:55], a[252:255], v[240:255]
  s_waitcnt lgkmcnt(10)
  s_waitcnt lgkmcnt(4)
  v_mfma_f32_32x32x16_bf16 v[64:79], v[32:35], a[192:195], v[64:79]
  ds_read_b64_tr_b16 v[44:45], v21 offset:128
  ds_read_b64_tr_b16 v[46:47], v21 offset:1664
  v_mfma_f32_32x32x16_bf16 v[80:95], v[32:35], a[196:199], v[80:95]
  s_waitcnt lgkmcnt(4)
  v_mfma_f32_32x32x16_bf16 v[96:111], v[36:39], a[192:195], v[96:111]
  ds_read_b64_tr_b16 v[48:49], v20 offset:256
  ds_read_b64_tr_b16 v[50:51], v20 offset:1792
  v_mfma_f32_32x32x16_bf16 v[112:127], v[36:39], a[196:199], v[112:127]
  s_waitcnt vmcnt(23)
  s_barrier
  s_waitcnt lgkmcnt(4)
  v_mfma_f32_32x32x16_bf16 v[128:143], v[40:43], a[192:195], v[128:143]
  ds_read_b64_tr_b16 v[52:53], v21 offset:256
  ds_read_b64_tr_b16 v[54:55], v21 offset:1792
  s_mov_b32 m0, s33
  s_nop 0
  buffer_load_dwordx4 v1, s[12:15], s31 offen nt lds
  v_mfma_f32_32x32x16_bf16 v[144:159], v[40:43], a[196:199], v[144:159]
  buffer_load_dwordx4 v2, s[12:15], s31 offen offset:1024 nt lds
  s_waitcnt lgkmcnt(4)
  v_mfma_f32_32x32x16_bf16 v[160:175], v[44:47], a[192:195], v[160:175]
  ds_read_b64_tr_b16 v[32:33], v20 offset:6144
  ds_read_b64_tr_b16 v[34:35], v20 offset:7680
  v_mfma_f32_32x32x16_bf16 v[176:191], v[44:47], a[196:199], v[176:191]
  buffer_load_dwordx4 v3, s[12:15], s31 offen offset:2048 nt lds
  s_waitcnt lgkmcnt(4)
  v_mfma_f32_32x32x16_bf16 v[192:207], v[48:51], a[192:195], v[192:207]
  ds_read_b64_tr_b16 v[36:37], v21 offset:6144
  ds_read_b64_tr_b16 v[38:39], v21 offset:7680
  v_mfma_f32_32x32x16_bf16 v[208:223], v[48:51], a[196:199], v[208:223]
  s_add_u32 s31, s31, 12288
  s_add_u32 s33, s33, 12288
  s_cmp_ge_u32 s33, s45
  s_cselect_b32 s39, 73728, 0
  s_sub_u32 s33, s33, s39
  s_waitcnt lgkmcnt(4)
  v_mfma_f32_32x32x16_bf16 v[224:239], v[52:55], a[192:195], v[224:239]
  ds_read_b64_tr_b16 v[40:41], v20 offset:6272
  ds_read_b64_tr_b16 v[42:43], v20 offset:7808
  v_mfma_f32_32x32x16_bf16 v[240:255], v[52:55], a[196:199], v[240:255]
  s_mov_b32 m0, s34
  s_nop 0
  buffer_load_dwordx4 v7, s[20:23], s32 offen lds
  s_waitcnt lgkmcnt(4)
  v_mfma_f32_32x32x16_bf16 v[64:79], v[32:35], a[200:203], v[64:79]
  ds_read_b64_tr_b16 v[44:45], v21 offset:6272
  ds_read_b64_tr_b16 v[46:47], v21 offset:7808
  v_mfma_f32_32x32x16_bf16 v[80:95], v[32:35], a[204:207], v[80:95]
  s_add_u32 m0, s58, 0
  s_mov_b32 s42, 1024
  buffer_load_dwordx4 v28, s[8:11], s42 offen lds
  s_waitcnt lgkmcnt(4)
  v_mfma_f32_32x32x16_bf16 v[96:111], v[36:39], a[200:203], v[96:111]
  ds_read_b64_tr_b16 v[48:49], v20 offset:6400
  ds_read_b64_tr_b16 v[50:51], v20 offset:7936
  s_mov_b32 m0, s34
  s_nop 0
  buffer_load_dwordx4 v8, s[20:23], s32 offen offset:1024 lds
  s_add_u32 s36, s36, 12288
  s_cmp_ge_u32 s36, 147456
  s_cselect_b32 s36, 73728, s36
  v_add_u32 v26, s36, v14
  v_add_u32 v27, s36, v15
  v_mfma_f32_32x32x16_bf16 v[112:127], v[36:39], a[204:207], v[112:127]
  s_waitcnt lgkmcnt(4)
  v_mfma_f32_32x32x16_bf16 v[128:143], v[40:43], a[200:203], v[128:143]
  ds_read_b64_tr_b16 v[52:53], v21 offset:6400
  ds_read_b64_tr_b16 v[54:55], v21 offset:7936
  s_add_u32 m0, s58, 0
  s_mov_b32 s42, 1024
  buffer_load_dwordx4 v29, s[8:11], s42 offen offset:1024 lds
  v_mfma_f32_32x32x16_bf16 v[144:159], v[40:43], a[204:207], v[144:159]
  s_waitcnt lgkmcnt(4)
  v_mfma_f32_32x32x16_bf16 v[160:175], v[44:47], a[200:203], v[160:175]
  ds_read_b64_tr_b16 v[32:33], v26 offset:0
  ds_read_b64_tr_b16 v[34:35], v26 offset:1536
  s_mov_b32 m0, s34
  s_nop 0
  buffer_load_dwordx4 v9, s[20:23], s32 offen offset:2048 lds
  s_add_u32 s32, s32, 393216
  s_add_u32 s34, s34, 12288
  s_cmp_ge_u32 s34, s46
  s_cselect_b32 s39, 73728, 0
  s_sub_u32 s34, s34, s39
  v_mfma_f32_32x32x16_bf16 v[176:191], v[44:47], a[204:207], v[176:191]
  s_waitcnt lgkmcnt(4)
  v_mfma_f32_32x32x16_bf16 v[192:207], v[48:51], a[200:203], v[192:207]
  ds_read_b64_tr_b16 v[36:37], v27 offset:0
  ds_read_b64_tr_b16 v[38:39], v27 offset:1536
  s_add_u32 m0, s58, 2048
  s_mov_b32 s42, 21504
  buffer_load_dwordx4 v28, s[8:11], s42 offen lds
  v_mfma_f32_32x32x16_bf16 v[208:223], v[48:51], a[204:207], v[208:223]
  s_waitcnt lgkmcnt(4)
  v_mfma_f32_32x32x16_bf16 v[224:239], v[52:55], a[200:203], v[224:239]
  ds_read_b64_tr_b16 v[40:41], v26 offset:128
  ds_read_b64_tr_b16 v[42:43], v26 offset:1664
  s_add_u32 m0, s58, 2048
  s_mov_b32 s42, 21504
  buffer_load_dwordx4 v29, s[8:11], s42 offen offset:1024 lds
  v_mfma_f32_32x32x16_bf16 v[240:255], v[52:55], a[204:207], v[240:255]
  s_waitcnt lgkmcnt(4)
  v_mfma_f32_32x32x16_bf16 v[64:79], v[32:35], a[208:211], v[64:79]
  ds_read_b64_tr_b16 v[44:45], v27 offset:128
  ds_read_b64_tr_b16 v[46:47], v27 offset:1664
  v_mfma_f32_32x32x16_bf16 v[80:95], v[32:35], a[212:215], v[80:95]
  s_waitcnt lgkmcnt(4)
  v_mfma_f32_32x32x16_bf16 v[96:111], v[36:39], a[208:211], v[96:111]
  ds_read_b64_tr_b16 v[48:49], v26 offset:256
  ds_read_b64_tr_b16 v[50:51], v26 offset:1792
  v_mfma_f32_32x32x16_bf16 v[112:127], v[36:39], a[212:215], v[112:127]
  s_waitcnt vmcnt(26)
  s_barrier
  s_waitcnt lgkmcnt(4)
  v_mfma_f32_32x32x16_bf16 v[128:143], v[40:43], a[208:211], v[128:143]
  ds_read_b64_tr_b16 v[52:53], v27 offset:256
  ds_read_b64_tr_b16 v[54:55], v27 offset:1792
  s_mov_b32 m0, s33
  s_nop 0
  buffer_load_dwordx4 v1, s[12:15], s31 offen nt lds
  v_mfma_f32_32x32x16_bf16 v[144:159], v[40:43], a[212:215], v[144:159]
  buffer_load_dwordx4 v2, s[12:15], s31 offen offset:1024 nt lds
  s_waitcnt lgkmcnt(4)
  v_mfma_f32_32x32x16_bf16 v[160:175], v[44:47], a[208:211], v[160:175]
  ds_read_b64_tr_b16 v[32:33], v26 offset:6144
  ds_read_b64_tr_b16 v[34:35], v26 offset:7680
  v_mfma_f32_32x32x16_bf16 v[176:191], v[44:47], a[212:215], v[176:191]
  buffer_load_dwordx4 v3, s[12:15], s31 offen offset:2048 nt lds
  s_waitcnt lgkmcnt(4)
  v_mfma_f32_32x32x16_bf16 v[192:207], v[48:51], a[208:211], v[192:207]
  ds_read_b64_tr_b16 v[36:37], v27 offset:6144
  ds_read_b64_tr_b16 v[38:39], v27 offset:7680
  v_mfma_f32_32x32x16_bf16 v[208:223], v[48:51], a[212:215], v[208:223]
  s_add_u32 s31, s31, 12288
  s_add_u32 s33, s33, 12288
  s_cmp_ge_u32 s33, s45
  s_cselect_b32 s39, 73728, 0
  s_sub_u32 s33, s33, s39
  s_waitcnt lgkmcnt(4)
  v_mfma_f32_32x32x16_bf16 v[224:239], v[52:55], a[208:211], v[224:239]
  ds_read_b64_tr_b16 v[40:41], v26 offset:6272
  ds_read_b64_tr_b16 v[42:43], v26 offset:7808
  v_mfma_f32_32x32x16_bf16 v[240:255], v[52:55], a[212:215], v[240:255]
  s_mov_b32 m0, s34
  s_nop 0
  buffer_load_dwordx4 v7, s[20:23], s32 offen lds
  s_waitcnt lgkmcnt(4)
  v_mfma_f32_32x32x16_bf16 v[64:79], v[32:35], a[216:219], v[64:79]
  ds_read_b64_tr_b16 v[44:45], v27 offset:6272
  ds_read_b64_tr_b16 v[46:47], v27 offset:7808
  s_waitcnt vmcnt(14)
  ds_read_b128 a[224:227], v60 offset:0
  ds_read_b128 a[228:231], v60 offset:4096
  ds_read_b128 a[232:235], v61 offset:0
  ds_read_b128 a[236:239], v61 offset:4096
  ds_read_b128 a[240:243], v62 offset:0
  ds_read_b128 a[244:247], v62 offset:4096
  ds_read_b128 a[248:251], v63 offset:0
  ds_read_b128 a[252:255], v63 offset:4096
  v_mfma_f32_32x32x16_bf16 v[80:95], v[32:35], a[220:223], v[80:95]
  s_add_u32 m0, s58, 4096
  s_mov_b32 s42, 41984
  buffer_load_dwordx4 v28, s[8:11], s42 offen lds
  s_waitcnt lgkmcnt(12)
  v_mfma_f32_32x32x16_bf16 v[96:111], v[36:39], a[216:219], v[96:111]
  ds_read_b64_tr_b16 v[48:49], v26 offset:6400
  ds_read_b64_tr_b16 v[50:51], v26 offset:7936
  s_mov_b32 m0, s34
  s_nop 0
  buffer_load_dwordx4 v8, s[20:23], s32 offen offset:1024 lds
  s_add_u32 s36, s36, 12288
  s_cmp_ge_u32 s36, 147456
  s_cselect_b32 s36, 73728, s36
  v_add_u32 v20, s36, v14
  v_add_u32 v21, s36, v15
  v_mfma_f32_32x32x16_bf16 v[112:127], v[36:39], a[220:223], v[112:127]
  s_waitcnt lgkmcnt(12)
  v_mfma_f32_32x32x16_bf16 v[128:143], v[40:43], a[216:219], v[128:143]
  ds_read_b64_tr_b16 v[52:53], v27 offset:6400
  ds_read_b64_tr_b16 v[54:55], v27 offset:7936
  s_add_u32 m0, s58, 4096
  s_mov_b32 s42, 41984
  buffer_load_dwordx4 v29, s[8:11], s42 offen offset:1024 lds
  v_mfma_f32_32x32x16_bf16 v[144:159], v[40:43], a[220:223], v[144:159]
  s_waitcnt lgkmcnt(12)
  v_mfma_f32_32x32x16_bf16 v[160:175], v[44:47], a[216:219], v[160:175]
  ds_read_b64_tr_b16 v[32:33], v20 offset:0
  ds_read_b64_tr_b16 v[34:35], v20 offset:1536
  s_mov_b32 m0, s34
  s_nop 0
  buffer_load_dwordx4 v9, s[20:23], s32 offen offset:2048 lds
  s_add_u32 s32, s32, 393216
  s_add_u32 s34, s34, 12288
  s_cmp_ge_u32 s34, s46
  s_cselect_b32 s39, 73728, 0
  s_sub_u32 s34, s34, s39
  v_mfma_f32_32x32x16_bf16 v[176:191], v[44:47], a[220:223], v[176:191]
  s_waitcnt lgkmcnt(4)
  v_mfma_f32_32x32x16_bf16 v[192:207], v[48:51], a[216:219], v[192:207]
  ds_read_b64_tr_b16 v[36:37], v21 offset:0
  ds_read_b64_tr_b16 v[38:39], v21 offset:1536
  s_add_u32 m0, s58, 6144
  s_mov_b32 s42, 62464
  buffer_load_dwordx4 v28, s[8:11], s42 offen lds
  v_mfma_f32_32x32x16_bf16 v[208:223], v[48:51], a[220:223], v[208:223]
  s_waitcnt lgkmcnt(4)
  v_mfma_f32_32x32x16_bf16 v[224:239], v[52:55], a[216:219], v[224:239]
  ds_read_b64_tr_b16 v[40:41], v20 offset:128
  ds_read_b64_tr_b16 v[42:43], v20 offset:1664
  s_add_u32 m0, s58, 6144
  s_mov_b32 s42, 62464
  buffer_load_dwordx4 v29, s[8:11], s42 offen offset:1024 lds
  v_mfma_f32_32x32x16_bf16 v[240:255], v[52:55], a[220:223], v[240:255]
  s_waitcnt lgkmcnt(10)
  s_waitcnt lgkmcnt(4)
  v_mfma_f32_32x32x16_bf16 v[64:79], v[32:35], a[224:227], v[64:79]
  ds_read_b64_tr_b16 v[44:45], v21 offset:128
  ds_read_b64_tr_b16 v[46:47], v21 offset:1664
  v_mfma_f32_32x32x16_bf16 v[80:95], v[32:35], a[228:231], v[80:95]
  s_waitcnt lgkmcnt(4)
  v_mfma_f32_32x32x16_bf16 v[96:111], v[36:39], a[224:227], v[96:111]
  ds_read_b64_tr_b16 v[48:49], v20 offset:256
  ds_read_b64_tr_b16 v[50:51], v20 offset:1792
  v_mfma_f32_32x32x16_bf16 v[112:127], v[36:39], a[228:231], v[112:127]
  s_waitcnt vmcnt(29)
  s_barrier
  s_waitcnt lgkmcnt(4)
  v_mfma_f32_32x32x16_bf16 v[128:143], v[40:43], a[224:227], v[128:143]
  ds_read_b64_tr_b16 v[52:53], v21 offset:256
  ds_read_b64_tr_b16 v[54:55], v21 offset:1792
  s_mov_b32 m0, s34
  s_nop 0
  buffer_load_dwordx4 v7, s[20:23], s32 offen lds
  v_mfma_f32_32x32x16_bf16 v[144:159], v[40:43], a[228:231], v[144:159]
  s_waitcnt lgkmcnt(4)
  v_mfma_f32_32x32x16_bf16 v[160:175], v[44:47], a[224:227], v[160:175]
  ds_read_b64_tr_b16 v[32:33], v20 offset:6144
  ds_read_b64_tr_b16 v[34:35], v20 offset:7680
  s_add_u32 m0, s59, 0
  s_mov_b32 s42, 1152
  buffer_load_dwordx4 v28, s[8:11], s42 offen lds
  v_mfma_f32_32x32x16_bf16 v[176:191], v[44:47], a[228:231], v[176:191]
  s_waitcnt lgkmcnt(4)
  v_mfma_f32_32x32x16_bf16 v[192:207], v[48:51], a[224:227], v[192:207]
  ds_read_b64_tr_b16 v[36:37], v21 offset:6144
  ds_read_b64_tr_b16 v[38:39], v21 offset:7680
  v_mfma_f32_32x32x16_bf16 v[208:223], v[48:51], a[228:231], v[208:223]
  s_mov_b32 m0, s34
  s_nop 0
  buffer_load_dwordx4 v8, s[20:23], s32 offen offset:1024 lds
  s_waitcnt lgkmcnt(4)
  v_mfma_f32_32x32x16_bf16 v[224:239], v[52:55], a[224:227], v[224:239]
  ds_read_b64_tr_b16 v[40:41], v20 offset:6272
  ds_read_b64_tr_b16 v[42:43], v20 offset:7808
  v_mfma_f32_32x32x16_bf16 v[240:255], v[52:55], a[228:231], v[240:255]
  s_waitcnt lgkmcnt(4)
  v_mfma_f32_32x32x16_bf16 v[64:79], v[32:35], a[232:235], v[64:79]
  ds_read_b64_tr_b16 v[44:45], v21 offset:6272
  ds_read_b64_tr_b16 v[46:47], v21 offset:7808
  s_add_u32 m0, s59, 0
  s_mov_b32 s42, 1152
  buffer_load_dwordx4 v29, s[8:11], s42 offen offset:1024 lds
  v_mfma_f32_32x32x16_bf16 v[80:95], v[32:35], a[236:239], v[80:95]
  s_waitcnt lgkmcnt(4)
  v_mfma_f32_32x32x16_bf16 v[96:111], v[36:39], a[232:235], v[96:111]
  ds_read_b64_tr_b16 v[48:49], v20 offset:6400
  ds_read_b64_tr_b16 v[50:51], v20 offset:7936
  s_add_u32 s36, s36, 12288
  s_cmp_ge_u32 s36, 147456
  s_cselect_b32 s36, 73728, s36
  v_add_u32 v26, s36, v14
  v_add_u32 v27, s36, v15
  v_mfma_f32_32x32x16_bf16 v[112:127], v[36:39], a[236:239], v[112:127]
  s_mov_b32 m0, s34
  s_nop 0
  buffer_load_dwordx4 v9, s[20:23], s32 offen offset:2048 lds
  s_add_u32 s32, s32, 0
  s_add_u32 s34, s34, 12288
  s_cmp_ge_u32 s34, s46
  s_cselect_b32 s39, 73728, 0
  s_sub_u32 s34, s34, s39
  s_mov_b32 s32, 0
  s_waitcnt lgkmcnt(4)
  v_mfma_f32_32x32x16_bf16 v[128:143], v[40:43], a[232:235], v[128:143]
  ds_read_b64_tr_b16 v[52:53], v21 offset:6400
  ds_read_b64_tr_b16 v[54:55], v21 offset:7936
  v_mfma_f32_32x32x16_bf16 v[144:159], v[40:43], a[236:239], v[144:159]
  s_waitcnt lgkmcnt(4)
  v_mfma_f32_32x32x16_bf16 v[160:175], v[44:47], a[232:235], v[160:175]
  ds_read_b64_tr_b16 v[32:33], v26 offset:0
  ds_read_b64_tr_b16 v[34:35], v26 offset:1536
  s_add_u32 m0, s59, 2048
  s_mov_b32 s42, 21632
  buffer_load_dwordx4 v28, s[8:11], s42 offen lds
  v_mfma_f32_32x32x16_bf16 v[176:191], v[44:47], a[236:239], v[176:191]
  s_waitcnt lgkmcnt(4)
  v_mfma_f32_32x32x16_bf16 v[192:207], v[48:51], a[232:235], v[192:207]
  ds_read_b64_tr_b16 v[36:37], v27 offset:0
  ds_read_b64_tr_b16 v[38:39], v27 offset:1536
  v_mfma_f32_32x32x16_bf16 v[208:223], v[48:51], a[236:239], v[208:223]
  s_add_u32 m0, s59, 2048
  s_mov_b32 s42, 21632
  buffer_load_dwordx4 v29, s[8:11], s42 offen offset:1024 lds
  s_waitcnt lgkmcnt(4)
  v_mfma_f32_32x32x16_bf16 v[224:239], v[52:55], a[232:235], v[224:239]
  ds_read_b64_tr_b16 v[40:41], v26 offset:128
  ds_read_b64_tr_b16 v[42:43], v26 offset:1664
  v_mfma_f32_32x32x16_bf16 v[240:255], v[52:55], a[236:239], v[240:255]
  s_waitcnt lgkmcnt(4)
  v_mfma_f32_32x32x16_bf16 v[64:79], v[32:35], a[240:243], v[64:79]
  ds_read_b64_tr_b16 v[44:45], v27 offset:128
  ds_read_b64_tr_b16 v[46:47], v27 offset:1664
  v_mfma_f32_32x32x16_bf16 v[80:95], v[32:35], a[244:247], v[80:95]
  s_waitcnt lgkmcnt(4)
  v_mfma_f32_32x32x16_bf16 v[96:111], v[36:39], a[240:243], v[96:111]
  ds_read_b64_tr_b16 v[48:49], v26 offset:256
  ds_read_b64_tr_b16 v[50:51], v26 offset:1792
  v_mfma_f32_32x32x16_bf16 v[112:127], v[36:39], a[244:247], v[112:127]
  s_waitcnt vmcnt(29)
  s_barrier
  s_waitcnt lgkmcnt(4)
  v_mfma_f32_32x32x16_bf16 v[128:143], v[40:43], a[240:243], v[128:143]
  ds_read_b64_tr_b16 v[52:53], v27 offset:256
  ds_read_b64_tr_b16 v[54:55], v27 offset:1792
  s_mov_b32 m0, s34
  s_nop 0
  buffer_load_dwordx4 v4, s[16:19], s32 offen nt lds
  v_mfma_f32_32x32x16_bf16 v[144:159], v[40:43], a[244:247], v[144:159]
  s_waitcnt lgkmcnt(4)
  v_mfma_f32_32x32x16_bf16 v[160:175], v[44:47], a[240:243], v[160:175]
  ds_read_b64_tr_b16 v[32:33], v26 offset:6144
  ds_read_b64_tr_b16 v[34:35], v26 offset:7680
  s_add_u32 m0, s59, 4096
  s_mov_b32 s42, 42112
  buffer_load_dwordx4 v28, s[8:11], s42 offen lds
  v_mfma_f32_32x32x16_bf16 v[176:191], v[44:47], a[244:247], v[176:191]
  s_waitcnt lgkmcnt(4)
  v_mfma_f32_32x32x16_bf16 v[192:207], v[48:51], a[240:243], v[192:207]
  ds_read_b64_tr_b16 v[36:37], v27 offset:6144
  ds_read_b64_tr_b16 v[38:39], v27 offset:7680
  v_mfma_f32_32x32x16_bf16 v[208:223], v[48:51], a[244:247], v[208:223]
  s_mov_b32 m0, s34
  s_nop 0
  buffer_load_dwordx4 v5, s[16:19], s32 offen offset:1024 nt lds
  s_waitcnt lgkmcnt(4)
  v_mfma_f32_32x32x16_bf16 v[224:239], v[52:55], a[240:243], v[224:239]
  ds_read_b64_tr_b16 v[40:41], v26 offset:6272
  ds_read_b64_tr_b16 v[42:43], v26 offset:7808
  v_mfma_f32_32x32x16_bf16 v[240:255], v[52:55], a[244:247], v[240:255]
  s_waitcnt lgkmcnt(4)
  v_mfma_f32_32x32x16_bf16 v[64:79], v[32:35], a[248:251], v[64:79]
  ds_read_b64_tr_b16 v[44:45], v27 offset:6272
  ds_read_b64_tr_b16 v[46:47], v27 offset:7808
  s_add_u32 m0, s59, 4096
  s_mov_b32 s42, 42112
  buffer_load_dwordx4 v29, s[8:11], s42 offen offset:1024 lds
  s_waitcnt vmcnt(11)
  ds_read_b128 a[192:195], v56 offset:0
  ds_read_b128 a[196:199], v56 offset:4096
  ds_read_b128 a[200:203], v57 offset:0
  ds_read_b128 a[204:207], v57 offset:4096
  ds_read_b128 a[208:211], v58 offset:0
  ds_read_b128 a[212:215], v58 offset:4096
  ds_read_b128 a[216:219], v59 offset:0
  ds_read_b128 a[220:223], v59 offset:4096
  v_mfma_f32_32x32x16_bf16 v[80:95], v[32:35], a[252:255], v[80:95]
  s_waitcnt lgkmcnt(12)
  v_mfma_f32_32x32x16_bf16 v[96:111], v[36:39], a[248:251], v[96:111]
  ds_read_b64_tr_b16 v[48:49], v26 offset:6400
  ds_read_b64_tr_b16 v[50:51], v26 offset:7936
  s_add_u32 s36, s36, 12288
  s_cmp_ge_u32 s36, 147456
  s_cselect_b32 s36, 73728, s36
  v_add_u32 v20, s36, v14
  v_add_u32 v21, s36, v15
  v_mfma_f32_32x32x16_bf16 v[112:127], v[36:39], a[252:255], v[112:127]
  s_mov_b32 m0, s34
  s_nop 0
  buffer_load_dwordx4 v6, s[16:19], s32 offen offset:2048 nt lds
  s_add_u32 s32, s32, 12288
  s_add_u32 s34, s34, 12288
  s_cmp_ge_u32 s34, s46
  s_cselect_b32 s39, 73728, 0
  s_sub_u32 s34, s34, s39
  s_waitcnt lgkmcnt(12)
  v_mfma_f32_32x32x16_bf16 v[128:143], v[40:43], a[248:251], v[128:143]
  ds_read_b64_tr_b16 v[52:53], v27 offset:6400
  ds_read_b64_tr_b16 v[54:55], v27 offset:7936
  v_mfma_f32_32x32x16_bf16 v[144:159], v[40:43], a[252:255], v[144:159]
  s_waitcnt lgkmcnt(12)
  v_mfma_f32_32x32x16_bf16 v[160:175], v[44:47], a[248:251], v[160:175]
  ds_read_b64_tr_b16 v[32:33], v20 offset:0
  ds_read_b64_tr_b16 v[34:35], v20 offset:1536
  s_add_u32 m0, s59, 6144
  s_mov_b32 s42, 62592
  buffer_load_dwordx4 v28, s[8:11], s42 offen lds
  v_mfma_f32_32x32x16_bf16 v[176:191], v[44:47], a[252:255], v[176:191]
  s_waitcnt lgkmcnt(4)
  v_mfma_f32_32x32x16_bf16 v[192:207], v[48:51], a[248:251], v[192:207]
  ds_read_b64_tr_b16 v[36:37], v21 offset:0
  ds_read_b64_tr_b16 v[38:39], v21 offset:1536
  v_mfma_f32_32x32x16_bf16 v[208:223], v[48:51], a[252:255], v[208:223]
  s_add_u32 m0, s59, 6144
  s_mov_b32 s42, 62592
  buffer_load_dwordx4 v29, s[8:11], s42 offen offset:1024 lds
  s_waitcnt lgkmcnt(4)
  v_mfma_f32_32x32x16_bf16 v[224:239], v[52:55], a[248:251], v[224:239]
  ds_read_b64_tr_b16 v[40:41], v20 offset:128
  ds_read_b64_tr_b16 v[42:43], v20 offset:1664
  v_mfma_f32_32x32x16_bf16 v[240:255], v[52:55], a[252:255], v[240:255]
  s_waitcnt lgkmcnt(10)
  s_waitcnt lgkmcnt(4)
  v_mfma_f32_32x32x16_bf16 v[64:79], v[32:35], a[192:195], v[64:79]
  ds_read_b64_tr_b16 v[44:45], v21 offset:128
  ds_read_b64_tr_b16 v[46:47], v21 offset:1664
  v_mfma_f32_32x32x16_bf16 v[80:95], v[32:35], a[196:199], v[80:95]
  s_waitcnt lgkmcnt(4)
  v_mfma_f32_32x32x16_bf16 v[96:111], v[36:39], a[192:195], v[96:111]
  ds_read_b64_tr_b16 v[48:49], v20 offset:256
  ds_read_b64_tr_b16 v[50:51], v20 offset:1792
  v_mfma_f32_32x32x16_bf16 v[112:127], v[36:39], a[196:199], v[112:127]
  s_waitcnt vmcnt(26)
  s_barrier
  s_waitcnt lgkmcnt(4)
  v_mfma_f32_32x32x16_bf16 v[128:143], v[40:43], a[192:195], v[128:143]
  ds_read_b64_tr_b16 v[52:53], v21 offset:256
  ds_read_b64_tr_b16 v[54:55], v21 offset:1792
  s_mov_b32 m0, s33
  s_nop 0
  buffer_load_dwordx4 v1, s[12:15], s31 offen nt lds
  v_mfma_f32_32x32x16_bf16 v[144:159], v[40:43], a[196:199], v[144:159]
  s_waitcnt lgkmcnt(4)
  v_mfma_f32_32x32x16_bf16 v[160:175], v[44:47], a[192:195], v[160:175]
  ds_read_b64_tr_b16 v[32:33], v20 offset:6144
  ds_read_b64_tr_b16 v[34:35], v20 offset:7680
  buffer_load_dwordx4 v2, s[12:15], s31 offen offset:1024 nt lds
  v_mfma_f32_32x32x16_bf16 v[176:191], v[44:47], a[196:199], v[176:191]
  s_waitcnt lgkmcnt(4)
  v_mfma_f32_32x32x16_bf16 v[192:207], v[48:51], a[192:195], v[192:207]
  ds_read_b64_tr_b16 v[36:37], v21 offset:6144
  ds_read_b64_tr_b16 v[38:39], v21 offset:7680
  v_mfma_f32_32x32x16_bf16 v[208:223], v[48:51], a[196:199], v[208:223]
  buffer_load_dwordx4 v3, s[12:15], s31 offen offset:2048 nt lds
  s_waitcnt lgkmcnt(4)
  v_mfma_f32_32x32x16_bf16 v[224:239], v[52:55], a[192:195], v[224:239]
  ds_read_b64_tr_b16 v[40:41], v20 offset:6272
  ds_read_b64_tr_b16 v[42:43], v20 offset:7808
  v_mfma_f32_32x32x16_bf16 v[240:255], v[52:55], a[196:199], v[240:255]
  s_waitcnt lgkmcnt(4)
  v_mfma_f32_32x32x16_bf16 v[64:79], v[32:35], a[200:203], v[64:79]
  ds_read_b64_tr_b16 v[44:45], v21 offset:6272
  ds_read_b64_tr_b16 v[46:47], v21 offset:7808
  s_add_u32 s31, s31, 12288
  s_add_u32 s33, s33, 12288
  s_cmp_ge_u32 s33, s45
  s_cselect_b32 s39, 73728, 0
  s_sub_u32 s33, s33, s39
  v_mfma_f32_32x32x16_bf16 v[80:95], v[32:35], a[204:207], v[80:95]
  s_waitcnt lgkmcnt(4)
  v_mfma_f32_32x32x16_bf16 v[96:111], v[36:39], a[200:203], v[96:111]
  ds_read_b64_tr_b16 v[48:49], v20 offset:6400
  ds_read_b64_tr_b16 v[50:51], v20 offset:7936
  s_add_u32 s36, s36, 12288
  s_cmp_ge_u32 s36, 147456
  s_cselect_b32 s36, 73728, s36
  v_add_u32 v26, s36, v14
  v_add_u32 v27, s36, v15
  v_mfma_f32_32x32x16_bf16 v[112:127], v[36:39], a[204:207], v[112:127]
  s_mov_b32 m0, s34
  s_nop 0
  buffer_load_dwordx4 v4, s[16:19], s32 offen nt lds
  s_waitcnt lgkmcnt(4)
  v_mfma_f32_32x32x16_bf16 v[128:143], v[40:43], a[200:203], v[128:143]
  ds_read_b64_tr_b16 v[52:53], v21 offset:6400
  ds_read_b64_tr_b16 v[54:55], v21 offset:7936
  v_mfma_f32_32x32x16_bf16 v[144:159], v[40:43], a[204:207], v[144:159]
  s_waitcnt lgkmcnt(4)
  v_mfma_f32_32x32x16_bf16 v[160:175], v[44:47], a[200:203], v[160:175]
  ds_read_b64_tr_b16 v[32:33], v26 offset:0
  ds_read_b64_tr_b16 v[34:35], v26 offset:1536
  s_mov_b32 m0, s34
  s_nop 0
  buffer_load_dwordx4 v5, s[16:19], s32 offen offset:1024 nt lds
  v_mfma_f32_32x32x16_bf16 v[176:191], v[44:47], a[204:207], v[176:191]
  s_waitcnt lgkmcnt(4)
  v_mfma_f32_32x32x16_bf16 v[192:207], v[48:51], a[200:203], v[192:207]
  ds_read_b64_tr_b16 v[36:37], v27 offset:0
  ds_read_b64_tr_b16 v[38:39], v27 offset:1536
  v_mfma_f32_32x32x16_bf16 v[208:223], v[48:51], a[204:207], v[208:223]
  s_mov_b32 m0, s34
  s_nop 0
  buffer_load_dwordx4 v6, s[16:19], s32 offen offset:2048 nt lds
  s_add_u32 s32, s32, 12288
  s_add_u32 s34, s34, 12288
  s_cmp_ge_u32 s34, s46
  s_cselect_b32 s39, 73728, 0
  s_sub_u32 s34, s34, s39
  s_waitcnt lgkmcnt(4)
  v_mfma_f32_32x32x16_bf16 v[224:239], v[52:55], a[200:203], v[224:239]
  ds_read_b64_tr_b16 v[40:41], v26 offset:128
  ds_read_b64_tr_b16 v[42:43], v26 offset:1664
  v_mfma_f32_32x32x16_bf16 v[240:255], v[52:55], a[204:207], v[240:255]
  s_waitcnt lgkmcnt(4)
  v_mfma_f32_32x32x16_bf16 v[64:79], v[32:35], a[208:211], v[64:79]
  ds_read_b64_tr_b16 v[44:45], v27 offset:128
  ds_read_b64_tr_b16 v[46:47], v27 offset:1664
  v_mfma_f32_32x32x16_bf16 v[80:95], v[32:35], a[212:215], v[80:95]
  s_waitcnt lgkmcnt(4)
  v_mfma_f32_32x32x16_bf16 v[96:111], v[36:39], a[208:211], v[96:111]
  ds_read_b64_tr_b16 v[48:49], v26 offset:256
  ds_read_b64_tr_b16 v[50:51], v26 offset:1792
  v_mfma_f32_32x32x16_bf16 v[112:127], v[36:39], a[212:215], v[112:127]
  s_waitcnt vmcnt(22)
  s_barrier
  s_waitcnt lgkmcnt(4)
  v_mfma_f32_32x32x16_bf16 v[128:143], v[40:43], a[208:211], v[128:143]
  ds_read_b64_tr_b16 v[52:53], v27 offset:256
  ds_read_b64_tr_b16 v[54:55], v27 offset:1792
  s_mov_b32 m0, s33
  s_nop 0
  buffer_load_dwordx4 v1, s[12:15], s31 offen nt lds
  v_mfma_f32_32x32x16_bf16 v[144:159], v[40:43], a[212:215], v[144:159]
  s_waitcnt lgkmcnt(4)
  v_mfma_f32_32x32x16_bf16 v[160:175], v[44:47], a[208:211], v[160:175]
  ds_read_b64_tr_b16 v[32:33], v26 offset:6144
  ds_read_b64_tr_b16 v[34:35], v26 offset:7680
  buffer_load_dwordx4 v2, s[12:15], s31 offen offset:1024 nt lds
  v_mfma_f32_32x32x16_bf16 v[176:191], v[44:47], a[212:215], v[176:191]
  s_waitcnt lgkmcnt(4)
  v_mfma_f32_32x32x16_bf16 v[192:207], v[48:51], a[208:211], v[192:207]
  ds_read_b64_tr_b16 v[36:37], v27 offset:6144
  ds_read_b64_tr_b16 v[38:39], v27 offset:7680
  v_mfma_f32_32x32x16_bf16 v[208:223], v[48:51], a[212:215], v[208:223]
  buffer_load_dwordx4 v3, s[12:15], s31 offen offset:2048 nt lds
  s_waitcnt lgkmcnt(4)
  v_mfma_f32_32x32x16_bf16 v[224:239], v[52:55], a[208:211], v[224:239]
  ds_read_b64_tr_b16 v[40:41], v26 offset:6272
  ds_read_b64_tr_b16 v[42:43], v26 offset:7808
  v_mfma_f32_32x32x16_bf16 v[240:255], v[52:55], a[212:215], v[240:255]
  s_waitcnt lgkmcnt(4)
  v_mfma_f32_32x32x16_bf16 v[64:79], v[32:35], a[216:219], v[64:79]
  ds_read_b64_tr_b16 v[44:45], v27 offset:6272
  ds_read_b64_tr_b16 v[46:47], v27 offset:7808
  s_add_u32 s31, s31, 12288
  s_add_u32 s33, s33, 12288
  s_cmp_ge_u32 s33, s45
  s_cselect_b32 s39, 73728, 0
  s_sub_u32 s33, s33, s39
  s_waitcnt vmcnt(9)
  ds_read_b128 a[224:227], v60 offset:0
  ds_read_b128 a[228:231], v60 offset:4096
  ds_read_b128 a[232:235], v61 offset:0
  ds_read_b128 a[236:239], v61 offset:4096
  ds_read_b128 a[240:243], v62 offset:0
  ds_read_b128 a[244:247], v62 offset:4096
  ds_read_b128 a[248:251], v63 offset:0
  ds_read_b128 a[252:255], v63 offset:4096
  v_mfma_f32_32x32x16_bf16 v[80:95], v[32:35], a[220:223], v[80:95]
  s_waitcnt lgkmcnt(12)
  v_mfma_f32_32x32x16_bf16 v[96:111], v[36:39], a[216:219], v[96:111]
  ds_read_b64_tr_b16 v[48:49], v26 offset:6400
  ds_read_b64_tr_b16 v[50:51], v26 offset:7936
  s_add_u32 s36, s36, 12288
  s_cmp_ge_u32 s36, 147456
  s_cselect_b32 s36, 73728, s36
  v_add_u32 v20, s36, v14
  v_add_u32 v21, s36, v15
  v_mfma_f32_32x32x16_bf16 v[112:127], v[36:39], a[220:223], v[112:127]
  s_mov_b32 m0, s34
  s_nop 0
  buffer_load_dwordx4 v4, s[16:19], s32 offen nt lds
  s_waitcnt lgkmcnt(12)
  v_mfma_f32_32x32x16_bf16 v[128:143], v[40:43], a[216:219], v[128:143]
  ds_read_b64_tr_b16 v[52:53], v27 offset:6400
  ds_read_b64_tr_b16 v[54:55], v27 offset:7936
  v_mfma_f32_32x32x16_bf16 v[144:159], v[40:43], a[220:223], v[144:159]
  s_waitcnt lgkmcnt(12)
  v_mfma_f32_32x32x16_bf16 v[160:175], v[44:47], a[216:219], v[160:175]
  ds_read_b64_tr_b16 v[32:33], v20 offset:0
  ds_read_b64_tr_b16 v[34:35], v20 offset:1536
  s_mov_b32 m0, s34
  s_nop 0
  buffer_load_dwordx4 v5, s[16:19], s32 offen offset:1024 nt lds
  v_mfma_f32_32x32x16_bf16 v[176:191], v[44:47], a[220:223], v[176:191]
  s_waitcnt lgkmcnt(4)
  v_mfma_f32_32x32x16_bf16 v[192:207], v[48:51], a[216:219], v[192:207]
  ds_read_b64_tr_b16 v[36:37], v21 offset:0
  ds_read_b64_tr_b16 v[38:39], v21 offset:1536
  v_mfma_f32_32x32x16_bf16 v[208:223], v[48:51], a[220:223], v[208:223]
  s_mov_b32 m0, s34
  s_nop 0
  buffer_load_dwordx4 v6, s[16:19], s32 offen offset:2048 nt lds
  s_add_u32 s32, s32, 12288
  s_add_u32 s34, s34, 12288
  s_cmp_ge_u32 s34, s46
  s_cselect_b32 s39, 73728, 0
  s_sub_u32 s34, s34, s39
  s_waitcnt lgkmcnt(4)
  v_mfma_f32_32x32x16_bf16 v[224:239], v[52:55], a[216:219], v[224:239]
  ds_read_b64_tr_b16 v[40:41], v20 offset:128
  ds_read_b64_tr_b16 v[42:43], v20 offset:1664
  v_mfma_f32_32x32x16_bf16 v[240:255], v[52:55], a[220:223], v[240:255]
  s_waitcnt lgkmcnt(10)
  s_waitcnt lgkmcnt(4)
  v_mfma_f32_32x32x16_bf16 v[64:79], v[32:35], a[224:227], v[64:79]
  ds_read_b64_tr_b16 v[44:45], v21 offset:128
  ds_read_b64_tr_b16 v[46:47], v21 offset:1664
  v_mfma_f32_32x32x16_bf16 v[80:95], v[32:35], a[228:231], v[80:95]
  s_waitcnt lgkmcnt(4)
  v_mfma_f32_32x32x16_bf16 v[96:111], v[36:39], a[224:227], v[96:111]
  ds_read_b64_tr_b16 v[48:49], v20 offset:256
  ds_read_b64_tr_b16 v[50:51], v20 offset:1792
  v_mfma_f32_32x32x16_bf16 v[112:127], v[36:39], a[228:231], v[112:127]
  s_waitcnt vmcnt(21)
  s_barrier
  s_waitcnt lgkmcnt(4)
  v_mfma_f32_32x32x16_bf16 v[128:143], v[40:43], a[224:227], v[128:143]
  ds_read_b64_tr_b16 v[52:53], v21 offset:256
  ds_read_b64_tr_b16 v[54:55], v21 offset:1792
  s_mov_b32 m0, s33
  s_nop 0
  buffer_load_dwordx4 v1, s[12:15], s31 offen nt lds
  v_mfma_f32_32x32x16_bf16 v[144:159], v[40:43], a[228:231], v[144:159]
  s_waitcnt lgkmcnt(4)
  v_mfma_f32_32x32x16_bf16 v[160:175], v[44:47], a[224:227], v[160:175]
  ds_read_b64_tr_b16 v[32:33], v20 offset:6144
  ds_read_b64_tr_b16 v[34:35], v20 offset:7680
  buffer_load_dwordx4 v2, s[12:15], s31 offen offset:1024 nt lds
  v_mfma_f32_32x32x16_bf16 v[176:191], v[44:47], a[228:231], v[176:191]
  s_waitcnt lgkmcnt(4)
  v_mfma_f32_32x32x16_bf16 v[192:207], v[48:51], a[224:227], v[192:207]
  ds_read_b64_tr_b16 v[36:37], v21 offset:6144
  ds_read_b64_tr_b16 v[38:39], v21 offset:7680
  v_mfma_f32_32x32x16_bf16 v[208:223], v[48:51], a[228:231], v[208:223]
  buffer_load_dwordx4 v3, s[12:15], s31 offen offset:2048 nt lds
  s_waitcnt lgkmcnt(4)
  v_mfma_f32_32x32x16_bf16 v[224:239], v[52:55], a[224:227], v[224:239]
  ds_read_b64_tr_b16 v[40:41], v20 offset:6272
  ds_read_b64_tr_b16 v[42:43], v20 offset:7808
  v_mfma_f32_32x32x16_bf16 v[240:255], v[52:55], a[228:231], v[240:255]
  s_waitcnt lgkmcnt(4)
  v_mfma_f32_32x32x16_bf16 v[64:79], v[32:35], a[232:235], v[64:79]
  ds_read_b64_tr_b16 v[44:45], v21 offset:6272
  ds_read_b64_tr_b16 v[46:47], v21 offset:7808
  s_add_u32 s31, s31, 12288
  s_add_u32 s33, s33, 12288
  s_cmp_ge_u32 s33, s45
  s_cselect_b32 s39, 73728, 0
  s_sub_u32 s33, s33, s39
  v_mfma_f32_32x32x16_bf16 v[80:95], v[32:35], a[236:239], v[80:95]
  s_waitcnt lgkmcnt(4)
  v_mfma_f32_32x32x16_bf16 v[96:111], v[36:39], a[232:235], v[96:111]
  ds_read_b64_tr_b16 v[48:49], v20 offset:6400
  ds_read_b64_tr_b16 v[50:51], v20 offset:7936
  s_add_u32 s36, s36, 12288
  s_cmp_ge_u32 s36, 147456
  s_cselect_b32 s36, 73728, s36
  v_add_u32 v26, s36, v14
  v_add_u32 v27, s36, v15
  v_mfma_f32_32x32x16_bf16 v[112:127], v[36:39], a[236:239], v[112:127]
  s_mov_b32 m0, s34
  s_nop 0
  buffer_load_dwordx4 v4, s[16:19], s32 offen nt lds
  s_waitcnt lgkmcnt(4)
  v_mfma_f32_32x32x16_bf16 v[128:143], v[40:43], a[232:235], v[128:143]
  ds_read_b64_tr_b16 v[52:53], v21 offset:6400
  ds_read_b64_tr_b16 v[54:55], v21 offset:7936
  v_mfma_f32_32x32x16_bf16 v[144:159], v[40:43], a[236:239], v[144:159]
  s_waitcnt lgkmcnt(4)
  v_mfma_f32_32x32x16_bf16 v[160:175], v[44:47], a[232:235], v[160:175]
  ds_read_b64_tr_b16 v[32:33], v26 offset:0
  ds_read_b64_tr_b16 v[34:35], v26 offset:1536
  s_mov_b32 m0, s34
  s_nop 0
  buffer_load_dwordx4 v5, s[16:19], s32 offen offset:1024 nt lds
  v_mfma_f32_32x32x16_bf16 v[176:191], v[44:47], a[236:239], v[176:191]
  s_waitcnt lgkmcnt(4)
  v_mfma_f32_32x32x16_bf16 v[192:207], v[48:51], a[232:235], v[192:207]
  ds_read_b64_tr_b16 v[36:37], v27 offset:0
  ds_read_b64_tr_b16 v[38:39], v27 offset:1536
  v_mfma_f32_32x32x16_bf16 v[208:223], v[48:51], a[236:239], v[208:223]
  s_mov_b32 m0, s34
  s_nop 0
  buffer_load_dwordx4 v6, s[16:19], s32 offen offset:2048 nt lds
  s_add_u32 s32, s32, 12288
  s_add_u32 s34, s34, 12288
  s_cmp_ge_u32 s34, s46
  s_cselect_b32 s39, 73728, 0
  s_sub_u32 s34, s34, s39
  s_waitcnt lgkmcnt(4)
  v_mfma_f32_32x32x16_bf16 v[224:239], v[52:55], a[232:235], v[224:239]
  ds_read_b64_tr_b16 v[40:41], v26 offset:128
  ds_read_b64_tr_b16 v[42:43], v26 offset:1664
  v_mfma_f32_32x32x16_bf16 v[240:255], v[52:55], a[236:239], v[240:255]
  s_waitcnt lgkmcnt(4)
  v_mfma_f32_32x32x16_bf16 v[64:79], v[32:35], a[240:243], v[64:79]
  ds_read_b64_tr_b16 v[44:45], v27 offset:128
  ds_read_b64_tr_b16 v[46:47], v27 offset:1664
  v_mfma_f32_32x32x16_bf16 v[80:95], v[32:35], a[244:247], v[80:95]
  s_waitcnt lgkmcnt(4)
  v_mfma_f32_32x32x16_bf16 v[96:111], v[36:39], a[240:243], v[96:111]
  ds_read_b64_tr_b16 v[48:49], v26 offset:256
  ds_read_b64_tr_b16 v[50:51], v26 offset:1792
  v_mfma_f32_32x32x16_bf16 v[112:127], v[36:39], a[244:247], v[112:127]
  s_waitcnt vmcnt(6)
  s_barrier
  s_waitcnt lgkmcnt(4)
  v_mfma_f32_32x32x16_bf16 v[128:143], v[40:43], a[240:243], v[128:143]
  ds_read_b64_tr_b16 v[52:53], v27 offset:256
  ds_read_b64_tr_b16 v[54:55], v27 offset:1792
  s_mov_b32 m0, s33
  s_nop 0
  buffer_load_dwordx4 v1, s[12:15], s31 offen nt lds
  v_mfma_f32_32x32x16_bf16 v[144:159], v[40:43], a[244:247], v[144:159]
  s_waitcnt lgkmcnt(4)
  v_mfma_f32_32x32x16_bf16 v[160:175], v[44:47], a[240:243], v[160:175]
  ds_read_b64_tr_b16 v[32:33], v26 offset:6144
  ds_read_b64_tr_b16 v[34:35], v26 offset:7680
  buffer_load_dwordx4 v2, s[12:15], s31 offen offset:1024 nt lds
  v_mfma_f32_32x32x16_bf16 v[176:191], v[44:47], a[244:247], v[176:191]
  s_waitcnt lgkmcnt(4)
  v_mfma_f32_32x32x16_bf16 v[192:207], v[48:51], a[240:243], v[192:207]
  ds_read_b64_tr_b16 v[36:37], v27 offset:6144
  ds_read_b64_tr_b16 v[38:39], v27 offset:7680
  v_mfma_f32_32x32x16_bf16 v[208:223], v[48:51], a[244:247], v[208:223]
  buffer_load_dwordx4 v3, s[12:15], s31 offen offset:2048 nt lds
  s_waitcnt lgkmcnt(4)
  v_mfma_f32_32x32x16_bf16 v[224:239], v[52:55], a[240:243], v[224:239]
  ds_read_b64_tr_b16 v[40:41], v26 offset:6272
  ds_read_b64_tr_b16 v[42:43], v26 offset:7808
  v_mfma_f32_32x32x16_bf16 v[240:255], v[52:55], a[244:247], v[240:255]
  s_waitcnt lgkmcnt(4)
  v_mfma_f32_32x32x16_bf16 v[64:79], v[32:35], a[248:251], v[64:79]
  ds_read_b64_tr_b16 v[44:45], v27 offset:6272
  ds_read_b64_tr_b16 v[46:47], v27 offset:7808
  s_add_u32 s31, s31, 12288
  s_add_u32 s33, s33, 12288
  s_cmp_ge_u32 s33, s45
  s_cselect_b32 s39, 73728, 0
  s_sub_u32 s33, s33, s39
  v_mfma_f32_32x32x16_bf16 v[80:95], v[32:35], a[252:255], v[80:95]
  s_waitcnt lgkmcnt(4)
  v_mfma_f32_32x32x16_bf16 v[96:111], v[36:39], a[248:251], v[96:111]
  ds_read_b64_tr_b16 v[48:49], v26 offset:6400
  ds_read_b64_tr_b16 v[50:51], v26 offset:7936
  s_mov_b32 s35, 61440
  s_add_u32 s35, s35, 12288
  s_cmp_ge_u32 s35, 73728
  s_cselect_b32 s35, 0, s35
  v_add_u32 v16, s35, v10
  v_add_u32 v17, s35, v11
  v_add_u32 v18, s35, v12
  v_add_u32 v19, s35, v13
  v_mfma_f32_32x32x16_bf16 v[112:127], v[36:39], a[252:255], v[112:127]
  s_mov_b32 m0, s34
  s_nop 0
  buffer_load_dwordx4 v4, s[16:19], s32 offen nt lds
  s_waitcnt lgkmcnt(4)
  v_mfma_f32_32x32x16_bf16 v[128:143], v[40:43], a[248:251], v[128:143]
  ds_read_b64_tr_b16 v[52:53], v27 offset:6400
  ds_read_b64_tr_b16 v[54:55], v27 offset:7936
  v_mfma_f32_32x32x16_bf16 v[144:159], v[40:43], a[252:255], v[144:159]
  s_waitcnt lgkmcnt(4)
  v_mfma_f32_32x32x16_bf16 v[160:175], v[44:47], a[248:251], v[160:175]
  ds_read_b128 v[32:35], v16 offset:0
  s_mov_b32 m0, s34
  s_nop 0
  buffer_load_dwordx4 v5, s[16:19], s32 offen offset:1024 nt lds
  v_mfma_f32_32x32x16_bf16 v[176:191], v[44:47], a[252:255], v[176:191]
  s_waitcnt lgkmcnt(3)
  v_mfma_f32_32x32x16_bf16 v[192:207], v[48:51], a[248:251], v[192:207]
  ds_read_b128 v[36:39], v17 offset:0
  v_mfma_f32_32x32x16_bf16 v[208:223], v[48:51], a[252:255], v[208:223]
  s_mov_b32 m0, s34
  s_nop 0
  buffer_load_dwordx4 v6, s[16:19], s32 offen offset:2048 nt lds
  s_add_u32 s32, s32, 12288
  s_add_u32 s34, s34, 12288
  s_cmp_ge_u32 s34, s46
  s_cselect_b32 s39, 73728, 0
  s_sub_u32 s34, s34, s39
  s_waitcnt lgkmcnt(2)
  v_mfma_f32_32x32x16_bf16 v[224:239], v[52:55], a[248:251], v[224:239]
  ds_read_b128 v[40:43], v18 offset:0
  v_mfma_f32_32x32x16_bf16 v[240:255], v[52:55], a[252:255], v[240:255]
  s_nop 15
  v_pk_mul_f32 v[192:193], v[192:193], s[40:41]
  v_pk_mul_f32 v[194:195], v[194:195], s[40:41]
  v_pk_mul_f32 v[196:197], v[196:197], s[40:41]
  v_pk_mul_f32 v[198:199], v[198:199], s[40:41]
  v_cvt_pk_bf16_f32 v56, v192, v193
  v_cvt_pk_bf16_f32 v57, v194, v195
  v_cvt_pk_bf16_f32 v58, v196, v197
  v_cvt_pk_bf16_f32 v59, v198, v199
  v_accvgpr_write_b32 a192, v56
  v_accvgpr_write_b32 a193, v57
  v_accvgpr_write_b32 a194, v58
  v_accvgpr_write_b32 a195, v59
  v_pk_mul_f32 v[200:201], v[200:201], s[40:41]
  v_pk_mul_f32 v[202:203], v[202:203], s[40:41]
  v_pk_mul_f32 v[204:205], v[204:205], s[40:41]
  v_pk_mul_f32 v[206:207], v[206:207], s[40:41]
  v_cvt_pk_bf16_f32 v56, v200, v201
  v_cvt_pk_bf16_f32 v57, v202, v203
  v_cvt_pk_bf16_f32 v58, v204, v205
  v_cvt_pk_bf16_f32 v59, v206, v207
  v_accvgpr_write_b32 a200, v56
  v_accvgpr_write_b32 a201, v57
  v_accvgpr_write_b32 a202, v58
  v_accvgpr_write_b32 a203, v59
  v_pk_mul_f32 v[208:209], v[208:209], s[40:41]
  v_pk_mul_f32 v[210:211], v[210:211], s[40:41]
  v_pk_mul_f32 v[212:213], v[212:213], s[40:41]
  v_pk_mul_f32 v[214:215], v[214:215], s[40:41]
  v_cvt_pk_bf16_f32 v56, v208, v209
  v_cvt_pk_bf16_f32 v57, v210, v211
  v_cvt_pk_bf16_f32 v58, v212, v213
  v_cvt_pk_bf16_f32 v59, v214, v215
  v_accvgpr_write_b32 a196, v56
  v_accvgpr_write_b32 a197, v57
  v_accvgpr_write_b32 a198, v58
  v_accvgpr_write_b32 a199, v59
  v_pk_mul_f32 v[216:217], v[216:217], s[40:41]
  v_pk_mul_f32 v[218:219], v[218:219], s[40:41]
  v_pk_mul_f32 v[220:221], v[220:221], s[40:41]
  v_pk_mul_f32 v[222:223], v[222:223], s[40:41]
  v_cvt_pk_bf16_f32 v56, v216, v217
  v_cvt_pk_bf16_f32 v57, v218, v219
  v_cvt_pk_bf16_f32 v58, v220, v221
  v_cvt_pk_bf16_f32 v59, v222, v223
  v_accvgpr_write_b32 a204, v56
  v_accvgpr_write_b32 a205, v57
  v_accvgpr_write_b32 a206, v58
  v_accvgpr_write_b32 a207, v59
  v_pk_mul_f32 v[224:225], v[224:225], s[40:41]
  v_pk_mul_f32 v[226:227], v[226:227], s[40:41]
  v_pk_mul_f32 v[228:229], v[228:229], s[40:41]
  v_pk_mul_f32 v[230:231], v[230:231], s[40:41]
  v_cvt_pk_bf16_f32 v56, v224, v225
  v_cvt_pk_bf16_f32 v57, v226, v227
  v_cvt_pk_bf16_f32 v58, v228, v229
  v_cvt_pk_bf16_f32 v59, v230, v231
  v_accvgpr_write_b32 a208, v56
  v_accvgpr_write_b32 a209, v57
  v_accvgpr_write_b32 a210, v58
  v_accvgpr_write_b32 a211, v59
  v_pk_mul_f32 v[232:233], v[232:233], s[40:41]
  v_pk_mul_f32 v[234:235], v[234:235], s[40:41]
  v_pk_mul_f32 v[236:237], v[236:237], s[40:41]
  v_pk_mul_f32 v[238:239], v[238:239], s[40:41]
  v_cvt_pk_bf16_f32 v56, v232, v233
  v_cvt_pk_bf16_f32 v57, v234, v235
  v_cvt_pk_bf16_f32 v58, v236, v237
  v_cvt_pk_bf16_f32 v59, v238, v239
  v_accvgpr_write_b32 a216, v56
  v_accvgpr_write_b32 a217, v57
  v_accvgpr_write_b32 a218, v58
  v_accvgpr_write_b32 a219, v59
  v_pk_mul_f32 v[240:241], v[240:241], s[40:41]
  v_pk_mul_f32 v[242:243], v[242:243], s[40:41]
  v_pk_mul_f32 v[244:245], v[244:245], s[40:41]
  v_pk_mul_f32 v[246:247], v[246:247], s[40:41]
  v_cvt_pk_bf16_f32 v56, v240, v241
  v_cvt_pk_bf16_f32 v57, v242, v243
  v_cvt_pk_bf16_f32 v58, v244, v245
  v_cvt_pk_bf16_f32 v59, v246, v247
  v_accvgpr_write_b32 a212, v56
  v_accvgpr_write_b32 a213, v57
  v_accvgpr_write_b32 a214, v58
  v_accvgpr_write_b32 a215, v59
  v_pk_mul_f32 v[248:249], v[248:249], s[40:41]
  v_pk_mul_f32 v[250:251], v[250:251], s[40:41]
  v_pk_mul_f32 v[252:253], v[252:253], s[40:41]
  v_pk_mul_f32 v[254:255], v[254:255], s[40:41]
  v_cvt_pk_bf16_f32 v56, v248, v249
  v_cvt_pk_bf16_f32 v57, v250, v251
  v_cvt_pk_bf16_f32 v58, v252, v253
  v_cvt_pk_bf16_f32 v59, v254, v255
  v_accvgpr_write_b32 a220, v56
  v_accvgpr_write_b32 a221, v57
  v_accvgpr_write_b32 a222, v58
  v_accvgpr_write_b32 a223, v59
  v_pk_mul_f32 v[64:65], v[64:65], s[40:41]
  v_pk_mul_f32 v[66:67], v[66:67], s[40:41]
  v_pk_mul_f32 v[68:69], v[68:69], s[40:41]
  v_pk_mul_f32 v[70:71], v[70:71], s[40:41]
  v_cvt_pk_bf16_f32 v192, v64, v65
  v_cvt_pk_bf16_f32 v193, v66, v67
  v_cvt_pk_bf16_f32 v194, v68, v69
  v_cvt_pk_bf16_f32 v195, v70, v71
  v_pk_mul_f32 v[72:73], v[72:73], s[40:41]
  v_pk_mul_f32 v[74:75], v[74:75], s[40:41]
  v_pk_mul_f32 v[76:77], v[76:77], s[40:41]
  v_pk_mul_f32 v[78:79], v[78:79], s[40:41]
  v_cvt_pk_bf16_f32 v200, v72, v73
  v_cvt_pk_bf16_f32 v201, v74, v75
  v_cvt_pk_bf16_f32 v202, v76, v77
  v_cvt_pk_bf16_f32 v203, v78, v79
  v_pk_mul_f32 v[80:81], v[80:81], s[40:41]
  v_pk_mul_f32 v[82:83], v[82:83], s[40:41]
  v_pk_mul_f32 v[84:85], v[84:85], s[40:41]
  v_pk_mul_f32 v[86:87], v[86:87], s[40:41]
  v_cvt_pk_bf16_f32 v196, v80, v81
  v_cvt_pk_bf16_f32 v197, v82, v83
  v_cvt_pk_bf16_f32 v198, v84, v85
  v_cvt_pk_bf16_f32 v199, v86, v87
  v_pk_mul_f32 v[88:89], v[88:89], s[40:41]
  v_pk_mul_f32 v[90:91], v[90:91], s[40:41]
  v_pk_mul_f32 v[92:93], v[92:93], s[40:41]
  v_pk_mul_f32 v[94:95], v[94:95], s[40:41]
  v_cvt_pk_bf16_f32 v204, v88, v89
  v_cvt_pk_bf16_f32 v205, v90, v91
  v_cvt_pk_bf16_f32 v206, v92, v93
  v_cvt_pk_bf16_f32 v207, v94, v95
  v_pk_mul_f32 v[96:97], v[96:97], s[40:41]
  v_pk_mul_f32 v[98:99], v[98:99], s[40:41]
  v_pk_mul_f32 v[100:101], v[100:101], s[40:41]
  v_pk_mul_f32 v[102:103], v[102:103], s[40:41]
  v_cvt_pk_bf16_f32 v208, v96, v97
  v_cvt_pk_bf16_f32 v209, v98, v99
  v_cvt_pk_bf16_f32 v210, v100, v101
  v_cvt_pk_bf16_f32 v211, v102, v103
  v_pk_mul_f32 v[104:105], v[104:105], s[40:41]
  v_pk_mul_f32 v[106:107], v[106:107], s[40:41]
  v_pk_mul_f32 v[108:109], v[108:109], s[40:41]
  v_pk_mul_f32 v[110:111], v[110:111], s[40:41]
  v_cvt_pk_bf16_f32 v216, v104, v105
  v_cvt_pk_bf16_f32 v217, v106, v107
  v_cvt_pk_bf16_f32 v218, v108, v109
  v_cvt_pk_bf16_f32 v219, v110, v111
  v_pk_mul_f32 v[112:113], v[112:113], s[40:41]
  v_pk_mul_f32 v[114:115], v[114:115], s[40:41]
  v_pk_mul_f32 v[116:117], v[116:117], s[40:41]
  v_pk_mul_f32 v[118:119], v[118:119], s[40:41]
  v_cvt_pk_bf16_f32 v212, v112, v113
  v_cvt_pk_bf16_f32 v213, v114, v115
  v_cvt_pk_bf16_f32 v214, v116, v117
  v_cvt_pk_bf16_f32 v215, v118, v119
  v_pk_mul_f32 v[120:121], v[120:121], s[40:41]
  v_pk_mul_f32 v[122:123], v[122:123], s[40:41]
  v_pk_mul_f32 v[124:125], v[124:125], s[40:41]
  v_pk_mul_f32 v[126:127], v[126:127], s[40:41]
  v_cvt_pk_bf16_f32 v220, v120, v121
  v_cvt_pk_bf16_f32 v221, v122, v123
  v_cvt_pk_bf16_f32 v222, v124, v125
  v_cvt_pk_bf16_f32 v223, v126, v127
  v_pk_mul_f32 v[128:129], v[128:129], s[40:41]
  v_pk_mul_f32 v[130:131], v[130:131], s[40:41]
  v_pk_mul_f32 v[132:133], v[132:133], s[40:41]
  v_pk_mul_f32 v[134:135], v[134:135], s[40:41]
  v_cvt_pk_bf16_f32 v56, v128, v129
  v_cvt_pk_bf16_f32 v57, v130, v131
  v_cvt_pk_bf16_f32 v58, v132, v133
  v_cvt_pk_bf16_f32 v59, v134, v135
  v_accvgpr_write_b32 a224, v56
  v_accvgpr_write_b32 a225, v57
  v_accvgpr_write_b32 a226, v58
  v_accvgpr_write_b32 a227, v59
  v_pk_mul_f32 v[136:137], v[136:137], s[40:41]
  v_pk_mul_f32 v[138:139], v[138:139], s[40:41]
  v_pk_mul_f32 v[140:141], v[140:141], s[40:41]
  v_pk_mul_f32 v[142:143], v[142:143], s[40:41]
  v_cvt_pk_bf16_f32 v56, v136, v137
  v_cvt_pk_bf16_f32 v57, v138, v139
  v_cvt_pk_bf16_f32 v58, v140, v141
  v_cvt_pk_bf16_f32 v59, v142, v143
  v_accvgpr_write_b32 a232, v56
  v_accvgpr_write_b32 a233, v57
  v_accvgpr_write_b32 a234, v58
  v_accvgpr_write_b32 a235, v59
  v_pk_mul_f32 v[144:145], v[144:145], s[40:41]
  v_pk_mul_f32 v[146:147], v[146:147], s[40:41]
  v_pk_mul_f32 v[148:149], v[148:149], s[40:41]
  v_pk_mul_f32 v[150:151], v[150:151], s[40:41]
  v_cvt_pk_bf16_f32 v56, v144, v145
  v_cvt_pk_bf16_f32 v57, v146, v147
  v_cvt_pk_bf16_f32 v58, v148, v149
  v_cvt_pk_bf16_f32 v59, v150, v151
  v_accvgpr_write_b32 a228, v56
  v_accvgpr_write_b32 a229, v57
  v_accvgpr_write_b32 a230, v58
  v_accvgpr_write_b32 a231, v59
  v_pk_mul_f32 v[152:153], v[152:153], s[40:41]
  v_pk_mul_f32 v[154:155], v[154:155], s[40:41]
  v_pk_mul_f32 v[156:157], v[156:157], s[40:41]
  v_pk_mul_f32 v[158:159], v[158:159], s[40:41]
  v_cvt_pk_bf16_f32 v56, v152, v153
  v_cvt_pk_bf16_f32 v57, v154, v155
  v_cvt_pk_bf16_f32 v58, v156, v157
  v_cvt_pk_bf16_f32 v59, v158, v159
  v_accvgpr_write_b32 a236, v56
  v_accvgpr_write_b32 a237, v57
  v_accvgpr_write_b32 a238, v58
  v_accvgpr_write_b32 a239, v59
  v_pk_mul_f32 v[160:161], v[160:161], s[40:41]
  v_pk_mul_f32 v[162:163], v[162:163], s[40:41]
  v_pk_mul_f32 v[164:165], v[164:165], s[40:41]
  v_pk_mul_f32 v[166:167], v[166:167], s[40:41]
  v_cvt_pk_bf16_f32 v56, v160, v161
  v_cvt_pk_bf16_f32 v57, v162, v163
  v_cvt_pk_bf16_f32 v58, v164, v165
  v_cvt_pk_bf16_f32 v59, v166, v167
  v_accvgpr_write_b32 a240, v56
  v_accvgpr_write_b32 a241, v57
  v_accvgpr_write_b32 a242, v58
  v_accvgpr_write_b32 a243, v59
  v_pk_mul_f32 v[168:169], v[168:169], s[40:41]
  v_pk_mul_f32 v[170:171], v[170:171], s[40:41]
  v_pk_mul_f32 v[172:173], v[172:173], s[40:41]
  v_pk_mul_f32 v[174:175], v[174:175], s[40:41]
  v_cvt_pk_bf16_f32 v56, v168, v169
  v_cvt_pk_bf16_f32 v57, v170, v171
  v_cvt_pk_bf16_f32 v58, v172, v173
  v_cvt_pk_bf16_f32 v59, v174, v175
  v_accvgpr_write_b32 a248, v56
  v_accvgpr_write_b32 a249, v57
  v_accvgpr_write_b32 a250, v58
  v_accvgpr_write_b32 a251, v59
  v_pk_mul_f32 v[176:177], v[176:177], s[40:41]
  v_pk_mul_f32 v[178:179], v[178:179], s[40:41]
  v_pk_mul_f32 v[180:181], v[180:181], s[40:41]
  v_pk_mul_f32 v[182:183], v[182:183], s[40:41]
  v_cvt_pk_bf16_f32 v56, v176, v177
  v_cvt_pk_bf16_f32 v57, v178, v179
  v_cvt_pk_bf16_f32 v58, v180, v181
  v_cvt_pk_bf16_f32 v59, v182, v183
  v_accvgpr_write_b32 a244, v56
  v_accvgpr_write_b32 a245, v57
  v_accvgpr_write_b32 a246, v58
  v_accvgpr_write_b32 a247, v59
  v_pk_mul_f32 v[184:185], v[184:185], s[40:41]
  v_pk_mul_f32 v[186:187], v[186:187], s[40:41]
  v_pk_mul_f32 v[188:189], v[188:189], s[40:41]
  v_pk_mul_f32 v[190:191], v[190:191], s[40:41]
  v_cvt_pk_bf16_f32 v56, v184, v185
  v_cvt_pk_bf16_f32 v57, v186, v187
  v_cvt_pk_bf16_f32 v58, v188, v189
  v_cvt_pk_bf16_f32 v59, v190, v191
  v_accvgpr_write_b32 a252, v56
  v_accvgpr_write_b32 a253, v57
  v_accvgpr_write_b32 a254, v58
  v_accvgpr_write_b32 a255, v59
  s_nop 1
  s_waitcnt lgkmcnt(2)
  v_mfma_f32_32x32x16_bf16 v[64:79], v[32:35], v[192:195], 0
  ds_read_b128 v[44:47], v19 offset:0
  v_mfma_f32_32x32x16_bf16 v[80:95], v[32:35], v[196:199], 0
  s_waitcnt lgkmcnt(2)
  v_mfma_f32_32x32x16_bf16 v[64:79], v[36:39], v[200:203], v[64:79]
  ds_read_b128 v[48:51], v16 offset:128
  v_mfma_f32_32x32x16_bf16 v[80:95], v[36:39], v[204:207], v[80:95]
  s_waitcnt lgkmcnt(2)
  v_mfma_f32_32x32x16_bf16 v[64:79], v[40:43], v[208:211], v[64:79]
  ds_read_b128 v[52:55], v17 offset:128
  v_mfma_f32_32x32x16_bf16 v[80:95], v[40:43], v[212:215], v[80:95]
  s_waitcnt lgkmcnt(2)
  v_mfma_f32_32x32x16_bf16 v[64:79], v[44:47], v[216:219], v[64:79]
  ds_read_b128 v[32:35], v18 offset:128
  v_mfma_f32_32x32x16_bf16 v[80:95], v[44:47], v[220:223], v[80:95]
  s_waitcnt lgkmcnt(2)
  v_mfma_f32_32x32x16_bf16 v[64:79], v[48:51], a[224:227], v[64:79]
  ds_read_b128 v[36:39], v19 offset:128
  v_mfma_f32_32x32x16_bf16 v[80:95], v[48:51], a[228:231], v[80:95]
  s_waitcnt lgkmcnt(2)
  v_mfma_f32_32x32x16_bf16 v[64:79], v[52:55], a[232:235], v[64:79]
  ds_read_b128 v[40:43], v16 offset:256
  v_mfma_f32_32x32x16_bf16 v[80:95], v[52:55], a[236:239], v[80:95]
  s_waitcnt lgkmcnt(2)
  v_mfma_f32_32x32x16_bf16 v[64:79], v[32:35], a[240:243], v[64:79]
  ds_read_b128 v[44:47], v17 offset:256
  v_mfma_f32_32x32x16_bf16 v[80:95], v[32:35], a[244:247], v[80:95]
  s_waitcnt lgkmcnt(2)
  v_mfma_f32_32x32x16_bf16 v[64:79], v[36:39], a[248:251], v[64:79]
  ds_read_b128 v[48:51], v18 offset:256
  v_mfma_f32_32x32x16_bf16 v[80:95], v[36:39], a[252:255], v[80:95]
  s_waitcnt lgkmcnt(2)
  v_mfma_f32_32x32x16_bf16 v[64:79], v[40:43], a[192:195], v[64:79]
  ds_read_b128 v[52:55], v19 offset:256
  v_mfma_f32_32x32x16_bf16 v[80:95], v[40:43], a[196:199], v[80:95]
  s_waitcnt lgkmcnt(2)
  v_mfma_f32_32x32x16_bf16 v[64:79], v[44:47], a[200:203], v[64:79]
  v_mfma_f32_32x32x16_bf16 v[80:95], v[44:47], a[204:207], v[80:95]
  s_waitcnt lgkmcnt(1)
  v_mfma_f32_32x32x16_bf16 v[64:79], v[48:51], a[208:211], v[64:79]
  v_mfma_f32_32x32x16_bf16 v[80:95], v[48:51], a[212:215], v[80:95]
  s_waitcnt lgkmcnt(0)
  v_mfma_f32_32x32x16_bf16 v[64:79], v[52:55], a[216:219], v[64:79]
  v_mfma_f32_32x32x16_bf16 v[80:95], v[52:55], a[220:223], v[80:95]
  s_add_u32 s35, s35, 12288
  s_cmp_ge_u32 s35, 73728
  s_cselect_b32 s35, 0, s35
  v_add_u32 v16, s35, v10
  v_add_u32 v17, s35, v11
  v_add_u32 v18, s35, v12
  v_add_u32 v19, s35, v13
  ds_read_b128 v[32:35], v16 offset:0
  ds_read_b128 v[36:39], v17 offset:0
  ds_read_b128 v[40:43], v18 offset:0
  s_nop 15
  v_max3_f32 v229, v64, v65, v66
  v_max3_f32 v229, v229, v67, v68
  v_max3_f32 v229, v229, v69, v70
  v_max3_f32 v229, v229, v71, v72
  v_max3_f32 v229, v229, v73, v74
  v_max3_f32 v229, v229, v75, v76
  v_max3_f32 v229, v229, v77, v78
  v_max_f32 v229, v229, v79
  v_mov_b32 v230, v229
  s_nop 1
  v_permlane32_swap_b32 v229, v230
  s_nop 1
  v_max_f32 v229, v229, v230
  v_sub_f32 v64, v64, v229
  v_sub_f32 v160, 0, v229
  v_sub_f32 v65, v65, v229
  v_sub_f32 v161, 0, v229
  v_sub_f32 v66, v66, v229
  v_sub_f32 v162, 0, v229
  v_sub_f32 v67, v67, v229
  v_sub_f32 v163, 0, v229
  v_sub_f32 v68, v68, v229
  v_sub_f32 v164, 0, v229
  v_sub_f32 v69, v69, v229
  v_sub_f32 v165, 0, v229
  v_sub_f32 v70, v70, v229
  v_sub_f32 v166, 0, v229
  v_sub_f32 v71, v71, v229
  v_sub_f32 v167, 0, v229
  v_sub_f32 v72, v72, v229
  v_sub_f32 v168, 0, v229
  v_sub_f32 v73, v73, v229
  v_sub_f32 v169, 0, v229
  v_sub_f32 v74, v74, v229
  v_sub_f32 v170, 0, v229
  v_sub_f32 v75, v75, v229
  v_sub_f32 v171, 0, v229
  v_sub_f32 v76, v76, v229
  v_sub_f32 v172, 0, v229
  v_sub_f32 v77, v77, v229
  v_sub_f32 v173, 0, v229
  v_sub_f32 v78, v78, v229
  v_sub_f32 v174, 0, v229
  v_sub_f32 v79, v79, v229
  v_sub_f32 v175, 0, v229
  v_mov_b32 v224, 0
  v_max3_f32 v229, v80, v81, v82
  v_max3_f32 v229, v229, v83, v84
  v_max3_f32 v229, v229, v85, v86
  v_max3_f32 v229, v229, v87, v88
  v_max3_f32 v229, v229, v89, v90
  v_max3_f32 v229, v229, v91, v92
  v_max3_f32 v229, v229, v93, v94
  v_max_f32 v229, v229, v95
  v_mov_b32 v230, v229
  s_nop 1
  v_permlane32_swap_b32 v229, v230
  s_nop 1
  v_max_f32 v229, v229, v230
  v_sub_f32 v80, v80, v229
  v_sub_f32 v176, 0, v229
  v_sub_f32 v81, v81, v229
  v_sub_f32 v177, 0, v229
  v_sub_f32 v82, v82, v229
  v_sub_f32 v178, 0, v229
  v_sub_f32 v83, v83, v229
  v_sub_f32 v179, 0, v229
  v_sub_f32 v84, v84, v229
  v_sub_f32 v180, 0, v229
  v_sub_f32 v85, v85, v229
  v_sub_f32 v181, 0, v229
  v_sub_f32 v86, v86, v229
  v_sub_f32 v182, 0, v229
  v_sub_f32 v87, v87, v229
  v_sub_f32 v183, 0, v229
  v_sub_f32 v88, v88, v229
  v_sub_f32 v184, 0, v229
  v_sub_f32 v89, v89, v229
  v_sub_f32 v185, 0, v229
  v_sub_f32 v90, v90, v229
  v_sub_f32 v186, 0, v229
  v_sub_f32 v91, v91, v229
  v_sub_f32 v187, 0, v229
  v_sub_f32 v92, v92, v229
  v_sub_f32 v188, 0, v229
  v_sub_f32 v93, v93, v229
  v_sub_f32 v189, 0, v229
  v_sub_f32 v94, v94, v229
  v_sub_f32 v190, 0, v229
  v_sub_f32 v95, v95, v229
  v_sub_f32 v191, 0, v229
  v_mov_b32 v225, 0
  s_nop 7
  s_mov_b32 s36, 86016
  v_lshrrev_b32 v242, 3, v0
  v_mul_u32_u24 v242, 1280, v242
  v_and_b32 v243, 7, v0
  v_lshl_add_u32 v242, v243, 4, v242
  s_lshl_b32 s100, s28, 12
  s_add_u32 s100, s100, 147456
  v_lshrrev_b32 v243, 4, v0
  v_lshlrev_b32 v243, 10, v243
  v_bfe_u32 v244, v0, 2, 2
  v_lshl_add_u32 v243, v244, 7, v243
  v_and_b32 v244, 3, v0
  v_lshl_add_u32 v243, v244, 3, v243
  v_add_u32 v243, s100, v243
  v_lshlrev_b32 v244, 4, v0
  s_waitcnt lgkmcnt(2)
  v_mfma_f32_32x32x16_bf16 v[96:111], v[32:35], v[192:195], v[160:175]
  ds_read_b128 v[44:47], v19 offset:0
  v_exp_f32 v56, v64
  v_exp_f32 v57, v65
  v_exp_f32 v58, v66
  v_mfma_f32_32x32x16_bf16 v[112:127], v[32:35], v[196:199], v[176:191]
  v_exp_f32 v59, v67
  v_add_f32 v226, v56, v57
  v_cvt_pk_bf16_f32 v128, v56, v57
  v_exp_f32 v60, v68
  s_waitcnt lgkmcnt(2)
  v_mfma_f32_32x32x16_bf16 v[96:111], v[36:39], v[200:203], v[96:111]
  ds_read_b128 v[48:51], v16 offset:128
  v_exp_f32 v61, v69
  v_add_f32 v226, v226, v58
  v_add_f32 v226, v226, v59
  v_mfma_f32_32x32x16_bf16 v[112:127], v[36:39], v[204:207], v[112:127]
  s_waitcnt vmcnt(21)
  s_barrier
  v_cvt_pk_bf16_f32 v129, v58, v59
  v_exp_f32 v62, v70
  v_exp_f32 v63, v71
  v_add_f32 v226, v226, v60
  s_waitcnt lgkmcnt(2)
  v_mfma_f32_32x32x16_bf16 v[96:111], v[40:43], v[208:211], v[96:111]
  ds_read_b128 v[52:55], v17 offset:128
  s_mov_b32 m0, s33
  s_nop 0
  buffer_load_dwordx4 v1, s[12:15], s31 offen nt lds
  v_add_f32 v226, v226, v61
  v_cvt_pk_bf16_f32 v130, v60, v61
  v_exp_f32 v56, v72
  v_exp_f32 v57, v73
  v_mfma_f32_32x32x16_bf16 v[112:127], v[40:43], v[212:215], v[112:127]
  v_add_f32 v226, v226, v62
  v_add_f32 v226, v226, v63
  v_cvt_pk_bf16_f32 v131, v62, v63
  v_exp_f32 v58, v74
  s_waitcnt lgkmcnt(2)
  v_mfma_f32_32x32x16_bf16 v[96:111], v[44:47], v[216:219], v[96:111]
  ds_read_b128 v[32:35], v18 offset:128
  buffer_load_dwordx4 v2, s[12:15], s31 offen offset:1024 nt lds
  v_exp_f32 v59, v75
  v_add_f32 v226, v226, v56
  v_add_f32 v226, v226, v57
  v_mfma_f32_32x32x16_bf16 v[112:127], v[44:47], v[220:223], v[112:127]
  v_cvt_pk_bf16_f32 v132, v56, v57
  v_exp_f32 v60, v76
  v_exp_f32 v61, v77
  v_add_f32 v226, v226, v58
  s_waitcnt lgkmcnt(2)
  v_mfma_f32_32x32x16_bf16 v[96:111], v[48:51], a[224:227], v[96:111]
  ds_read_b128 v[36:39], v19 offset:128
  buffer_load_dwordx4 v3, s[12:15], s31 offen offset:2048 nt lds
  v_add_f32 v226, v226, v59
  v_cvt_pk_bf16_f32 v133, v58, v59
  v_exp_f32 v62, v78
  v_exp_f32 v63, v79
  v_mfma_f32_32x32x16_bf16 v[112:127], v[48:51], a[228:231], v[112:127]
  v_add_f32 v226, v226, v60
  v_add_f32 v226, v226, v61
  v_cvt_pk_bf16_f32 v134, v60, v61
  v_exp_f32 v56, v80
  s_waitcnt lgkmcnt(2)
  v_mfma_f32_32x32x16_bf16 v[96:111], v[52:55], a[232:235], v[96:111]
  ds_read_b128 v[40:43], v16 offset:256
  s_add_u32 s31, s31, 12288
  s_add_u32 s33, s33, 12288
  s_cmp_ge_u32 s33, s45
  s_cselect_b32 s39, 73728, 0
  s_sub_u32 s33, s33, s39
  v_exp_f32 v57, v81
  v_add_f32 v226, v226, v62
  v_add_f32 v226, v226, v63
  v_cvt_pk_bf16_f32 v135, v62, v63
  v_mfma_f32_32x32x16_bf16 v[112:127], v[52:55], a[236:239], v[112:127]
  v_exp_f32 v58, v82
  v_exp_f32 v59, v83
  v_add_f32 v227, v56, v57
  s_waitcnt lgkmcnt(2)
  v_mfma_f32_32x32x16_bf16 v[96:111], v[32:35], a[240:243], v[96:111]
  ds_read_b128 v[44:47], v17 offset:256
  s_add_u32 s35, s35, 12288
  s_cmp_ge_u32 s35, 73728
  s_cselect_b32 s35, 0, s35
  v_add_u32 v22, s35, v10
  v_add_u32 v23, s35, v11
  v_add_u32 v24, s35, v12
  v_add_u32 v25, s35, v13
  v_cvt_pk_bf16_f32 v136, v56, v57
  v_exp_f32 v60, v84
  v_exp_f32 v61, v85
  v_mfma_f32_32x32x16_bf16 v[112:127], v[32:35], a[244:247], v[112:127]
  v_add_f32 v227, v227, v58
  v_add_f32 v227, v227, v59
  v_cvt_pk_bf16_f32 v137, v58, v59
  v_exp_f32 v62, v86
  s_waitcnt lgkmcnt(2)
  v_mfma_f32_32x32x16_bf16 v[96:111], v[36:39], a[248:251], v[96:111]
  ds_read_b128 v[48:51], v18 offset:256
  s_add_u32 s36, s36, 12288
  s_cmp_ge_u32 s36, 147456
  s_cselect_b32 s36, 73728, s36
  v_add_u32 v26, s36, v14
  v_add_u32 v27, s36, v15
  v_exp_f32 v63, v87
  v_add_f32 v227, v227, v60
  v_add_f32 v227, v227, v61
  v_cvt_pk_bf16_f32 v138, v60, v61
  v_exp_f32 v56, v88
  v_mfma_f32_32x32x16_bf16 v[112:127], v[36:39], a[252:255], v[112:127]
  v_exp_f32 v57, v89
  v_add_f32 v227, v227, v62
  v_add_f32 v227, v227, v63
  s_waitcnt lgkmcnt(2)
  v_mfma_f32_32x32x16_bf16 v[96:111], v[40:43], a[192:195], v[96:111]
  ds_read_b128 v[52:55], v19 offset:256
  v_cvt_pk_bf16_f32 v139, v62, v63
  v_exp_f32 v58, v90
  v_exp_f32 v59, v91
  v_mfma_f32_32x32x16_bf16 v[112:127], v[40:43], a[196:199], v[112:127]
  v_add_f32 v227, v227, v56
  v_add_f32 v227, v227, v57
  v_cvt_pk_bf16_f32 v140, v56, v57
  v_exp_f32 v60, v92
  v_exp_f32 v61, v93
  s_waitcnt lgkmcnt(2)
  v_mfma_f32_32x32x16_bf16 v[96:111], v[44:47], a[200:203], v[96:111]
  ds_read_b128 v[32:35], v22 offset:0
  v_add_f32 v227, v227, v58
  v_add_f32 v227, v227, v59
  v_cvt_pk_bf16_f32 v141, v58, v59
  v_exp_f32 v62, v94
  v_mfma_f32_32x32x16_bf16 v[112:127], v[44:47], a[204:207], v[112:127]
  v_exp_f32 v63, v95
  v_add_f32 v227, v227, v60
  v_add_f32 v227, v227, v61
  s_waitcnt lgkmcnt(2)
  v_mfma_f32_32x32x16_bf16 v[96:111], v[48:51], a[208:211], v[96:111]
  ds_read_b128 v[36:39], v23 offset:0
  v_cvt_pk_bf16_f32 v142, v60, v61
  s_nop 0
  v_add_f32 v227, v227, v62
  v_add_f32 v227, v227, v63
  v_cvt_pk_bf16_f32 v143, v62, v63
  v_mfma_f32_32x32x16_bf16 v[112:127], v[48:51], a[212:215], v[112:127]
  s_waitcnt lgkmcnt(2)
  v_mfma_f32_32x32x16_bf16 v[96:111], v[52:55], a[216:219], v[96:111]
  ds_read_b64_tr_b16 v[40:41], v26 offset:0
  ds_read_b64_tr_b16 v[42:43], v26 offset:1536
  v_mfma_f32_32x32x16_bf16 v[112:127], v[52:55], a[220:223], v[112:127]
  v_add_f32 v224, v224, v226
  v_add_f32 v225, v225, v227
  s_nop 7
  s_mov_b32 s37, 15
A_LOOP:
  s_waitcnt lgkmcnt(3)
  v_mfma_f32_32x32x16_bf16 v[64:79], v[32:35], v[192:195], v[160:175]
  ds_read_b128 v[44:47], v24 offset:0
  v_exp_f32 v56, v96
  v_exp_f32 v57, v97
  v_mfma_f32_32x32x16_bf16 v[80:95], v[32:35], v[196:199], v[176:191]
  v_exp_f32 v58, v98
  s_waitcnt lgkmcnt(3)
  v_mfma_f32_32x32x16_bf16 v[64:79], v[36:39], v[200:203], v[64:79]
  ds_read_b64_tr_b16 v[48:49], v27 offset:0
  ds_read_b64_tr_b16 v[50:51], v27 offset:1536
  v_exp_f32 v59, v99
  v_mfma_f32_32x32x16_bf16 v[80:95], v[36:39], v[204:207], v[80:95]
  s_waitcnt vmcnt(18)
  s_barrier
  v_add_f32 v226, v56, v57
  v_cvt_pk_bf16_f32 v144, v56, v57
  s_waitcnt lgkmcnt(3)
  v_mfma_f32_32x32x16_bf16 a[0:15], v[40:43], v[128:131], a[0:15]
  ds_read_b128 v[52:55], v25 offset:0
  s_mov_b32 m0, s33
  s_nop 0
  buffer_load_dwordx4 v1, s[12:15], s31 offen nt lds
  v_exp_f32 v60, v100
  v_exp_f32 v61, v101
  v_mfma_f32_32x32x16_bf16 a[16:31], v[40:43], v[136:139], a[16:31]
  v_add_f32 v226, v226, v58
  s_waitcnt lgkmcnt(3)
  v_mfma_f32_32x32x16_bf16 v[64:79], v[44:47], v[208:211], v[64:79]
  ds_read_b64_tr_b16 v[32:33], v26 offset:128
  ds_read_b64_tr_b16 v[34:35], v26 offset:1664
  v_add_f32 v226, v226, v59
  v_cvt_pk_bf16_f32 v145, v58, v59
  v_exp_f32 v62, v102
  v_mfma_f32_32x32x16_bf16 v[80:95], v[44:47], v[212:215], v[80:95]
  v_exp_f32 v63, v103
  s_waitcnt lgkmcnt(3)
  v_mfma_f32_32x32x16_bf16 a[32:47], v[48:51], v[128:131], a[32:47]
  ds_read_b128 v[36:39], v22 offset:128
  buffer_load_dwordx4 v2, s[12:15], s31 offen offset:1024 nt lds
  v_add_f32 v226, v226, v60
  v_add_f32 v226, v226, v61
  v_mfma_f32_32x32x16_bf16 a[48:63], v[48:51], v[136:139], a[48:63]
  v_cvt_pk_bf16_f32 v146, v60, v61
  v_exp_f32 v56, v104
  s_waitcnt lgkmcnt(3)
  v_mfma_f32_32x32x16_bf16 v[64:79], v[52:55], v[216:219], v[64:79]
  ds_read_b64_tr_b16 v[40:41], v27 offset:128
  ds_read_b64_tr_b16 v[42:43], v27 offset:1664
  v_exp_f32 v57, v105
  v_mfma_f32_32x32x16_bf16 v[80:95], v[52:55], v[220:223], v[80:95]
  v_add_f32 v226, v226, v62
  v_add_f32 v226, v226, v63
  s_waitcnt lgkmcnt(3)
  v_mfma_f32_32x32x16_bf16 a[64:79], v[32:35], v[128:131], a[64:79]
  ds_read_b128 v[44:47], v23 offset:128
  buffer_load_dwordx4 v3, s[12:15], s31 offen offset:2048 nt lds
  v_cvt_pk_bf16_f32 v147, v62, v63
  v_exp_f32 v58, v106
  v_mfma_f32_32x32x16_bf16 a[80:95], v[32:35], v[136:139], a[80:95]
  v_exp_f32 v59, v107
  s_waitcnt lgkmcnt(3)
  v_mfma_f32_32x32x16_bf16 v[64:79], v[36:39], a[224:227], v[64:79]
  ds_read_b64_tr_b16 v[48:49], v26 offset:256
  ds_read_b64_tr_b16 v[50:51], v26 offset:1792
  v_add_f32 v226, v226, v56
  v_add_f32 v226, v226, v57
  v_mfma_f32_32x32x16_bf16 v[80:95], v[36:39], a[228:231], v[80:95]
  v_cvt_pk_bf16_f32 v148, v56, v57
  v_exp_f32 v60, v108
  s_waitcnt lgkmcnt(3)
  v_mfma_f32_32x32x16_bf16 a[96:111], v[40:43], v[128:131], a[96:111]
  ds_read_b128 v[52:55], v24 offset:128
  s_add_u32 s31, s31, 12288
  s_add_u32 s33, s33, 12288
  s_cmp_ge_u32 s33, s45
  s_cselect_b32 s39, 73728, 0
  s_sub_u32 s33, s33, s39
  v_exp_f32 v61, v109
  v_mfma_f32_32x32x16_bf16 a[112:127], v[40:43], v[136:139], a[112:127]
  v_add_f32 v226, v226, v58
  v_add_f32 v226, v226, v59
  v_cvt_pk_bf16_f32 v149, v58, v59
  s_waitcnt lgkmcnt(3)
  v_mfma_f32_32x32x16_bf16 v[64:79], v[44:47], a[232:235], v[64:79]
  ds_read_b64_tr_b16 v[32:33], v27 offset:256
  ds_read_b64_tr_b16 v[34:35], v27 offset:1792
  v_exp_f32 v62, v110
  v_mfma_f32_32x32x16_bf16 v[80:95], v[44:47], a[236:239], v[80:95]
  v_exp_f32 v63, v111
  v_add_f32 v226, v226, v60
  s_waitcnt lgkmcnt(3)
  v_mfma_f32_32x32x16_bf16 a[128:143], v[48:51], v[128:131], a[128:143]
  ds_read_b128 v[36:39], v25 offset:128
  s_mov_b32 m0, s34
  s_nop 0
  buffer_load_dwordx4 v4, s[16:19], s32 offen nt lds
  v_add_f32 v226, v226, v61
  v_cvt_pk_bf16_f32 v150, v60, v61
  v_mfma_f32_32x32x16_bf16 a[144:159], v[48:51], v[136:139], a[144:159]
  v_exp_f32 v56, v112
  v_exp_f32 v57, v113
  s_waitcnt lgkmcnt(3)
  v_mfma_f32_32x32x16_bf16 v[64:79], v[52:55], a[240:243], v[64:79]
  ds_read_b64_tr_b16 v[40:41], v26 offset:6144
  ds_read_b64_tr_b16 v[42:43], v26 offset:7680
  v_add_f32 v226, v226, v62
  v_mfma_f32_32x32x16_bf16 v[80:95], v[52:55], a[244:247], v[80:95]
  v_add_f32 v226, v226, v63
  v_cvt_pk_bf16_f32 v151, v62, v63
  v_exp_f32 v58, v114
  s_waitcnt lgkmcnt(3)
  v_mfma_f32_32x32x16_bf16 a[160:175], v[32:35], v[128:131], a[160:175]
  ds_read_b128 v[44:47], v22 offset:256
  buffer_load_dwordx4 v5, s[16:19], s32 offen offset:1024 nt lds
  v_exp_f32 v59, v115
  v_mfma_f32_32x32x16_bf16 a[176:191], v[32:35], v[136:139], a[176:191]
  v_add_f32 v227, v56, v57
  v_cvt_pk_bf16_f32 v152, v56, v57
  s_waitcnt lgkmcnt(3)
  v_mfma_f32_32x32x16_bf16 v[64:79], v[36:39], a[248:251], v[64:79]
  ds_read_b64_tr_b16 v[48:49], v27 offset:6144
  ds_read_b64_tr_b16 v[50:51], v27 offset:7680
  v_exp_f32 v60, v116
  v_mfma_f32_32x32x16_bf16 v[80:95], v[36:39], a[252:255], v[80:95]
  v_exp_f32 v61, v117
  v_add_f32 v227, v227, v58
  s_waitcnt lgkmcnt(3)
  v_mfma_f32_32x32x16_bf16 a[0:15], v[40:43], v[132:135], a[0:15]
  ds_read_b128 v[52:55], v23 offset:256
  buffer_load_dwordx4 v6, s[16:19], s32 offen offset:2048 nt lds
  v_add_f32 v227, v227, v59
  v_cvt_pk_bf16_f32 v153, v58, v59
  v_mfma_f32_32x32x16_bf16 a[16:31], v[40:43], v[140:143], a[16:31]
  v_exp_f32 v62, v118
  s_waitcnt lgkmcnt(3)
  v_mfma_f32_32x32x16_bf16 v[64:79], v[44:47], a[192:195], v[64:79]
  ds_read_b64_tr_b16 v[32:33], v26 offset:6272
  ds_read_b64_tr_b16 v[34:35], v26 offset:7808
  v_exp_f32 v63, v119
  v_add_f32 v227, v227, v60
  v_mfma_f32_32x32x16_bf16 v[80:95], v[44:47], a[196:199], v[80:95]
  v_add_f32 v227, v227, v61
  v_cvt_pk_bf16_f32 v154, v60, v61
  s_waitcnt lgkmcnt(3)
  v_mfma_f32_32x32x16_bf16 a[32:47], v[48:51], v[132:135], a[32:47]
  ds_read_b128 v[36:39], v24 offset:256
  s_add_u32 s32, s32, 12288
  s_add_u32 s34, s34, 12288
  s_cmp_ge_u32 s34, s46
  s_cselect_b32 s39, 73728, 0
  s_sub_u32 s34, s34, s39
  v_exp_f32 v56, v120
  v_exp_f32 v57, v121
  v_mfma_f32_32x32x16_bf16 a[48:63], v[48:51], v[140:143], a[48:63]
  v_add_f32 v227, v227, v62
  s_waitcnt lgkmcnt(3)
  v_mfma_f32_32x32x16_bf16 v[64:79], v[52:55], a[200:203], v[64:79]
  ds_read_b64_tr_b16 v[40:41], v27 offset:6272
  ds_read_b64_tr_b16 v[42:43], v27 offset:7808
  v_add_f32 v227, v227, v63
  v_cvt_pk_bf16_f32 v155, v62, v63
  v_exp_f32 v58, v122
  v_mfma_f32_32x32x16_bf16 v[80:95], v[52:55], a[204:207], v[80:95]
  v_exp_f32 v59, v123
  s_waitcnt lgkmcnt(3)
  v_mfma_f32_32x32x16_bf16 a[64:79], v[32:35], v[132:135], a[64:79]
  ds_read_b128 v[44:47], v25 offset:256
  s_add_u32 s35, s35, 12288
  s_cmp_ge_u32 s35, 73728
  s_cselect_b32 s35, 0, s35
  v_add_u32 v16, s35, v10
  v_add_u32 v17, s35, v11
  v_add_u32 v18, s35, v12
  v_add_u32 v19, s35, v13
  v_add_f32 v227, v227, v56
  v_add_f32 v227, v227, v57
  v_mfma_f32_32x32x16_bf16 a[80:95], v[32:35], v[140:143], a[80:95]
  v_cvt_pk_bf16_f32 v156, v56, v57
  v_exp_f32 v60, v124
  s_waitcnt lgkmcnt(3)
  v_mfma_f32_32x32x16_bf16 v[64:79], v[36:39], a[208:211], v[64:79]
  ds_read_b64_tr_b16 v[48:49], v26 offset:6400
  ds_read_b64_tr_b16 v[50:51], v26 offset:7936
  s_add_u32 s36, s36, 12288
  s_cmp_ge_u32 s36, 147456
  s_cselect_b32 s36, 73728, s36
  v_add_u32 v20, s36, v14
  v_add_u32 v21, s36, v15
  v_exp_f32 v61, v125
  v_mfma_f32_32x32x16_bf16 v[80:95], v[36:39], a[212:215], v[80:95]
  v_add_f32 v227, v227, v58
  v_add_f32 v227, v227, v59
  s_waitcnt lgkmcnt(3)
  v_mfma_f32_32x32x16_bf16 a[96:111], v[40:43], v[132:135], a[96:111]
  ds_read_b64_tr_b16 v[52:53], v27 offset:6400
  ds_read_b64_tr_b16 v[54:55], v27 offset:7936
  v_cvt_pk_bf16_f32 v157, v58, v59
  v_exp_f32 v62, v126
  v_mfma_f32_32x32x16_bf16 a[112:127], v[40:43], v[140:143], a[112:127]
  v_exp_f32 v63, v127
  s_waitcnt lgkmcnt(4)
  v_mfma_f32_32x32x16_bf16 v[64:79], v[44:47], a[216:219], v[64:79]
  ds_read_b128 v[32:35], v16 offset:0
  v_add_f32 v227, v227, v60
  v_add_f32 v227, v227, v61
  v_cvt_pk_bf16_f32 v158, v60, v61
  v_mfma_f32_32x32x16_bf16 v[80:95], v[44:47], a[220:223], v[80:95]
  s_nop 0
  v_add_f32 v227, v227, v62
  s_waitcnt lgkmcnt(3)
  v_mfma_f32_32x32x16_bf16 a[128:143], v[48:51], v[132:135], a[128:143]
  ds_read_b128 v[36:39], v17 offset:0
  v_add_f32 v227, v227, v63
  v_cvt_pk_bf16_f32 v159, v62, v63
  v_mfma_f32_32x32x16_bf16 a[144:159], v[48:51], v[140:143], a[144:159]
  s_waitcnt lgkmcnt(2)
  v_mfma_f32_32x32x16_bf16 a[160:175], v[52:55], v[132:135], a[160:175]
  ds_read_b64_tr_b16 v[40:41], v20 offset:0
  ds_read_b64_tr_b16 v[42:43], v20 offset:1536
  v_mfma_f32_32x32x16_bf16 a[176:191], v[52:55], v[140:143], a[176:191]
  v_max_f32 v228, v226, v227
  v_cmp_lt_f32 vcc, s38, v228
  s_cbranch_vccnz RARE1
RARE1_ret:
  v_add_f32 v224, v224, v226
  v_add_f32 v225, v225, v227
  s_waitcnt lgkmcnt(3)
  v_mfma_f32_32x32x16_bf16 v[96:111], v[32:35], v[192:195], v[160:175]
  ds_read_b128 v[44:47], v18 offset:0
  v_exp_f32 v56, v64
  v_exp_f32 v57, v65
  v_mfma_f32_32x32x16_bf16 v[112:127], v[32:35], v[196:199], v[176:191]
  v_exp_f32 v58, v66
  s_waitcnt lgkmcnt(3)
  v_mfma_f32_32x32x16_bf16 v[96:111], v[36:39], v[200:203], v[96:111]
  ds_read_b64_tr_b16 v[48:49], v21 offset:0
  ds_read_b64_tr_b16 v[50:51], v21 offset:1536
  v_exp_f32 v59, v67
  v_mfma_f32_32x32x16_bf16 v[112:127], v[36:39], v[204:207], v[112:127]
  s_waitcnt vmcnt(18)
  s_barrier
  v_add_f32 v226, v56, v57
  v_cvt_pk_bf16_f32 v128, v56, v57
  s_waitcnt lgkmcnt(3)
  v_mfma_f32_32x32x16_bf16 a[0:15], v[40:43], v[144:147], a[0:15]
  ds_read_b128 v[52:55], v19 offset:0
  s_mov_b32 m0, s33
  s_nop 0
  buffer_load_dwordx4 v1, s[12:15], s31 offen nt lds
  v_exp_f32 v60, v68
  v_exp_f32 v61, v69
  v_mfma_f32_32x32x16_bf16 a[16:31], v[40:43], v[152:155], a[16:31]
  v_add_f32 v226, v226, v58
  s_waitcnt lgkmcnt(3)
  v_mfma_f32_32x32x16_bf16 v[96:111], v[44:47], v[208:211], v[96:111]
  ds_read_b64_tr_b16 v[32:33], v20 offset:128
  ds_read_b64_tr_b16 v[34:35], v20 offset:1664
  v_add_f32 v226, v226, v59
  v_cvt_pk_bf16_f32 v129, v58, v59
  v_exp_f32 v62, v70
  v_mfma_f32_32x32x16_bf16 v[112:127], v[44:47], v[212:215], v[112:127]
  v_exp_f32 v63, v71
  s_waitcnt lgkmcnt(3)
  v_mfma_f32_32x32x16_bf16 a[32:47], v[48:51], v[144:147], a[32:47]
  ds_read_b128 v[36:39], v16 offset:128
  buffer_load_dwordx4 v2, s[12:15], s31 offen offset:1024 nt lds
  v_add_f32 v226, v226, v60
  v_add_f32 v226, v226, v61
  v_mfma_f32_32x32x16_bf16 a[48:63], v[48:51], v[152:155], a[48:63]
  v_cvt_pk_bf16_f32 v130, v60, v61
  v_exp_f32 v56, v72
  s_waitcnt lgkmcnt(3)
  v_mfma_f32_32x32x16_bf16 v[96:111], v[52:55], v[216:219], v[96:111]
  ds_read_b64_tr_b16 v[40:41], v21 offset:128
  ds_read_b64_tr_b16 v[42:43], v21 offset:1664
  v_exp_f32 v57, v73
  v_mfma_f32_32x32x16_bf16 v[112:127], v[52:55], v[220:223], v[112:127]
  v_add_f32 v226, v226, v62
  v_add_f32 v226, v226, v63
  s_waitcnt lgkmcnt(3)
  v_mfma_f32_32x32x16_bf16 a[64:79], v[32:35], v[144:147], a[64:79]
  ds_read_b128 v[44:47], v17 offset:128
  buffer_load_dwordx4 v3, s[12:15], s31 offen offset:2048 nt lds
  v_cvt_pk_bf16_f32 v131, v62, v63
  v_exp_f32 v58, v74
  v_mfma_f32_32x32x16_bf16 a[80:95], v[32:35], v[152:155], a[80:95]
  v_exp_f32 v59, v75
  s_waitcnt lgkmcnt(3)
  v_mfma_f32_32x32x16_bf16 v[96:111], v[36:39], a[224:227], v[96:111]
  ds_read_b64_tr_b16 v[48:49], v20 offset:256
  ds_read_b64_tr_b16 v[50:51], v20 offset:1792
  v_add_f32 v226, v226, v56
  v_add_f32 v226, v226, v57
  v_mfma_f32_32x32x16_bf16 v[112:127], v[36:39], a[228:231], v[112:127]
  v_cvt_pk_bf16_f32 v132, v56, v57
  v_exp_f32 v60, v76
  s_waitcnt lgkmcnt(3)
  v_mfma_f32_32x32x16_bf16 a[96:111], v[40:43], v[144:147], a[96:111]
  ds_read_b128 v[52:55], v18 offset:128
  s_add_u32 s31, s31, 12288
  s_add_u32 s33, s33, 12288
  s_cmp_ge_u32 s33, s45
  s_cselect_b32 s39, 73728, 0
  s_sub_u32 s33, s33, s39
  v_exp_f32 v61, v77
  v_mfma_f32_32x32x16_bf16 a[112:127], v[40:43], v[152:155], a[112:127]
  v_add_f32 v226, v226, v58
  v_add_f32 v226, v226, v59
  v_cvt_pk_bf16_f32 v133, v58, v59
  s_waitcnt lgkmcnt(3)
  v_mfma_f32_32x32x16_bf16 v[96:111], v[44:47], a[232:235], v[96:111]
  ds_read_b64_tr_b16 v[32:33], v21 offset:256
  ds_read_b64_tr_b16 v[34:35], v21 offset:1792
  v_exp_f32 v62, v78
  v_mfma_f32_32x32x16_bf16 v[112:127], v[44:47], a[236:239], v[112:127]
  v_exp_f32 v63, v79
  v_add_f32 v226, v226, v60
  s_waitcnt lgkmcnt(3)
  v_mfma_f32_32x32x16_bf16 a[128:143], v[48:51], v[144:147], a[128:143]
  ds_read_b128 v[36:39], v19 offset:128
  s_mov_b32 m0, s34
  s_nop 0
  buffer_load_dwordx4 v4, s[16:19], s32 offen nt lds
  v_add_f32 v226, v226, v61
  v_cvt_pk_bf16_f32 v134, v60, v61
  v_mfma_f32_32x32x16_bf16 a[144:159], v[48:51], v[152:155], a[144:159]
  v_exp_f32 v56, v80
  v_exp_f32 v57, v81
  s_waitcnt lgkmcnt(3)
  v_mfma_f32_32x32x16_bf16 v[96:111], v[52:55], a[240:243], v[96:111]
  ds_read_b64_tr_b16 v[40:41], v20 offset:6144
  ds_read_b64_tr_b16 v[42:43], v20 offset:7680
  v_add_f32 v226, v226, v62
  v_mfma_f32_32x32x16_bf16 v[112:127], v[52:55], a[244:247], v[112:127]
  v_add_f32 v226, v226, v63
  v_cvt_pk_bf16_f32 v135, v62, v63
  v_exp_f32 v58, v82
  s_waitcnt lgkmcnt(3)
  v_mfma_f32_32x32x16_bf16 a[160:175], v[32:35], v[144:147], a[160:175]
  ds_read_b128 v[44:47], v16 offset:256
  buffer_load_dwordx4 v5, s[16:19], s32 offen offset:1024 nt lds
  v_exp_f32 v59, v83
  v_mfma_f32_32x32x16_bf16 a[176:191], v[32:35], v[152:155], a[176:191]
  v_add_f32 v227, v56, v57
  v_cvt_pk_bf16_f32 v136, v56, v57
  s_waitcnt lgkmcnt(3)
  v_mfma_f32_32x32x16_bf16 v[96:111], v[36:39], a[248:251], v[96:111]
  ds_read_b64_tr_b16 v[48:49], v21 offset:6144
  ds_read_b64_tr_b16 v[50:51], v21 offset:7680
  v_exp_f32 v60, v84
  v_mfma_f32_32x32x16_bf16 v[112:127], v[36:39], a[252:255], v[112:127]
  v_exp_f32 v61, v85
  v_add_f32 v227, v227, v58
  s_waitcnt lgkmcnt(3)
  v_mfma_f32_32x32x16_bf16 a[0:15], v[40:43], v[148:151], a[0:15]
  ds_read_b128 v[52:55], v17 offset:256
  buffer_load_dwordx4 v6, s[16:19], s32 offen offset:2048 nt lds
  v_add_f32 v227, v227, v59
  v_cvt_pk_bf16_f32 v137, v58, v59
  v_mfma_f32_32x32x16_bf16 a[16:31], v[40:43], v[156:159], a[16:31]
  v_exp_f32 v62, v86
  s_waitcnt lgkmcnt(3)
  v_mfma_f32_32x32x16_bf16 v[96:111], v[44:47], a[192:195], v[96:111]
  ds_read_b64_tr_b16 v[32:33], v20 offset:6272
  ds_read_b64_tr_b16 v[34:35], v20 offset:7808
  v_exp_f32 v63, v87
  v_add_f32 v227, v227, v60
  v_mfma_f32_32x32x16_bf16 v[112:127], v[44:47], a[196:199], v[112:127]
  v_add_f32 v227, v227, v61
  v_cvt_pk_bf16_f32 v138, v60, v61
  s_waitcnt lgkmcnt(3)
  v_mfma_f32_32x32x16_bf16 a[32:47], v[48:51], v[148:151], a[32:47]
  ds_read_b128 v[36:39], v18 offset:256
  s_add_u32 s32, s32, 12288
  s_add_u32 s34, s34, 12288
  s_cmp_ge_u32 s34, s46
  s_cselect_b32 s39, 73728, 0
  s_sub_u32 s34, s34, s39
  v_exp_f32 v56, v88
  v_exp_f32 v57, v89
  v_mfma_f32_32x32x16_bf16 a[48:63], v[48:51], v[156:159], a[48:63]
  v_add_f32 v227, v227, v62
  s_waitcnt lgkmcnt(3)
  v_mfma_f32_32x32x16_bf16 v[96:111], v[52:55], a[200:203], v[96:111]
  ds_read_b64_tr_b16 v[40:41], v21 offset:6272
  ds_read_b64_tr_b16 v[42:43], v21 offset:7808
  v_add_f32 v227, v227, v63
  v_cvt_pk_bf16_f32 v139, v62, v63
  v_exp_f32 v58, v90
  v_mfma_f32_32x32x16_bf16 v[112:127], v[52:55], a[204:207], v[112:127]
  v_exp_f32 v59, v91
  s_waitcnt lgkmcnt(3)
  v_mfma_f32_32x32x16_bf16 a[64:79], v[32:35], v[148:151], a[64:79]
  ds_read_b128 v[44:47], v19 offset:256
  s_add_u32 s35, s35, 12288
  s_cmp_ge_u32 s35, 73728
  s_cselect_b32 s35, 0, s35
  v_add_u32 v22, s35, v10
  v_add_u32 v23, s35, v11
  v_add_u32 v24, s35, v12
  v_add_u32 v25, s35, v13
  v_add_f32 v227, v227, v56
  v_add_f32 v227, v227, v57
  v_mfma_f32_32x32x16_bf16 a[80:95], v[32:35], v[156:159], a[80:95]
  v_cvt_pk_bf16_f32 v140, v56, v57
  v_exp_f32 v60, v92
  s_waitcnt lgkmcnt(3)
  v_mfma_f32_32x32x16_bf16 v[96:111], v[36:39], a[208:211], v[96:111]
  ds_read_b64_tr_b16 v[48:49], v20 offset:6400
  ds_read_b64_tr_b16 v[50:51], v20 offset:7936
  s_add_u32 s36, s36, 12288
  s_cmp_ge_u32 s36, 147456
  s_cselect_b32 s36, 73728, s36
  v_add_u32 v26, s36, v14
  v_add_u32 v27, s36, v15
  v_exp_f32 v61, v93
  v_mfma_f32_32x32x16_bf16 v[112:127], v[36:39], a[212:215], v[112:127]
  v_add_f32 v227, v227, v58
  v_add_f32 v227, v227, v59
  s_waitcnt lgkmcnt(3)
  v_mfma_f32_32x32x16_bf16 a[96:111], v[40:43], v[148:151], a[96:111]
  ds_read_b64_tr_b16 v[52:53], v21 offset:6400
  ds_read_b64_tr_b16 v[54:55], v21 offset:7936
  v_cvt_pk_bf16_f32 v141, v58, v59
  v_exp_f32 v62, v94
  v_mfma_f32_32x32x16_bf16 a[112:127], v[40:43], v[156:159], a[112:127]
  v_exp_f32 v63, v95
  s_waitcnt lgkmcnt(4)
  v_mfma_f32_32x32x16_bf16 v[96:111], v[44:47], a[216:219], v[96:111]
  ds_read_b128 v[32:35], v22 offset:0
  v_add_f32 v227, v227, v60
  v_add_f32 v227, v227, v61
  v_cvt_pk_bf16_f32 v142, v60, v61
  v_mfma_f32_32x32x16_bf16 v[112:127], v[44:47], a[220:223], v[112:127]
  s_nop 0
  v_add_f32 v227, v227, v62
  s_waitcnt lgkmcnt(3)
  v_mfma_f32_32x32x16_bf16 a[128:143], v[48:51], v[148:151], a[128:143]
  ds_read_b128 v[36:39], v23 offset:0
  v_add_f32 v227, v227, v63
  v_cvt_pk_bf16_f32 v143, v62, v63
  v_mfma_f32_32x32x16_bf16 a[144:159], v[48:51], v[156:159], a[144:159]
  s_waitcnt lgkmcnt(2)
  v_mfma_f32_32x32x16_bf16 a[160:175], v[52:55], v[148:151], a[160:175]
  ds_read_b64_tr_b16 v[40:41], v26 offset:0
  ds_read_b64_tr_b16 v[42:43], v26 offset:1536
  v_mfma_f32_32x32x16_bf16 a[176:191], v[52:55], v[156:159], a[176:191]
  v_max_f32 v228, v226, v227
  v_cmp_lt_f32 vcc, s38, v228
  s_cbranch_vccnz RARE0
RARE0_ret:
  v_add_f32 v224, v224, v226
  v_add_f32 v225, v225, v227
  s_cmp_eq_u32 s37, 13
  s_cbranch_scc1 PK0
PK0_ret:
  s_cmp_eq_u32 s37, 9
  s_cbranch_scc1 PK1
PK1_ret:
  s_cmp_eq_u32 s37, 5
  s_cbranch_scc1 PK2
PK2_ret:
  s_sub_u32 s37, s37, 1
  s_cmp_lg_u32 s37, 0
  s_cbranch_scc1 A_LOOP
  s_waitcnt lgkmcnt(0)
  ds_read_b64_tr_b16 v[32:33], v26 offset:0
  ds_read_b64_tr_b16 v[34:35], v26 offset:1536
  ds_read_b64_tr_b16 v[36:37], v27 offset:0
  ds_read_b64_tr_b16 v[38:39], v27 offset:1536
  ds_read_b64_tr_b16 v[40:41], v26 offset:128
  ds_read_b64_tr_b16 v[42:43], v26 offset:1664
  s_mov_b32 s48, s24
  s_mov_b32 s49, s25
  s_mov_b32 s50, s26
  s_mov_b32 s51, s27
  s_cmp_ge_u32 s2, 240
  s_cselect_b32 s50, 0, s50
  s_waitcnt lgkmcnt(4)
  v_mfma_f32_32x32x16_bf16 a[0:15], v[32:35], v[128:131], a[0:15]
  ds_read_b64_tr_b16 v[44:45], v27 offset:128
  ds_read_b64_tr_b16 v[46:47], v27 offset:1664
  v_exp_f32 v56, v96
  v_exp_f32 v57, v97
  v_exp_f32 v58, v98
  v_mfma_f32_32x32x16_bf16 a[16:31], v[32:35], v[136:139], a[16:31]
  v_exp_f32 v59, v99
  v_add_f32 v226, v56, v57
  v_cvt_pk_bf16_f32 v144, v56, v57
  v_exp_f32 v60, v100
  s_waitcnt lgkmcnt(4)
  v_mfma_f32_32x32x16_bf16 a[32:47], v[36:39], v[128:131], a[32:47]
  ds_read_b64_tr_b16 v[48:49], v26 offset:256
  ds_read_b64_tr_b16 v[50:51], v26 offset:1792
  v_exp_f32 v61, v101
  v_add_f32 v226, v226, v58
  v_add_f32 v226, v226, v59
  v_mfma_f32_32x32x16_bf16 a[48:63], v[36:39], v[136:139], a[48:63]
  s_waitcnt vmcnt(0)
  s_barrier
  v_cvt_pk_bf16_f32 v145, v58, v59
  v_exp_f32 v62, v102
  v_exp_f32 v63, v103
  v_add_f32 v226, v226, v60
  s_waitcnt lgkmcnt(4)
  v_mfma_f32_32x32x16_bf16 a[64:79], v[40:43], v[128:131], a[64:79]
  ds_read_b64_tr_b16 v[52:53], v27 offset:256
  ds_read_b64_tr_b16 v[54:55], v27 offset:1792
  v_add_f32 v226, v226, v61
  v_cvt_pk_bf16_f32 v146, v60, v61
  v_exp_f32 v56, v104
  v_exp_f32 v57, v105
  v_mfma_f32_32x32x16_bf16 a[80:95], v[40:43], v[136:139], a[80:95]
  v_add_f32 v226, v226, v62
  v_add_f32 v226, v226, v63
  v_cvt_pk_bf16_f32 v147, v62, v63
  v_exp_f32 v58, v106
  s_waitcnt lgkmcnt(4)
  v_mfma_f32_32x32x16_bf16 a[96:111], v[44:47], v[128:131], a[96:111]
  ds_read_b64_tr_b16 v[32:33], v26 offset:6144
  ds_read_b64_tr_b16 v[34:35], v26 offset:7680
  v_exp_f32 v59, v107
  v_add_f32 v226, v226, v56
  v_add_f32 v226, v226, v57
  v_mfma_f32_32x32x16_bf16 a[112:127], v[44:47], v[136:139], a[112:127]
  v_cvt_pk_bf16_f32 v148, v56, v57
  v_exp_f32 v60, v108
  v_exp_f32 v61, v109
  v_add_f32 v226, v226, v58
  s_waitcnt lgkmcnt(4)
  v_mfma_f32_32x32x16_bf16 a[128:143], v[48:51], v[128:131], a[128:143]
  ds_read_b64_tr_b16 v[36:37], v27 offset:6144
  ds_read_b64_tr_b16 v[38:39], v27 offset:7680
  v_add_f32 v226, v226, v59
  v_cvt_pk_bf16_f32 v149, v58, v59
  v_exp_f32 v62, v110
  v_exp_f32 v63, v111
  v_mfma_f32_32x32x16_bf16 a[144:159], v[48:51], v[136:139], a[144:159]
  v_add_f32 v226, v226, v60
  v_add_f32 v226, v226, v61
  v_cvt_pk_bf16_f32 v150, v60, v61
  v_exp_f32 v56, v112
  s_waitcnt lgkmcnt(4)
  v_mfma_f32_32x32x16_bf16 a[160:175], v[52:55], v[128:131], a[160:175]
  ds_read_b64_tr_b16 v[40:41], v26 offset:6272
  ds_read_b64_tr_b16 v[42:43], v26 offset:7808
  v_exp_f32 v57, v113
  v_add_f32 v226, v226, v62
  v_add_f32 v226, v226, v63
  v_cvt_pk_bf16_f32 v151, v62, v63
  v_mfma_f32_32x32x16_bf16 a[176:191], v[52:55], v[136:139], a[176:191]
  v_exp_f32 v58, v114
  v_exp_f32 v59, v115
  v_add_f32 v227, v56, v57
  s_waitcnt lgkmcnt(4)
  v_mfma_f32_32x32x16_bf16 a[0:15], v[32:35], v[132:135], a[0:15]
  ds_read_b64_tr_b16 v[44:45], v27 offset:6272
  ds_read_b64_tr_b16 v[46:47], v27 offset:7808
  v_cvt_pk_bf16_f32 v152, v56, v57
  v_exp_f32 v60, v116
  v_exp_f32 v61, v117
  v_mfma_f32_32x32x16_bf16 a[16:31], v[32:35], v[140:143], a[16:31]
  v_add_f32 v227, v227, v58
  v_add_f32 v227, v227, v59
  v_cvt_pk_bf16_f32 v153, v58, v59
  v_exp_f32 v62, v118
  s_waitcnt lgkmcnt(4)
  v_mfma_f32_32x32x16_bf16 a[32:47], v[36:39], v[132:135], a[32:47]
  ds_read_b64_tr_b16 v[48:49], v26 offset:6400
  ds_read_b64_tr_b16 v[50:51], v26 offset:7936
  s_add_u32 s36, s36, 12288
  s_cmp_ge_u32 s36, 147456
  s_cselect_b32 s36, 73728, s36
  v_add_u32 v20, s36, v14
  v_add_u32 v21, s36, v15
  v_exp_f32 v63, v119
  v_add_f32 v227, v227, v60
  v_add_f32 v227, v227, v61
  v_cvt_pk_bf16_f32 v154, v60, v61
  v_exp_f32 v56, v120
  v_mfma_f32_32x32x16_bf16 a[48:63], v[36:39], v[140:143], a[48:63]
  v_exp_f32 v57, v121
  v_add_f32 v227, v227, v62
  v_add_f32 v227, v227, v63
  s_waitcnt lgkmcnt(4)
  v_mfma_f32_32x32x16_bf16 a[64:79], v[40:43], v[132:135], a[64:79]
  ds_read_b64_tr_b16 v[52:53], v27 offset:6400
  ds_read_b64_tr_b16 v[54:55], v27 offset:7936
  v_cvt_pk_bf16_f32 v155, v62, v63
  v_exp_f32 v58, v122
  v_exp_f32 v59, v123
  v_mfma_f32_32x32x16_bf16 a[80:95], v[40:43], v[140:143], a[80:95]
  v_add_f32 v227, v227, v56
  v_add_f32 v227, v227, v57
  v_cvt_pk_bf16_f32 v156, v56, v57
  v_exp_f32 v60, v124
  v_exp_f32 v61, v125
  s_waitcnt lgkmcnt(4)
  v_mfma_f32_32x32x16_bf16 a[96:111], v[44:47], v[132:135], a[96:111]
  ds_read_b64_tr_b16 v[32:33], v20 offset:0
  ds_read_b64_tr_b16 v[34:35], v20 offset:1536
  v_add_f32 v227, v227, v58
  v_add_f32 v227, v227, v59
  v_cvt_pk_bf16_f32 v157, v58, v59
  v_exp_f32 v62, v126
  v_mfma_f32_32x32x16_bf16 a[112:127], v[44:47], v[140:143], a[112:127]
  v_exp_f32 v63, v127
  v_add_f32 v227, v227, v60
  v_add_f32 v227, v227, v61
  s_waitcnt lgkmcnt(4)
  v_mfma_f32_32x32x16_bf16 a[128:143], v[48:51], v[132:135], a[128:143]
  ds_read_b64_tr_b16 v[36:37], v20 offset:6144
  ds_read_b64_tr_b16 v[38:39], v20 offset:7680
  v_cvt_pk_bf16_f32 v158, v60, v61
  s_nop 0
  v_add_f32 v227, v227, v62
  v_add_f32 v227, v227, v63
  v_cvt_pk_bf16_f32 v159, v62, v63
  v_mfma_f32_32x32x16_bf16 a[144:159], v[48:51], v[140:143], a[144:159]
  s_waitcnt lgkmcnt(4)
  v_mfma_f32_32x32x16_bf16 a[160:175], v[52:55], v[132:135], a[160:175]
  ds_read_b64_tr_b16 v[40:41], v21 offset:0
  ds_read_b64_tr_b16 v[42:43], v21 offset:1536
  v_mfma_f32_32x32x16_bf16 a[176:191], v[52:55], v[140:143], a[176:191]
  v_max_f32 v228, v226, v227
  v_cmp_lt_f32 vcc, s38, v228
  s_cbranch_vccnz RARE2
RARE2_ret:
  v_add_f32 v224, v224, v226
  v_add_f32 v225, v225, v227
  s_waitcnt lgkmcnt(4)
  v_mfma_f32_32x32x16_bf16 a[0:15], v[32:35], v[144:147], a[0:15]
  ds_read_b64_tr_b16 v[44:45], v21 offset:6144
  ds_read_b64_tr_b16 v[46:47], v21 offset:7680
  v_mov_b32 v228, v224
  s_nop 1
  v_permlane32_swap_b32 v224, v228
  s_nop 1
  v_add_f32 v224, v224, v228
  v_rcp_f32 v224, v224
  v_mfma_f32_32x32x16_bf16 a[16:31], v[32:35], v[152:155], a[16:31]
  v_mov_b32 v229, v225
  s_nop 1
  v_permlane32_swap_b32 v225, v229
  s_nop 1
  v_add_f32 v225, v225, v229
  v_rcp_f32 v225, v225
  s_waitcnt lgkmcnt(4)
  v_mfma_f32_32x32x16_bf16 a[0:15], v[36:39], v[148:151], a[0:15]
  ds_read_b64_tr_b16 v[48:49], v20 offset:128
  ds_read_b64_tr_b16 v[50:51], v20 offset:1664
  v_lshrrev_b32 v235, 5, v0
  v_bfe_u32 v232, v0, 4, 1
  s_lshl_b32 s39, s28, 2
  v_add_u32 v232, s39, v232
  s_mov_b32 s44, 196608
  v_mul_lo_u32 v232, v232, s44
  v_mfma_f32_32x32x16_bf16 a[16:31], v[36:39], v[156:159], a[16:31]
  v_lshl_add_u32 v232, v235, 8, v232
  v_and_b32 v233, 15, v0
  v_lshl_add_u32 v240, v233, 4, v232
  v_add_u32 v241, 393216, v240
  s_mul_i32 s39, s29, 3145728
  s_mul_i32 s44, s30, 6144
  s_add_u32 s39, s39, s44
  s_add_u32 s44, s39, 4096
  s_waitcnt lgkmcnt(4)
  v_mfma_f32_32x32x16_bf16 a[32:47], v[40:43], v[144:147], a[32:47]
  ds_read_b64_tr_b16 v[52:53], v20 offset:6272
  ds_read_b64_tr_b16 v[54:55], v20 offset:7808
  v_accvgpr_read_b32 v64, a0
  v_accvgpr_read_b32 v65, a1
  v_accvgpr_read_b32 v66, a2
  v_accvgpr_read_b32 v67, a3
  v_accvgpr_read_b32 v68, a4
  v_accvgpr_read_b32 v69, a5
  v_accvgpr_read_b32 v70, a6
  v_accvgpr_read_b32 v71, a7
  v_pk_mul_f32 v[64:65], v[64:65], v[224:225] op_sel:[0,0] op_sel_hi:[1,0]
  v_pk_mul_f32 v[66:67], v[66:67], v[224:225] op_sel:[0,0] op_sel_hi:[1,0]
  v_pk_mul_f32 v[68:69], v[68:69], v[224:225] op_sel:[0,0] op_sel_hi:[1,0]
  v_pk_mul_f32 v[70:71], v[70:71], v[224:225] op_sel:[0,0] op_sel_hi:[1,0]
  v_cvt_pk_bf16_f32 v72, v64, v65
  v_cvt_pk_bf16_f32 v73, v66, v67
  v_cvt_pk_bf16_f32 v74, v68, v69
  v_cvt_pk_bf16_f32 v75, v70, v71
  buffer_store_dwordx4 v[72:75], v240, s[24:27], s39 offen offset:0 sc0 sc1
  v_mfma_f32_32x32x16_bf16 a[48:63], v[40:43], v[152:155], a[48:63]
  v_accvgpr_read_b32 v76, a8
  v_accvgpr_read_b32 v77, a9
  v_accvgpr_read_b32 v78, a10
  v_accvgpr_read_b32 v79, a11
  v_accvgpr_read_b32 v80, a12
  v_accvgpr_read_b32 v81, a13
  v_accvgpr_read_b32 v82, a14
  v_accvgpr_read_b32 v83, a15
  v_pk_mul_f32 v[76:77], v[76:77], v[224:225] op_sel:[0,0] op_sel_hi:[1,0]
  v_pk_mul_f32 v[78:79], v[78:79], v[224:225] op_sel:[0,0] op_sel_hi:[1,0]
  v_pk_mul_f32 v[80:81], v[80:81], v[224:225] op_sel:[0,0] op_sel_hi:[1,0]
  v_pk_mul_f32 v[82:83], v[82:83], v[224:225] op_sel:[0,0] op_sel_hi:[1,0]
  v_cvt_pk_bf16_f32 v84, v76, v77
  v_cvt_pk_bf16_f32 v85, v78, v79
  v_cvt_pk_bf16_f32 v86, v80, v81
  v_cvt_pk_bf16_f32 v87, v82, v83
  buffer_store_dwordx4 v[84:87], v240, s[24:27], s39 offen offset:512 sc0 sc1
  s_waitcnt lgkmcnt(4)
  v_mfma_f32_32x32x16_bf16 a[32:47], v[44:47], v[148:151], a[32:47]
  ds_read_b64_tr_b16 v[32:33], v21 offset:128
  ds_read_b64_tr_b16 v[34:35], v21 offset:1664
  v_accvgpr_read_b32 v88, a16
  v_accvgpr_read_b32 v89, a17
  v_accvgpr_read_b32 v90, a18
  v_accvgpr_read_b32 v91, a19
  v_accvgpr_read_b32 v92, a20
  v_accvgpr_read_b32 v93, a21
  v_accvgpr_read_b32 v94, a22
  v_accvgpr_read_b32 v95, a23
  v_pk_mul_f32 v[88:89], v[88:89], v[224:225] op_sel:[0,1] op_sel_hi:[1,1]
  v_pk_mul_f32 v[90:91], v[90:91], v[224:225] op_sel:[0,1] op_sel_hi:[1,1]
  v_pk_mul_f32 v[92:93], v[92:93], v[224:225] op_sel:[0,1] op_sel_hi:[1,1]
  v_pk_mul_f32 v[94:95], v[94:95], v[224:225] op_sel:[0,1] op_sel_hi:[1,1]
  v_cvt_pk_bf16_f32 v96, v88, v89
  v_cvt_pk_bf16_f32 v97, v90, v91
  v_cvt_pk_bf16_f32 v98, v92, v93
  v_cvt_pk_bf16_f32 v99, v94, v95
  buffer_store_dwordx4 v[96:99], v241, s[24:27], s39 offen offset:0 sc0 sc1
  v_mfma_f32_32x32x16_bf16 a[48:63], v[44:47], v[156:159], a[48:63]
  v_accvgpr_read_b32 v100, a24
  v_accvgpr_read_b32 v101, a25
  v_accvgpr_read_b32 v102, a26
  v_accvgpr_read_b32 v103, a27
  v_accvgpr_read_b32 v104, a28
  v_accvgpr_read_b32 v105, a29
  v_accvgpr_read_b32 v106, a30
  v_accvgpr_read_b32 v107, a31
  v_pk_mul_f32 v[100:101], v[100:101], v[224:225] op_sel:[0,1] op_sel_hi:[1,1]
  v_pk_mul_f32 v[102:103], v[102:103], v[224:225] op_sel:[0,1] op_sel_hi:[1,1]
  v_pk_mul_f32 v[104:105], v[104:105], v[224:225] op_sel:[0,1] op_sel_hi:[1,1]
  v_pk_mul_f32 v[106:107], v[106:107], v[224:225] op_sel:[0,1] op_sel_hi:[1,1]
  v_cvt_pk_bf16_f32 v108, v100, v101
  v_cvt_pk_bf16_f32 v109, v102, v103
  v_cvt_pk_bf16_f32 v110, v104, v105
  v_cvt_pk_bf16_f32 v111, v106, v107
  buffer_store_dwordx4 v[108:111], v241, s[24:27], s39 offen offset:512 sc0 sc1
  s_waitcnt lgkmcnt(4)
  v_mfma_f32_32x32x16_bf16 a[64:79], v[48:51], v[144:147], a[64:79]
  ds_read_b64_tr_b16 v[36:37], v21 offset:6272
  ds_read_b64_tr_b16 v[38:39], v21 offset:7808
  v_accvgpr_read_b32 v112, a32
  v_accvgpr_read_b32 v113, a33
  v_accvgpr_read_b32 v114, a34
  v_accvgpr_read_b32 v115, a35
  v_accvgpr_read_b32 v116, a36
  v_accvgpr_read_b32 v117, a37
  v_accvgpr_read_b32 v118, a38
  v_accvgpr_read_b32 v119, a39
  v_pk_mul_f32 v[112:113], v[112:113], v[224:225] op_sel:[0,0] op_sel_hi:[1,0]
  v_pk_mul_f32 v[114:115], v[114:115], v[224:225] op_sel:[0,0] op_sel_hi:[1,0]
  v_pk_mul_f32 v[116:117], v[116:117], v[224:225] op_sel:[0,0] op_sel_hi:[1,0]
  v_pk_mul_f32 v[118:119], v[118:119], v[224:225] op_sel:[0,0] op_sel_hi:[1,0]
  v_cvt_pk_bf16_f32 v120, v112, v113
  v_cvt_pk_bf16_f32 v121, v114, v115
  v_cvt_pk_bf16_f32 v122, v116, v117
  v_cvt_pk_bf16_f32 v123, v118, v119
  buffer_store_dwordx4 v[120:123], v240, s[24:27], s39 offen offset:1024 sc0 sc1
  v_mfma_f32_32x32x16_bf16 a[80:95], v[48:51], v[152:155], a[80:95]
  v_accvgpr_read_b32 v160, a40
  v_accvgpr_read_b32 v161, a41
  v_accvgpr_read_b32 v162, a42
  v_accvgpr_read_b32 v163, a43
  v_accvgpr_read_b32 v164, a44
  v_accvgpr_read_b32 v165, a45
  v_accvgpr_read_b32 v166, a46
  v_accvgpr_read_b32 v167, a47
  v_pk_mul_f32 v[160:161], v[160:161], v[224:225] op_sel:[0,0] op_sel_hi:[1,0]
  v_pk_mul_f32 v[162:163], v[162:163], v[224:225] op_sel:[0,0] op_sel_hi:[1,0]
  v_pk_mul_f32 v[164:165], v[164:165], v[224:225] op_sel:[0,0] op_sel_hi:[1,0]
  v_pk_mul_f32 v[166:167], v[166:167], v[224:225] op_sel:[0,0] op_sel_hi:[1,0]
  v_cvt_pk_bf16_f32 v168, v160, v161
  v_cvt_pk_bf16_f32 v169, v162, v163
  v_cvt_pk_bf16_f32 v170, v164, v165
  v_cvt_pk_bf16_f32 v171, v166, v167
  buffer_store_dwordx4 v[168:171], v240, s[24:27], s39 offen offset:1536 sc0 sc1
  s_waitcnt lgkmcnt(4)
  v_mfma_f32_32x32x16_bf16 a[64:79], v[52:55], v[148:151], a[64:79]
  ds_read_b64_tr_b16 v[40:41], v20 offset:256
  ds_read_b64_tr_b16 v[42:43], v20 offset:1792
  v_accvgpr_read_b32 v172, a48
  v_accvgpr_read_b32 v173, a49
  v_accvgpr_read_b32 v174, a50
  v_accvgpr_read_b32 v175, a51
  v_accvgpr_read_b32 v176, a52
  v_accvgpr_read_b32 v177, a53
  v_accvgpr_read_b32 v178, a54
  v_accvgpr_read_b32 v179, a55
  v_pk_mul_f32 v[172:173], v[172:173], v[224:225] op_sel:[0,1] op_sel_hi:[1,1]
  v_pk_mul_f32 v[174:175], v[174:175], v[224:225] op_sel:[0,1] op_sel_hi:[1,1]
  v_pk_mul_f32 v[176:177], v[176:177], v[224:225] op_sel:[0,1] op_sel_hi:[1,1]
  v_pk_mul_f32 v[178:179], v[178:179], v[224:225] op_sel:[0,1] op_sel_hi:[1,1]
  v_cvt_pk_bf16_f32 v180, v172, v173
  v_cvt_pk_bf16_f32 v181, v174, v175
  v_cvt_pk_bf16_f32 v182, v176, v177
  v_cvt_pk_bf16_f32 v183, v178, v179
  buffer_store_dwordx4 v[180:183], v241, s[24:27], s39 offen offset:1024 sc0 sc1
  v_mfma_f32_32x32x16_bf16 a[80:95], v[52:55], v[156:159], a[80:95]
  v_accvgpr_read_b32 v184, a56
  v_accvgpr_read_b32 v185, a57
  v_accvgpr_read_b32 v186, a58
  v_accvgpr_read_b32 v187, a59
  v_accvgpr_read_b32 v188, a60
  v_accvgpr_read_b32 v189, a61
  v_accvgpr_read_b32 v190, a62
  v_accvgpr_read_b32 v191, a63
  v_pk_mul_f32 v[184:185], v[184:185], v[224:225] op_sel:[0,1] op_sel_hi:[1,1]
  v_pk_mul_f32 v[186:187], v[186:187], v[224:225] op_sel:[0,1] op_sel_hi:[1,1]
  v_pk_mul_f32 v[188:189], v[188:189], v[224:225] op_sel:[0,1] op_sel_hi:[1,1]
  v_pk_mul_f32 v[190:191], v[190:191], v[224:225] op_sel:[0,1] op_sel_hi:[1,1]
  v_cvt_pk_bf16_f32 v192, v184, v185
  v_cvt_pk_bf16_f32 v193, v186, v187
  v_cvt_pk_bf16_f32 v194, v188, v189
  v_cvt_pk_bf16_f32 v195, v190, v191
  buffer_store_dwordx4 v[192:195], v241, s[24:27], s39 offen offset:1536 sc0 sc1
  s_waitcnt lgkmcnt(4)
  v_mfma_f32_32x32x16_bf16 a[96:111], v[32:35], v[144:147], a[96:111]
  ds_read_b64_tr_b16 v[44:45], v20 offset:6400
  ds_read_b64_tr_b16 v[46:47], v20 offset:7936
  v_accvgpr_read_b32 v196, a64
  v_accvgpr_read_b32 v197, a65
  v_accvgpr_read_b32 v198, a66
  v_accvgpr_read_b32 v199, a67
  v_accvgpr_read_b32 v200, a68
  v_accvgpr_read_b32 v201, a69
  v_accvgpr_read_b32 v202, a70
  v_accvgpr_read_b32 v203, a71
  v_pk_mul_f32 v[196:197], v[196:197], v[224:225] op_sel:[0,0] op_sel_hi:[1,0]
  v_pk_mul_f32 v[198:199], v[198:199], v[224:225] op_sel:[0,0] op_sel_hi:[1,0]
  v_pk_mul_f32 v[200:201], v[200:201], v[224:225] op_sel:[0,0] op_sel_hi:[1,0]
  v_pk_mul_f32 v[202:203], v[202:203], v[224:225] op_sel:[0,0] op_sel_hi:[1,0]
  v_cvt_pk_bf16_f32 v204, v196, v197
  v_cvt_pk_bf16_f32 v205, v198, v199
  v_cvt_pk_bf16_f32 v206, v200, v201
  v_cvt_pk_bf16_f32 v207, v202, v203
  buffer_store_dwordx4 v[204:207], v240, s[24:27], s39 offen offset:2048 sc0 sc1
  v_mfma_f32_32x32x16_bf16 a[112:127], v[32:35], v[152:155], a[112:127]
  v_accvgpr_read_b32 v208, a72
  v_accvgpr_read_b32 v209, a73
  v_accvgpr_read_b32 v210, a74
  v_accvgpr_read_b32 v211, a75
  v_accvgpr_read_b32 v212, a76
  v_accvgpr_read_b32 v213, a77
  v_accvgpr_read_b32 v214, a78
  v_accvgpr_read_b32 v215, a79
  v_pk_mul_f32 v[208:209], v[208:209], v[224:225] op_sel:[0,0] op_sel_hi:[1,0]
  v_pk_mul_f32 v[210:211], v[210:211], v[224:225] op_sel:[0,0] op_sel_hi:[1,0]
  v_pk_mul_f32 v[212:213], v[212:213], v[224:225] op_sel:[0,0] op_sel_hi:[1,0]
  v_pk_mul_f32 v[214:215], v[214:215], v[224:225] op_sel:[0,0] op_sel_hi:[1,0]
  v_cvt_pk_bf16_f32 v216, v208, v209
  v_cvt_pk_bf16_f32 v217, v210, v211
  v_cvt_pk_bf16_f32 v218, v212, v213
  v_cvt_pk_bf16_f32 v219, v214, v215
  buffer_store_dwordx4 v[216:219], v240, s[24:27], s39 offen offset:2560 sc0 sc1
  s_waitcnt lgkmcnt(4)
  v_mfma_f32_32x32x16_bf16 a[96:111], v[36:39], v[148:151], a[96:111]
  ds_read_b64_tr_b16 v[48:49], v21 offset:256
  ds_read_b64_tr_b16 v[50:51], v21 offset:1792
  v_accvgpr_read_b32 v64, a80
  v_accvgpr_read_b32 v65, a81
  v_accvgpr_read_b32 v66, a82
  v_accvgpr_read_b32 v67, a83
  v_accvgpr_read_b32 v68, a84
  v_accvgpr_read_b32 v69, a85
  v_accvgpr_read_b32 v70, a86
  v_accvgpr_read_b32 v71, a87
  v_pk_mul_f32 v[64:65], v[64:65], v[224:225] op_sel:[0,1] op_sel_hi:[1,1]
  v_pk_mul_f32 v[66:67], v[66:67], v[224:225] op_sel:[0,1] op_sel_hi:[1,1]
  v_pk_mul_f32 v[68:69], v[68:69], v[224:225] op_sel:[0,1] op_sel_hi:[1,1]
  v_pk_mul_f32 v[70:71], v[70:71], v[224:225] op_sel:[0,1] op_sel_hi:[1,1]
  v_cvt_pk_bf16_f32 v72, v64, v65
  v_cvt_pk_bf16_f32 v73, v66, v67
  v_cvt_pk_bf16_f32 v74, v68, v69
  v_cvt_pk_bf16_f32 v75, v70, v71
  buffer_store_dwordx4 v[72:75], v241, s[24:27], s39 offen offset:2048 sc0 sc1
  v_mfma_f32_32x32x16_bf16 a[112:127], v[36:39], v[156:159], a[112:127]
  v_accvgpr_read_b32 v76, a88
  v_accvgpr_read_b32 v77, a89
  v_accvgpr_read_b32 v78, a90
  v_accvgpr_read_b32 v79, a91
  v_accvgpr_read_b32 v80, a92
  v_accvgpr_read_b32 v81, a93
  v_accvgpr_read_b32 v82, a94
  v_accvgpr_read_b32 v83, a95
  v_pk_mul_f32 v[76:77], v[76:77], v[224:225] op_sel:[0,1] op_sel_hi:[1,1]
  v_pk_mul_f32 v[78:79], v[78:79], v[224:225] op_sel:[0,1] op_sel_hi:[1,1]
  v_pk_mul_f32 v[80:81], v[80:81], v[224:225] op_sel:[0,1] op_sel_hi:[1,1]
  v_pk_mul_f32 v[82:83], v[82:83], v[224:225] op_sel:[0,1] op_sel_hi:[1,1]
  v_cvt_pk_bf16_f32 v84, v76, v77
  v_cvt_pk_bf16_f32 v85, v78, v79
  v_cvt_pk_bf16_f32 v86, v80, v81
  v_cvt_pk_bf16_f32 v87, v82, v83
  buffer_store_dwordx4 v[84:87], v241, s[24:27], s39 offen offset:2560 sc0 sc1
  s_waitcnt lgkmcnt(4)
  v_mfma_f32_32x32x16_bf16 a[128:143], v[40:43], v[144:147], a[128:143]
  ds_read_b64_tr_b16 v[52:53], v21 offset:6400
  ds_read_b64_tr_b16 v[54:55], v21 offset:7936
  v_accvgpr_read_b32 v88, a96
  v_accvgpr_read_b32 v89, a97
  v_accvgpr_read_b32 v90, a98
  v_accvgpr_read_b32 v91, a99
  v_accvgpr_read_b32 v92, a100
  v_accvgpr_read_b32 v93, a101
  v_accvgpr_read_b32 v94, a102
  v_accvgpr_read_b32 v95, a103
  v_pk_mul_f32 v[88:89], v[88:89], v[224:225] op_sel:[0,0] op_sel_hi:[1,0]
  v_pk_mul_f32 v[90:91], v[90:91], v[224:225] op_sel:[0,0] op_sel_hi:[1,0]
  v_pk_mul_f32 v[92:93], v[92:93], v[224:225] op_sel:[0,0] op_sel_hi:[1,0]
  v_pk_mul_f32 v[94:95], v[94:95], v[224:225] op_sel:[0,0] op_sel_hi:[1,0]
  v_cvt_pk_bf16_f32 v96, v88, v89
  v_cvt_pk_bf16_f32 v97, v90, v91
  v_cvt_pk_bf16_f32 v98, v92, v93
  v_cvt_pk_bf16_f32 v99, v94, v95
  buffer_store_dwordx4 v[96:99], v240, s[24:27], s39 offen offset:3072 sc0 sc1
  v_mfma_f32_32x32x16_bf16 a[144:159], v[40:43], v[152:155], a[144:159]
  v_accvgpr_read_b32 v100, a104
  v_accvgpr_read_b32 v101, a105
  v_accvgpr_read_b32 v102, a106
  v_accvgpr_read_b32 v103, a107
  v_accvgpr_read_b32 v104, a108
  v_accvgpr_read_b32 v105, a109
  v_accvgpr_read_b32 v106, a110
  v_accvgpr_read_b32 v107, a111
  v_pk_mul_f32 v[100:101], v[100:101], v[224:225] op_sel:[0,0] op_sel_hi:[1,0]
  v_pk_mul_f32 v[102:103], v[102:103], v[224:225] op_sel:[0,0] op_sel_hi:[1,0]
  v_pk_mul_f32 v[104:105], v[104:105], v[224:225] op_sel:[0,0] op_sel_hi:[1,0]
  v_pk_mul_f32 v[106:107], v[106:107], v[224:225] op_sel:[0,0] op_sel_hi:[1,0]
  v_cvt_pk_bf16_f32 v108, v100, v101
  v_cvt_pk_bf16_f32 v109, v102, v103
  v_cvt_pk_bf16_f32 v110, v104, v105
  v_cvt_pk_bf16_f32 v111, v106, v107
  buffer_store_dwordx4 v[108:111], v240, s[24:27], s39 offen offset:3584 sc0 sc1
  s_waitcnt lgkmcnt(4)
  v_mfma_f32_32x32x16_bf16 a[128:143], v[44:47], v[148:151], a[128:143]
  v_accvgpr_read_b32 v112, a112
  v_accvgpr_read_b32 v113, a113
  v_accvgpr_read_b32 v114, a114
  v_accvgpr_read_b32 v115, a115
  v_accvgpr_read_b32 v116, a116
  v_accvgpr_read_b32 v117, a117
  v_accvgpr_read_b32 v118, a118
  v_accvgpr_read_b32 v119, a119
  v_pk_mul_f32 v[112:113], v[112:113], v[224:225] op_sel:[0,1] op_sel_hi:[1,1]
  v_pk_mul_f32 v[114:115], v[114:115], v[224:225] op_sel:[0,1] op_sel_hi:[1,1]
  v_pk_mul_f32 v[116:117], v[116:117], v[224:225] op_sel:[0,1] op_sel_hi:[1,1]
  v_pk_mul_f32 v[118:119], v[118:119], v[224:225] op_sel:[0,1] op_sel_hi:[1,1]
  v_cvt_pk_bf16_f32 v120, v112, v113
  v_cvt_pk_bf16_f32 v121, v114, v115
  v_cvt_pk_bf16_f32 v122, v116, v117
  v_cvt_pk_bf16_f32 v123, v118, v119
  buffer_store_dwordx4 v[120:123], v241, s[24:27], s39 offen offset:3072 sc0 sc1
  v_mfma_f32_32x32x16_bf16 a[144:159], v[44:47], v[156:159], a[144:159]
  v_accvgpr_read_b32 v160, a120
  v_accvgpr_read_b32 v161, a121
  v_accvgpr_read_b32 v162, a122
  v_accvgpr_read_b32 v163, a123
  v_accvgpr_read_b32 v164, a124
  v_accvgpr_read_b32 v165, a125
  v_accvgpr_read_b32 v166, a126
  v_accvgpr_read_b32 v167, a127
  v_pk_mul_f32 v[160:161], v[160:161], v[224:225] op_sel:[0,1] op_sel_hi:[1,1]
  v_pk_mul_f32 v[162:163], v[162:163], v[224:225] op_sel:[0,1] op_sel_hi:[1,1]
  v_pk_mul_f32 v[164:165], v[164:165], v[224:225] op_sel:[0,1] op_sel_hi:[1,1]
  v_pk_mul_f32 v[166:167], v[166:167], v[224:225] op_sel:[0,1] op_sel_hi:[1,1]
  v_cvt_pk_bf16_f32 v168, v160, v161
  v_cvt_pk_bf16_f32 v169, v162, v163
  v_cvt_pk_bf16_f32 v170, v164, v165
  v_cvt_pk_bf16_f32 v171, v166, v167
  buffer_store_dwordx4 v[168:171], v241, s[24:27], s39 offen offset:3584 sc0 sc1
  s_waitcnt lgkmcnt(2)
  v_mfma_f32_32x32x16_bf16 a[160:175], v[48:51], v[144:147], a[160:175]
  v_accvgpr_read_b32 v172, a128
  v_accvgpr_read_b32 v173, a129
  v_accvgpr_read_b32 v174, a130
  v_accvgpr_read_b32 v175, a131
  v_accvgpr_read_b32 v176, a132
  v_accvgpr_read_b32 v177, a133
  v_accvgpr_read_b32 v178, a134
  v_accvgpr_read_b32 v179, a135
  v_pk_mul_f32 v[172:173], v[172:173], v[224:225] op_sel:[0,0] op_sel_hi:[1,0]
  v_pk_mul_f32 v[174:175], v[174:175], v[224:225] op_sel:[0,0] op_sel_hi:[1,0]
  v_pk_mul_f32 v[176:177], v[176:177], v[224:225] op_sel:[0,0] op_sel_hi:[1,0]
  v_pk_mul_f32 v[178:179], v[178:179], v[224:225] op_sel:[0,0] op_sel_hi:[1,0]
  v_cvt_pk_bf16_f32 v180, v172, v173
  v_cvt_pk_bf16_f32 v181, v174, v175
  v_cvt_pk_bf16_f32 v182, v176, v177
  v_cvt_pk_bf16_f32 v183, v178, v179
  buffer_store_dwordx4 v[180:183], v240, s[24:27], s44 offen offset:0 sc0 sc1
  v_mfma_f32_32x32x16_bf16 a[176:191], v[48:51], v[152:155], a[176:191]
  v_accvgpr_read_b32 v184, a136
  v_accvgpr_read_b32 v185, a137
  v_accvgpr_read_b32 v186, a138
  v_accvgpr_read_b32 v187, a139
  v_accvgpr_read_b32 v188, a140
  v_accvgpr_read_b32 v189, a141
  v_accvgpr_read_b32 v190, a142
  v_accvgpr_read_b32 v191, a143
  v_pk_mul_f32 v[184:185], v[184:185], v[224:225] op_sel:[0,0] op_sel_hi:[1,0]
  v_pk_mul_f32 v[186:187], v[186:187], v[224:225] op_sel:[0,0] op_sel_hi:[1,0]
  v_pk_mul_f32 v[188:189], v[188:189], v[224:225] op_sel:[0,0] op_sel_hi:[1,0]
  v_pk_mul_f32 v[190:191], v[190:191], v[224:225] op_sel:[0,0] op_sel_hi:[1,0]
  v_cvt_pk_bf16_f32 v192, v184, v185
  v_cvt_pk_bf16_f32 v193, v186, v187
  v_cvt_pk_bf16_f32 v194, v188, v189
  v_cvt_pk_bf16_f32 v195, v190, v191
  buffer_store_dwordx4 v[192:195], v240, s[24:27], s44 offen offset:512 sc0 sc1
  s_waitcnt lgkmcnt(0)
  v_mfma_f32_32x32x16_bf16 a[160:175], v[52:55], v[148:151], a[160:175]
  v_accvgpr_read_b32 v196, a144
  v_accvgpr_read_b32 v197, a145
  v_accvgpr_read_b32 v198, a146
  v_accvgpr_read_b32 v199, a147
  v_accvgpr_read_b32 v200, a148
  v_accvgpr_read_b32 v201, a149
  v_accvgpr_read_b32 v202, a150
  v_accvgpr_read_b32 v203, a151
  v_pk_mul_f32 v[196:197], v[196:197], v[224:225] op_sel:[0,1] op_sel_hi:[1,1]
  v_pk_mul_f32 v[198:199], v[198:199], v[224:225] op_sel:[0,1] op_sel_hi:[1,1]
  v_pk_mul_f32 v[200:201], v[200:201], v[224:225] op_sel:[0,1] op_sel_hi:[1,1]
  v_pk_mul_f32 v[202:203], v[202:203], v[224:225] op_sel:[0,1] op_sel_hi:[1,1]
  v_cvt_pk_bf16_f32 v204, v196, v197
  v_cvt_pk_bf16_f32 v205, v198, v199
  v_cvt_pk_bf16_f32 v206, v200, v201
  v_cvt_pk_bf16_f32 v207, v202, v203
  buffer_store_dwordx4 v[204:207], v241, s[24:27], s44 offen offset:0 sc0 sc1
  v_mfma_f32_32x32x16_bf16 a[176:191], v[52:55], v[156:159], a[176:191]
  v_accvgpr_read_b32 v208, a152
  v_accvgpr_read_b32 v209, a153
  v_accvgpr_read_b32 v210, a154
  v_accvgpr_read_b32 v211, a155
  v_accvgpr_read_b32 v212, a156
  v_accvgpr_read_b32 v213, a157
  v_accvgpr_read_b32 v214, a158
  v_accvgpr_read_b32 v215, a159
  v_pk_mul_f32 v[208:209], v[208:209], v[224:225] op_sel:[0,1] op_sel_hi:[1,1]
  v_pk_mul_f32 v[210:211], v[210:211], v[224:225] op_sel:[0,1] op_sel_hi:[1,1]
  v_pk_mul_f32 v[212:213], v[212:213], v[224:225] op_sel:[0,1] op_sel_hi:[1,1]
  v_pk_mul_f32 v[214:215], v[214:215], v[224:225] op_sel:[0,1] op_sel_hi:[1,1]
  v_cvt_pk_bf16_f32 v216, v208, v209
  v_cvt_pk_bf16_f32 v217, v210, v211
  v_cvt_pk_bf16_f32 v218, v212, v213
  v_cvt_pk_bf16_f32 v219, v214, v215
  buffer_store_dwordx4 v[216:219], v241, s[24:27], s44 offen offset:512 sc0 sc1
  s_nop 15
  s_nop 7
  v_accvgpr_read_b32 v64, a160
  v_accvgpr_read_b32 v65, a161
  v_accvgpr_read_b32 v66, a162
  v_accvgpr_read_b32 v67, a163
  v_accvgpr_read_b32 v68, a164
  v_accvgpr_read_b32 v69, a165
  v_accvgpr_read_b32 v70, a166
  v_accvgpr_read_b32 v71, a167
  v_pk_mul_f32 v[64:65], v[64:65], v[224:225] op_sel:[0,0] op_sel_hi:[1,0]
  v_pk_mul_f32 v[66:67], v[66:67], v[224:225] op_sel:[0,0] op_sel_hi:[1,0]
  v_pk_mul_f32 v[68:69], v[68:69], v[224:225] op_sel:[0,0] op_sel_hi:[1,0]
  v_pk_mul_f32 v[70:71], v[70:71], v[224:225] op_sel:[0,0] op_sel_hi:[1,0]
  v_cvt_pk_bf16_f32 v72, v64, v65
  v_cvt_pk_bf16_f32 v73, v66, v67
  v_cvt_pk_bf16_f32 v74, v68, v69
  v_cvt_pk_bf16_f32 v75, v70, v71
  buffer_store_dwordx4 v[72:75], v240, s[24:27], s44 offen offset:1024 sc0 sc1
  v_accvgpr_read_b32 v76, a168
  v_accvgpr_read_b32 v77, a169
  v_accvgpr_read_b32 v78, a170
  v_accvgpr_read_b32 v79, a171
  v_accvgpr_read_b32 v80, a172
  v_accvgpr_read_b32 v81, a173
  v_accvgpr_read_b32 v82, a174
  v_accvgpr_read_b32 v83, a175
  v_pk_mul_f32 v[76:77], v[76:77], v[224:225] op_sel:[0,0] op_sel_hi:[1,0]
  v_pk_mul_f32 v[78:79], v[78:79], v[224:225] op_sel:[0,0] op_sel_hi:[1,0]
  v_pk_mul_f32 v[80:81], v[80:81], v[224:225] op_sel:[0,0] op_sel_hi:[1,0]
  v_pk_mul_f32 v[82:83], v[82:83], v[224:225] op_sel:[0,0] op_sel_hi:[1,0]
  v_cvt_pk_bf16_f32 v84, v76, v77
  v_cvt_pk_bf16_f32 v85, v78, v79
  v_cvt_pk_bf16_f32 v86, v80, v81
  v_cvt_pk_bf16_f32 v87, v82, v83
  buffer_store_dwordx4 v[84:87], v240, s[24:27], s44 offen offset:1536 sc0 sc1
  v_accvgpr_read_b32 v88, a176
  v_accvgpr_read_b32 v89, a177
  v_accvgpr_read_b32 v90, a178
  v_accvgpr_read_b32 v91, a179
  v_accvgpr_read_b32 v92, a180
  v_accvgpr_read_b32 v93, a181
  v_accvgpr_read_b32 v94, a182
  v_accvgpr_read_b32 v95, a183
  v_pk_mul_f32 v[88:89], v[88:89], v[224:225] op_sel:[0,1] op_sel_hi:[1,1]
  v_pk_mul_f32 v[90:91], v[90:91], v[224:225] op_sel:[0,1] op_sel_hi:[1,1]
  v_pk_mul_f32 v[92:93], v[92:93], v[224:225] op_sel:[0,1] op_sel_hi:[1,1]
  v_pk_mul_f32 v[94:95], v[94:95], v[224:225] op_sel:[0,1] op_sel_hi:[1,1]
  v_cvt_pk_bf16_f32 v96, v88, v89
  v_cvt_pk_bf16_f32 v97, v90, v91
  v_cvt_pk_bf16_f32 v98, v92, v93
  v_cvt_pk_bf16_f32 v99, v94, v95
  buffer_store_dwordx4 v[96:99], v241, s[24:27], s44 offen offset:1024 sc0 sc1
  v_accvgpr_read_b32 v100, a184
  v_accvgpr_read_b32 v101, a185
  v_accvgpr_read_b32 v102, a186
  v_accvgpr_read_b32 v103, a187
  v_accvgpr_read_b32 v104, a188
  v_accvgpr_read_b32 v105, a189
  v_accvgpr_read_b32 v106, a190
  v_accvgpr_read_b32 v107, a191
  v_pk_mul_f32 v[100:101], v[100:101], v[224:225] op_sel:[0,1] op_sel_hi:[1,1]
  v_pk_mul_f32 v[102:103], v[102:103], v[224:225] op_sel:[0,1] op_sel_hi:[1,1]
  v_pk_mul_f32 v[104:105], v[104:105], v[224:225] op_sel:[0,1] op_sel_hi:[1,1]
  v_pk_mul_f32 v[106:107], v[106:107], v[224:225] op_sel:[0,1] op_sel_hi:[1,1]
  v_cvt_pk_bf16_f32 v108, v100, v101
  v_cvt_pk_bf16_f32 v109, v102, v103
  v_cvt_pk_bf16_f32 v110, v104, v105
  v_cvt_pk_bf16_f32 v111, v106, v107
  buffer_store_dwordx4 v[108:111], v241, s[24:27], s44 offen offset:1536 sc0 sc1
A_END:
  s_endpgm
PK0:
  s_cmp_ge_u32 s2, 240
  s_cbranch_scc1 PK0_ret
  s_add_u32 m0, s100, 0
  s_add_u32 s42, s98, 0
  buffer_load_dwordx4 v242, s[92:95], s42 offen nt lds
  s_add_u32 m0, s100, 1024
  s_add_u32 s42, s98, 10240
  buffer_load_dwordx4 v242, s[92:95], s42 offen nt lds
  s_add_u32 m0, s100, 2048
  s_add_u32 s42, s98, 20480
  buffer_load_dwordx4 v242, s[92:95], s42 offen nt lds
  s_add_u32 m0, s100, 3072
  s_add_u32 s42, s98, 30720
  buffer_load_dwordx4 v242, s[92:95], s42 offen nt lds
  s_branch PK0_ret
PK1:
  s_cmp_ge_u32 s2, 240
  s_cbranch_scc1 PK1_ret
  ds_read_b64_tr_b16 v[56:57], v243 offset:0
  ds_read_b64_tr_b16 v[58:59], v243 offset:512
  ds_read_b64_tr_b16 v[60:61], v243 offset:32
  ds_read_b64_tr_b16 v[62:63], v243 offset:544
  ds_read_b64_tr_b16 v[232:233], v243 offset:64
  ds_read_b64_tr_b16 v[234:235], v243 offset:576
  ds_read_b64_tr_b16 v[236:237], v243 offset:96
  ds_read_b64_tr_b16 v[238:239], v243 offset:608
  s_waitcnt lgkmcnt(6)
  buffer_store_dwordx4 v[56:59], v244, s[24:27], s99 offen sc0 sc1
  s_add_u32 s99, s99, 196608
  s_waitcnt lgkmcnt(4)
  buffer_store_dwordx4 v[60:63], v244, s[24:27], s99 offen sc0 sc1
  s_add_u32 s99, s99, 196608
  s_waitcnt lgkmcnt(2)
  buffer_store_dwordx4 v[232:235], v244, s[24:27], s99 offen sc0 sc1
  s_add_u32 s99, s99, 196608
  s_waitcnt lgkmcnt(0)
  buffer_store_dwordx4 v[236:239], v244, s[24:27], s99 offen sc0 sc1
  s_add_u32 s99, s99, 196608
  s_add_u32 m0, s100, 0
  s_add_u32 s42, s98, 128
  buffer_load_dwordx4 v242, s[92:95], s42 offen nt lds
  s_add_u32 m0, s100, 1024
  s_add_u32 s42, s98, 10368
  buffer_load_dwordx4 v242, s[92:95], s42 offen nt lds
  s_add_u32 m0, s100, 2048
  s_add_u32 s42, s98, 20608
  buffer_load_dwordx4 v242, s[92:95], s42 offen nt lds
  s_add_u32 m0, s100, 3072
  s_add_u32 s42, s98, 30848
  buffer_load_dwordx4 v242, s[92:95], s42 offen nt lds
  s_nop 4
  s_branch PK1_ret
PK2:
  s_cmp_ge_u32 s2, 240
  s_cbranch_scc1 PK2_ret
  ds_read_b64_tr_b16 v[56:57], v243 offset:0
  ds_read_b64_tr_b16 v[58:59], v243 offset:512
  ds_read_b64_tr_b16 v[60:61], v243 offset:32
  ds_read_b64_tr_b16 v[62:63], v243 offset:544
  ds_read_b64_tr_b16 v[232:233], v243 offset:64
  ds_read_b64_tr_b16 v[234:235], v243 offset:576
  ds_read_b64_tr_b16 v[236:237], v243 offset:96
  ds_read_b64_tr_b16 v[238:239], v243 offset:608
  s_waitcnt lgkmcnt(6)
  buffer_store_dwordx4 v[56:59], v244, s[24:27], s99 offen sc0 sc1
  s_add_u32 s99, s99, 196608
  s_waitcnt lgkmcnt(4)
  buffer_store_dwordx4 v[60:63], v244, s[24:27], s99 offen sc0 sc1
  s_add_u32 s99, s99, 196608
  s_waitcnt lgkmcnt(2)
  buffer_store_dwordx4 v[232:235], v244, s[24:27], s99 offen sc0 sc1
  s_add_u32 s99, s99, 196608
  s_waitcnt lgkmcnt(0)
  buffer_store_dwordx4 v[236:239], v244, s[24:27], s99 offen sc0 sc1
  s_add_u32 s99, s99, 196608
  s_nop 4
  s_branch PK2_ret
RARE1:
  s_nop 15
  s_nop 15
  v_max3_f32 v229, v96, v97, v98
  v_max3_f32 v229, v229, v99, v100
  v_max3_f32 v229, v229, v101, v102
  v_max3_f32 v229, v229, v103, v104
  v_max3_f32 v229, v229, v105, v106
  v_max3_f32 v229, v229, v107, v108
  v_max3_f32 v229, v229, v109, v110
  v_max_f32 v229, v229, v111
  v_mov_b32 v230, v229
  s_nop 1
  v_permlane32_swap_b32 v229, v230
  s_nop 1
  v_max_f32 v229, v229, v230
  v_max_f32 v229, 0, v229
  v_sub_f32 v231, 0, v229
  v_exp_f32 v231, v231
  s_nop 1
  v_sub_f32 v96, v96, v229
  v_sub_f32 v64, v64, v229
  v_sub_f32 v160, v160, v229
  v_sub_f32 v97, v97, v229
  v_sub_f32 v65, v65, v229
  v_sub_f32 v161, v161, v229
  v_sub_f32 v98, v98, v229
  v_sub_f32 v66, v66, v229
  v_sub_f32 v162, v162, v229
  v_sub_f32 v99, v99, v229
  v_sub_f32 v67, v67, v229
  v_sub_f32 v163, v163, v229
  v_sub_f32 v100, v100, v229
  v_sub_f32 v68, v68, v229
  v_sub_f32 v164, v164, v229
  v_sub_f32 v101, v101, v229
  v_sub_f32 v69, v69, v229
  v_sub_f32 v165, v165, v229
  v_sub_f32 v102, v102, v229
  v_sub_f32 v70, v70, v229
  v_sub_f32 v166, v166, v229
  v_sub_f32 v103, v103, v229
  v_sub_f32 v71, v71, v229
  v_sub_f32 v167, v167, v229
  v_sub_f32 v104, v104, v229
  v_sub_f32 v72, v72, v229
  v_sub_f32 v168, v168, v229
  v_sub_f32 v105, v105, v229
  v_sub_f32 v73, v73, v229
  v_sub_f32 v169, v169, v229
  v_sub_f32 v106, v106, v229
  v_sub_f32 v74, v74, v229
  v_sub_f32 v170, v170, v229
  v_sub_f32 v107, v107, v229
  v_sub_f32 v75, v75, v229
  v_sub_f32 v171, v171, v229
  v_sub_f32 v108, v108, v229
  v_sub_f32 v76, v76, v229
  v_sub_f32 v172, v172, v229
  v_sub_f32 v109, v109, v229
  v_sub_f32 v77, v77, v229
  v_sub_f32 v173, v173, v229
  v_sub_f32 v110, v110, v229
  v_sub_f32 v78, v78, v229
  v_sub_f32 v174, v174, v229
  v_sub_f32 v111, v111, v229
  v_sub_f32 v79, v79, v229
  v_sub_f32 v175, v175, v229
  v_mul_f32 v224, v224, v231
  v_accvgpr_read_b32 v230, a0
  v_mul_f32 v230, v230, v231
  v_accvgpr_write_b32 a0, v230
  v_accvgpr_read_b32 v230, a1
  v_mul_f32 v230, v230, v231
  v_accvgpr_write_b32 a1, v230
  v_accvgpr_read_b32 v230, a2
  v_mul_f32 v230, v230, v231
  v_accvgpr_write_b32 a2, v230
  v_accvgpr_read_b32 v230, a3
  v_mul_f32 v230, v230, v231
  v_accvgpr_write_b32 a3, v230
  v_accvgpr_read_b32 v230, a4
  v_mul_f32 v230, v230, v231
  v_accvgpr_write_b32 a4, v230
  v_accvgpr_read_b32 v230, a5
  v_mul_f32 v230, v230, v231
  v_accvgpr_write_b32 a5, v230
  v_accvgpr_read_b32 v230, a6
  v_mul_f32 v230, v230, v231
  v_accvgpr_write_b32 a6, v230
  v_accvgpr_read_b32 v230, a7
  v_mul_f32 v230, v230, v231
  v_accvgpr_write_b32 a7, v230
  v_accvgpr_read_b32 v230, a8
  v_mul_f32 v230, v230, v231
  v_accvgpr_write_b32 a8, v230
  v_accvgpr_read_b32 v230, a9
  v_mul_f32 v230, v230, v231
  v_accvgpr_write_b32 a9, v230
  v_accvgpr_read_b32 v230, a10
  v_mul_f32 v230, v230, v231
  v_accvgpr_write_b32 a10, v230
  v_accvgpr_read_b32 v230, a11
  v_mul_f32 v230, v230, v231
  v_accvgpr_write_b32 a11, v230
  v_accvgpr_read_b32 v230, a12
  v_mul_f32 v230, v230, v231
  v_accvgpr_write_b32 a12, v230
  v_accvgpr_read_b32 v230, a13
  v_mul_f32 v230, v230, v231
  v_accvgpr_write_b32 a13, v230
  v_accvgpr_read_b32 v230, a14
  v_mul_f32 v230, v230, v231
  v_accvgpr_write_b32 a14, v230
  v_accvgpr_read_b32 v230, a15
  v_mul_f32 v230, v230, v231
  v_accvgpr_write_b32 a15, v230
  v_accvgpr_read_b32 v230, a32
  v_mul_f32 v230, v230, v231
  v_accvgpr_write_b32 a32, v230
  v_accvgpr_read_b32 v230, a33
  v_mul_f32 v230, v230, v231
  v_accvgpr_write_b32 a33, v230
  v_accvgpr_read_b32 v230, a34
  v_mul_f32 v230, v230, v231
  v_accvgpr_write_b32 a34, v230
  v_accvgpr_read_b32 v230, a35
  v_mul_f32 v230, v230, v231
  v_accvgpr_write_b32 a35, v230
  v_accvgpr_read_b32 v230, a36
  v_mul_f32 v230, v230, v231
  v_accvgpr_write_b32 a36, v230
  v_accvgpr_read_b32 v230, a37
  v_mul_f32 v230, v230, v231
  v_accvgpr_write_b32 a37, v230
  v_accvgpr_read_b32 v230, a38
  v_mul_f32 v230, v230, v231
  v_accvgpr_write_b32 a38, v230
  v_accvgpr_read_b32 v230, a39
  v_mul_f32 v230, v230, v231
  v_accvgpr_write_b32 a39, v230
  v_accvgpr_read_b32 v230, a40
  v_mul_f32 v230, v230, v231
  v_accvgpr_write_b32 a40, v230
  v_accvgpr_read_b32 v230, a41
  v_mul_f32 v230, v230, v231
  v_accvgpr_write_b32 a41, v230
  v_accvgpr_read_b32 v230, a42
  v_mul_f32 v230, v230, v231
  v_accvgpr_write_b32 a42, v230
  v_accvgpr_read_b32 v230, a43
  v_mul_f32 v230, v230, v231
  v_accvgpr_write_b32 a43, v230
  v_accvgpr_read_b32 v230, a44
  v_mul_f32 v230, v230, v231
  v_accvgpr_write_b32 a44, v230
  v_accvgpr_read_b32 v230, a45
  v_mul_f32 v230, v230, v231
  v_accvgpr_write_b32 a45, v230
  v_accvgpr_read_b32 v230, a46
  v_mul_f32 v230, v230, v231
  v_accvgpr_write_b32 a46, v230
  v_accvgpr_read_b32 v230, a47
  v_mul_f32 v230, v230, v231
  v_accvgpr_write_b32 a47, v230
  v_accvgpr_read_b32 v230, a64
  v_mul_f32 v230, v230, v231
  v_accvgpr_write_b32 a64, v230
  v_accvgpr_read_b32 v230, a65
  v_mul_f32 v230, v230, v231
  v_accvgpr_write_b32 a65, v230
  v_accvgpr_read_b32 v230, a66
  v_mul_f32 v230, v230, v231
  v_accvgpr_write_b32 a66, v230
  v_accvgpr_read_b32 v230, a67
  v_mul_f32 v230, v230, v231
  v_accvgpr_write_b32 a67, v230
  v_accvgpr_read_b32 v230, a68
  v_mul_f32 v230, v230, v231
  v_accvgpr_write_b32 a68, v230
  v_accvgpr_read_b32 v230, a69
  v_mul_f32 v230, v230, v231
  v_accvgpr_write_b32 a69, v230
  v_accvgpr_read_b32 v230, a70
  v_mul_f32 v230, v230, v231
  v_accvgpr_write_b32 a70, v230
  v_accvgpr_read_b32 v230, a71
  v_mul_f32 v230, v230, v231
  v_accvgpr_write_b32 a71, v230
  v_accvgpr_read_b32 v230, a72
  v_mul_f32 v230, v230, v231
  v_accvgpr_write_b32 a72, v230
  v_accvgpr_read_b32 v230, a73
  v_mul_f32 v230, v230, v231
  v_accvgpr_write_b32 a73, v230
  v_accvgpr_read_b32 v230, a74
  v_mul_f32 v230, v230, v231
  v_accvgpr_write_b32 a74, v230
  v_accvgpr_read_b32 v230, a75
  v_mul_f32 v230, v230, v231
  v_accvgpr_write_b32 a75, v230
  v_accvgpr_read_b32 v230, a76
  v_mul_f32 v230, v230, v231
  v_accvgpr_write_b32 a76, v230
  v_accvgpr_read_b32 v230, a77
  v_mul_f32 v230, v230, v231
  v_accvgpr_write_b32 a77, v230
  v_accvgpr_read_b32 v230, a78
  v_mul_f32 v230, v230, v231
  v_accvgpr_write_b32 a78, v230
  v_accvgpr_read_b32 v230, a79
  v_mul_f32 v230, v230, v231
  v_accvgpr_write_b32 a79, v230
  v_accvgpr_read_b32 v230, a96
  v_mul_f32 v230, v230, v231
  v_accvgpr_write_b32 a96, v230
  v_accvgpr_read_b32 v230, a97
  v_mul_f32 v230, v230, v231
  v_accvgpr_write_b32 a97, v230
  v_accvgpr_read_b32 v230, a98
  v_mul_f32 v230, v230, v231
  v_accvgpr_write_b32 a98, v230
  v_accvgpr_read_b32 v230, a99
  v_mul_f32 v230, v230, v231
  v_accvgpr_write_b32 a99, v230
  v_accvgpr_read_b32 v230, a100
  v_mul_f32 v230, v230, v231
  v_accvgpr_write_b32 a100, v230
  v_accvgpr_read_b32 v230, a101
  v_mul_f32 v230, v230, v231
  v_accvgpr_write_b32 a101, v230
  v_accvgpr_read_b32 v230, a102
  v_mul_f32 v230, v230, v231
  v_accvgpr_write_b32 a102, v230
  v_accvgpr_read_b32 v230, a103
  v_mul_f32 v230, v230, v231
  v_accvgpr_write_b32 a103, v230
  v_accvgpr_read_b32 v230, a104
  v_mul_f32 v230, v230, v231
  v_accvgpr_write_b32 a104, v230
  v_accvgpr_read_b32 v230, a105
  v_mul_f32 v230, v230, v231
  v_accvgpr_write_b32 a105, v230
  v_accvgpr_read_b32 v230, a106
  v_mul_f32 v230, v230, v231
  v_accvgpr_write_b32 a106, v230
  v_accvgpr_read_b32 v230, a107
  v_mul_f32 v230, v230, v231
  v_accvgpr_write_b32 a107, v230
  v_accvgpr_read_b32 v230, a108
  v_mul_f32 v230, v230, v231
  v_accvgpr_write_b32 a108, v230
  v_accvgpr_read_b32 v230, a109
  v_mul_f32 v230, v230, v231
  v_accvgpr_write_b32 a109, v230
  v_accvgpr_read_b32 v230, a110
  v_mul_f32 v230, v230, v231
  v_accvgpr_write_b32 a110, v230
  v_accvgpr_read_b32 v230, a111
  v_mul_f32 v230, v230, v231
  v_accvgpr_write_b32 a111, v230
  v_accvgpr_read_b32 v230, a128
  v_mul_f32 v230, v230, v231
  v_accvgpr_write_b32 a128, v230
  v_accvgpr_read_b32 v230, a129
  v_mul_f32 v230, v230, v231
  v_accvgpr_write_b32 a129, v230
  v_accvgpr_read_b32 v230, a130
  v_mul_f32 v230, v230, v231
  v_accvgpr_write_b32 a130, v230
  v_accvgpr_read_b32 v230, a131
  v_mul_f32 v230, v230, v231
  v_accvgpr_write_b32 a131, v230
  v_accvgpr_read_b32 v230, a132
  v_mul_f32 v230, v230, v231
  v_accvgpr_write_b32 a132, v230
  v_accvgpr_read_b32 v230, a133
  v_mul_f32 v230, v230, v231
  v_accvgpr_write_b32 a133, v230
  v_accvgpr_read_b32 v230, a134
  v_mul_f32 v230, v230, v231
  v_accvgpr_write_b32 a134, v230
  v_accvgpr_read_b32 v230, a135
  v_mul_f32 v230, v230, v231
  v_accvgpr_write_b32 a135, v230
  v_accvgpr_read_b32 v230, a136
  v_mul_f32 v230, v230, v231
  v_accvgpr_write_b32 a136, v230
  v_accvgpr_read_b32 v230, a137
  v_mul_f32 v230, v230, v231
  v_accvgpr_write_b32 a137, v230
  v_accvgpr_read_b32 v230, a138
  v_mul_f32 v230, v230, v231
  v_accvgpr_write_b32 a138, v230
  v_accvgpr_read_b32 v230, a139
  v_mul_f32 v230, v230, v231
  v_accvgpr_write_b32 a139, v230
  v_accvgpr_read_b32 v230, a140
  v_mul_f32 v230, v230, v231
  v_accvgpr_write_b32 a140, v230
  v_accvgpr_read_b32 v230, a141
  v_mul_f32 v230, v230, v231
  v_accvgpr_write_b32 a141, v230
  v_accvgpr_read_b32 v230, a142
  v_mul_f32 v230, v230, v231
  v_accvgpr_write_b32 a142, v230
  v_accvgpr_read_b32 v230, a143
  v_mul_f32 v230, v230, v231
  v_accvgpr_write_b32 a143, v230
  v_accvgpr_read_b32 v230, a160
  v_mul_f32 v230, v230, v231
  v_accvgpr_write_b32 a160, v230
  v_accvgpr_read_b32 v230, a161
  v_mul_f32 v230, v230, v231
  v_accvgpr_write_b32 a161, v230
  v_accvgpr_read_b32 v230, a162
  v_mul_f32 v230, v230, v231
  v_accvgpr_write_b32 a162, v230
  v_accvgpr_read_b32 v230, a163
  v_mul_f32 v230, v230, v231
  v_accvgpr_write_b32 a163, v230
  v_accvgpr_read_b32 v230, a164
  v_mul_f32 v230, v230, v231
  v_accvgpr_write_b32 a164, v230
  v_accvgpr_read_b32 v230, a165
  v_mul_f32 v230, v230, v231
  v_accvgpr_write_b32 a165, v230
  v_accvgpr_read_b32 v230, a166
  v_mul_f32 v230, v230, v231
  v_accvgpr_write_b32 a166, v230
  v_accvgpr_read_b32 v230, a167
  v_mul_f32 v230, v230, v231
  v_accvgpr_write_b32 a167, v230
  v_accvgpr_read_b32 v230, a168
  v_mul_f32 v230, v230, v231
  v_accvgpr_write_b32 a168, v230
  v_accvgpr_read_b32 v230, a169
  v_mul_f32 v230, v230, v231
  v_accvgpr_write_b32 a169, v230
  v_accvgpr_read_b32 v230, a170
  v_mul_f32 v230, v230, v231
  v_accvgpr_write_b32 a170, v230
  v_accvgpr_read_b32 v230, a171
  v_mul_f32 v230, v230, v231
  v_accvgpr_write_b32 a171, v230
  v_accvgpr_read_b32 v230, a172
  v_mul_f32 v230, v230, v231
  v_accvgpr_write_b32 a172, v230
  v_accvgpr_read_b32 v230, a173
  v_mul_f32 v230, v230, v231
  v_accvgpr_write_b32 a173, v230
  v_accvgpr_read_b32 v230, a174
  v_mul_f32 v230, v230, v231
  v_accvgpr_write_b32 a174, v230
  v_accvgpr_read_b32 v230, a175
  v_mul_f32 v230, v230, v231
  v_accvgpr_write_b32 a175, v230
  v_max3_f32 v229, v112, v113, v114
  v_max3_f32 v229, v229, v115, v116
  v_max3_f32 v229, v229, v117, v118
  v_max3_f32 v229, v229, v119, v120
  v_max3_f32 v229, v229, v121, v122
  v_max3_f32 v229, v229, v123, v124
  v_max3_f32 v229, v229, v125, v126
  v_max_f32 v229, v229, v127
  v_mov_b32 v230, v229
  s_nop 1
  v_permlane32_swap_b32 v229, v230
  s_nop 1
  v_max_f32 v229, v229, v230
  v_max_f32 v229, 0, v229
  v_sub_f32 v231, 0, v229
  v_exp_f32 v231, v231
  s_nop 1
  v_sub_f32 v112, v112, v229
  v_sub_f32 v80, v80, v229
  v_sub_f32 v176, v176, v229
  v_sub_f32 v113, v113, v229
  v_sub_f32 v81, v81, v229
  v_sub_f32 v177, v177, v229
  v_sub_f32 v114, v114, v229
  v_sub_f32 v82, v82, v229
  v_sub_f32 v178, v178, v229
  v_sub_f32 v115, v115, v229
  v_sub_f32 v83, v83, v229
  v_sub_f32 v179, v179, v229
  v_sub_f32 v116, v116, v229
  v_sub_f32 v84, v84, v229
  v_sub_f32 v180, v180, v229
  v_sub_f32 v117, v117, v229
  v_sub_f32 v85, v85, v229
  v_sub_f32 v181, v181, v229
  v_sub_f32 v118, v118, v229
  v_sub_f32 v86, v86, v229
  v_sub_f32 v182, v182, v229
  v_sub_f32 v119, v119, v229
  v_sub_f32 v87, v87, v229
  v_sub_f32 v183, v183, v229
  v_sub_f32 v120, v120, v229
  v_sub_f32 v88, v88, v229
  v_sub_f32 v184, v184, v229
  v_sub_f32 v121, v121, v229
  v_sub_f32 v89, v89, v229
  v_sub_f32 v185, v185, v229
  v_sub_f32 v122, v122, v229
  v_sub_f32 v90, v90, v229
  v_sub_f32 v186, v186, v229
  v_sub_f32 v123, v123, v229
  v_sub_f32 v91, v91, v229
  v_sub_f32 v187, v187, v229
  v_sub_f32 v124, v124, v229
  v_sub_f32 v92, v92, v229
  v_sub_f32 v188, v188, v229
  v_sub_f32 v125, v125, v229
  v_sub_f32 v93, v93, v229
  v_sub_f32 v189, v189, v229
  v_sub_f32 v126, v126, v229
  v_sub_f32 v94, v94, v229
  v_sub_f32 v190, v190, v229
  v_sub_f32 v127, v127, v229
  v_sub_f32 v95, v95, v229
  v_sub_f32 v191, v191, v229
  v_mul_f32 v225, v225, v231
  v_accvgpr_read_b32 v230, a16
  v_mul_f32 v230, v230, v231
  v_accvgpr_write_b32 a16, v230
  v_accvgpr_read_b32 v230, a17
  v_mul_f32 v230, v230, v231
  v_accvgpr_write_b32 a17, v230
  v_accvgpr_read_b32 v230, a18
  v_mul_f32 v230, v230, v231
  v_accvgpr_write_b32 a18, v230
  v_accvgpr_read_b32 v230, a19
  v_mul_f32 v230, v230, v231
  v_accvgpr_write_b32 a19, v230
  v_accvgpr_read_b32 v230, a20
  v_mul_f32 v230, v230, v231
  v_accvgpr_write_b32 a20, v230
  v_accvgpr_read_b32 v230, a21
  v_mul_f32 v230, v230, v231
  v_accvgpr_write_b32 a21, v230
  v_accvgpr_read_b32 v230, a22
  v_mul_f32 v230, v230, v231
  v_accvgpr_write_b32 a22, v230
  v_accvgpr_read_b32 v230, a23
  v_mul_f32 v230, v230, v231
  v_accvgpr_write_b32 a23, v230
  v_accvgpr_read_b32 v230, a24
  v_mul_f32 v230, v230, v231
  v_accvgpr_write_b32 a24, v230
  v_accvgpr_read_b32 v230, a25
  v_mul_f32 v230, v230, v231
  v_accvgpr_write_b32 a25, v230
  v_accvgpr_read_b32 v230, a26
  v_mul_f32 v230, v230, v231
  v_accvgpr_write_b32 a26, v230
  v_accvgpr_read_b32 v230, a27
  v_mul_f32 v230, v230, v231
  v_accvgpr_write_b32 a27, v230
  v_accvgpr_read_b32 v230, a28
  v_mul_f32 v230, v230, v231
  v_accvgpr_write_b32 a28, v230
  v_accvgpr_read_b32 v230, a29
  v_mul_f32 v230, v230, v231
  v_accvgpr_write_b32 a29, v230
  v_accvgpr_read_b32 v230, a30
  v_mul_f32 v230, v230, v231
  v_accvgpr_write_b32 a30, v230
  v_accvgpr_read_b32 v230, a31
  v_mul_f32 v230, v230, v231
  v_accvgpr_write_b32 a31, v230
  v_accvgpr_read_b32 v230, a48
  v_mul_f32 v230, v230, v231
  v_accvgpr_write_b32 a48, v230
  v_accvgpr_read_b32 v230, a49
  v_mul_f32 v230, v230, v231
  v_accvgpr_write_b32 a49, v230
  v_accvgpr_read_b32 v230, a50
  v_mul_f32 v230, v230, v231
  v_accvgpr_write_b32 a50, v230
  v_accvgpr_read_b32 v230, a51
  v_mul_f32 v230, v230, v231
  v_accvgpr_write_b32 a51, v230
  v_accvgpr_read_b32 v230, a52
  v_mul_f32 v230, v230, v231
  v_accvgpr_write_b32 a52, v230
  v_accvgpr_read_b32 v230, a53
  v_mul_f32 v230, v230, v231
  v_accvgpr_write_b32 a53, v230
  v_accvgpr_read_b32 v230, a54
  v_mul_f32 v230, v230, v231
  v_accvgpr_write_b32 a54, v230
  v_accvgpr_read_b32 v230, a55
  v_mul_f32 v230, v230, v231
  v_accvgpr_write_b32 a55, v230
  v_accvgpr_read_b32 v230, a56
  v_mul_f32 v230, v230, v231
  v_accvgpr_write_b32 a56, v230
  v_accvgpr_read_b32 v230, a57
  v_mul_f32 v230, v230, v231
  v_accvgpr_write_b32 a57, v230
  v_accvgpr_read_b32 v230, a58
  v_mul_f32 v230, v230, v231
  v_accvgpr_write_b32 a58, v230
  v_accvgpr_read_b32 v230, a59
  v_mul_f32 v230, v230, v231
  v_accvgpr_write_b32 a59, v230
  v_accvgpr_read_b32 v230, a60
  v_mul_f32 v230, v230, v231
  v_accvgpr_write_b32 a60, v230
  v_accvgpr_read_b32 v230, a61
  v_mul_f32 v230, v230, v231
  v_accvgpr_write_b32 a61, v230
  v_accvgpr_read_b32 v230, a62
  v_mul_f32 v230, v230, v231
  v_accvgpr_write_b32 a62, v230
  v_accvgpr_read_b32 v230, a63
  v_mul_f32 v230, v230, v231
  v_accvgpr_write_b32 a63, v230
  v_accvgpr_read_b32 v230, a80
  v_mul_f32 v230, v230, v231
  v_accvgpr_write_b32 a80, v230
  v_accvgpr_read_b32 v230, a81
  v_mul_f32 v230, v230, v231
  v_accvgpr_write_b32 a81, v230
  v_accvgpr_read_b32 v230, a82
  v_mul_f32 v230, v230, v231
  v_accvgpr_write_b32 a82, v230
  v_accvgpr_read_b32 v230, a83
  v_mul_f32 v230, v230, v231
  v_accvgpr_write_b32 a83, v230
  v_accvgpr_read_b32 v230, a84
  v_mul_f32 v230, v230, v231
  v_accvgpr_write_b32 a84, v230
  v_accvgpr_read_b32 v230, a85
  v_mul_f32 v230, v230, v231
  v_accvgpr_write_b32 a85, v230
  v_accvgpr_read_b32 v230, a86
  v_mul_f32 v230, v230, v231
  v_accvgpr_write_b32 a86, v230
  v_accvgpr_read_b32 v230, a87
  v_mul_f32 v230, v230, v231
  v_accvgpr_write_b32 a87, v230
  v_accvgpr_read_b32 v230, a88
  v_mul_f32 v230, v230, v231
  v_accvgpr_write_b32 a88, v230
  v_accvgpr_read_b32 v230, a89
  v_mul_f32 v230, v230, v231
  v_accvgpr_write_b32 a89, v230
  v_accvgpr_read_b32 v230, a90
  v_mul_f32 v230, v230, v231
  v_accvgpr_write_b32 a90, v230
  v_accvgpr_read_b32 v230, a91
  v_mul_f32 v230, v230, v231
  v_accvgpr_write_b32 a91, v230
  v_accvgpr_read_b32 v230, a92
  v_mul_f32 v230, v230, v231
  v_accvgpr_write_b32 a92, v230
  v_accvgpr_read_b32 v230, a93
  v_mul_f32 v230, v230, v231
  v_accvgpr_write_b32 a93, v230
  v_accvgpr_read_b32 v230, a94
  v_mul_f32 v230, v230, v231
  v_accvgpr_write_b32 a94, v230
  v_accvgpr_read_b32 v230, a95
  v_mul_f32 v230, v230, v231
  v_accvgpr_write_b32 a95, v230
  v_accvgpr_read_b32 v230, a112
  v_mul_f32 v230, v230, v231
  v_accvgpr_write_b32 a112, v230
  v_accvgpr_read_b32 v230, a113
  v_mul_f32 v230, v230, v231
  v_accvgpr_write_b32 a113, v230
  v_accvgpr_read_b32 v230, a114
  v_mul_f32 v230, v230, v231
  v_accvgpr_write_b32 a114, v230
  v_accvgpr_read_b32 v230, a115
  v_mul_f32 v230, v230, v231
  v_accvgpr_write_b32 a115, v230
  v_accvgpr_read_b32 v230, a116
  v_mul_f32 v230, v230, v231
  v_accvgpr_write_b32 a116, v230
  v_accvgpr_read_b32 v230, a117
  v_mul_f32 v230, v230, v231
  v_accvgpr_write_b32 a117, v230
  v_accvgpr_read_b32 v230, a118
  v_mul_f32 v230, v230, v231
  v_accvgpr_write_b32 a118, v230
  v_accvgpr_read_b32 v230, a119
  v_mul_f32 v230, v230, v231
  v_accvgpr_write_b32 a119, v230
  v_accvgpr_read_b32 v230, a120
  v_mul_f32 v230, v230, v231
  v_accvgpr_write_b32 a120, v230
  v_accvgpr_read_b32 v230, a121
  v_mul_f32 v230, v230, v231
  v_accvgpr_write_b32 a121, v230
  v_accvgpr_read_b32 v230, a122
  v_mul_f32 v230, v230, v231
  v_accvgpr_write_b32 a122, v230
  v_accvgpr_read_b32 v230, a123
  v_mul_f32 v230, v230, v231
  v_accvgpr_write_b32 a123, v230
  v_accvgpr_read_b32 v230, a124
  v_mul_f32 v230, v230, v231
  v_accvgpr_write_b32 a124, v230
  v_accvgpr_read_b32 v230, a125
  v_mul_f32 v230, v230, v231
  v_accvgpr_write_b32 a125, v230
  v_accvgpr_read_b32 v230, a126
  v_mul_f32 v230, v230, v231
  v_accvgpr_write_b32 a126, v230
  v_accvgpr_read_b32 v230, a127
  v_mul_f32 v230, v230, v231
  v_accvgpr_write_b32 a127, v230
  v_accvgpr_read_b32 v230, a144
  v_mul_f32 v230, v230, v231
  v_accvgpr_write_b32 a144, v230
  v_accvgpr_read_b32 v230, a145
  v_mul_f32 v230, v230, v231
  v_accvgpr_write_b32 a145, v230
  v_accvgpr_read_b32 v230, a146
  v_mul_f32 v230, v230, v231
  v_accvgpr_write_b32 a146, v230
  v_accvgpr_read_b32 v230, a147
  v_mul_f32 v230, v230, v231
  v_accvgpr_write_b32 a147, v230
  v_accvgpr_read_b32 v230, a148
  v_mul_f32 v230, v230, v231
  v_accvgpr_write_b32 a148, v230
  v_accvgpr_read_b32 v230, a149
  v_mul_f32 v230, v230, v231
  v_accvgpr_write_b32 a149, v230
  v_accvgpr_read_b32 v230, a150
  v_mul_f32 v230, v230, v231
  v_accvgpr_write_b32 a150, v230
  v_accvgpr_read_b32 v230, a151
  v_mul_f32 v230, v230, v231
  v_accvgpr_write_b32 a151, v230
  v_accvgpr_read_b32 v230, a152
  v_mul_f32 v230, v230, v231
  v_accvgpr_write_b32 a152, v230
  v_accvgpr_read_b32 v230, a153
  v_mul_f32 v230, v230, v231
  v_accvgpr_write_b32 a153, v230
  v_accvgpr_read_b32 v230, a154
  v_mul_f32 v230, v230, v231
  v_accvgpr_write_b32 a154, v230
  v_accvgpr_read_b32 v230, a155
  v_mul_f32 v230, v230, v231
  v_accvgpr_write_b32 a155, v230
  v_accvgpr_read_b32 v230, a156
  v_mul_f32 v230, v230, v231
  v_accvgpr_write_b32 a156, v230
  v_accvgpr_read_b32 v230, a157
  v_mul_f32 v230, v230, v231
  v_accvgpr_write_b32 a157, v230
  v_accvgpr_read_b32 v230, a158
  v_mul_f32 v230, v230, v231
  v_accvgpr_write_b32 a158, v230
  v_accvgpr_read_b32 v230, a159
  v_mul_f32 v230, v230, v231
  v_accvgpr_write_b32 a159, v230
  v_accvgpr_read_b32 v230, a176
  v_mul_f32 v230, v230, v231
  v_accvgpr_write_b32 a176, v230
  v_accvgpr_read_b32 v230, a177
  v_mul_f32 v230, v230, v231
  v_accvgpr_write_b32 a177, v230
  v_accvgpr_read_b32 v230, a178
  v_mul_f32 v230, v230, v231
  v_accvgpr_write_b32 a178, v230
  v_accvgpr_read_b32 v230, a179
  v_mul_f32 v230, v230, v231
  v_accvgpr_write_b32 a179, v230
  v_accvgpr_read_b32 v230, a180
  v_mul_f32 v230, v230, v231
  v_accvgpr_write_b32 a180, v230
  v_accvgpr_read_b32 v230, a181
  v_mul_f32 v230, v230, v231
  v_accvgpr_write_b32 a181, v230
  v_accvgpr_read_b32 v230, a182
  v_mul_f32 v230, v230, v231
  v_accvgpr_write_b32 a182, v230
  v_accvgpr_read_b32 v230, a183
  v_mul_f32 v230, v230, v231
  v_accvgpr_write_b32 a183, v230
  v_accvgpr_read_b32 v230, a184
  v_mul_f32 v230, v230, v231
  v_accvgpr_write_b32 a184, v230
  v_accvgpr_read_b32 v230, a185
  v_mul_f32 v230, v230, v231
  v_accvgpr_write_b32 a185, v230
  v_accvgpr_read_b32 v230, a186
  v_mul_f32 v230, v230, v231
  v_accvgpr_write_b32 a186, v230
  v_accvgpr_read_b32 v230, a187
  v_mul_f32 v230, v230, v231
  v_accvgpr_write_b32 a187, v230
  v_accvgpr_read_b32 v230, a188
  v_mul_f32 v230, v230, v231
  v_accvgpr_write_b32 a188, v230
  v_accvgpr_read_b32 v230, a189
  v_mul_f32 v230, v230, v231
  v_accvgpr_write_b32 a189, v230
  v_accvgpr_read_b32 v230, a190
  v_mul_f32 v230, v230, v231
  v_accvgpr_write_b32 a190, v230
  v_accvgpr_read_b32 v230, a191
  v_mul_f32 v230, v230, v231
  v_accvgpr_write_b32 a191, v230
  v_exp_f32 v56, v96
  v_exp_f32 v57, v97
  v_exp_f32 v58, v98
  v_exp_f32 v59, v99
  v_add_f32 v226, v56, v57
  v_cvt_pk_bf16_f32 v144, v56, v57
  v_exp_f32 v60, v100
  v_exp_f32 v61, v101
  v_add_f32 v226, v226, v58
  v_add_f32 v226, v226, v59
  v_cvt_pk_bf16_f32 v145, v58, v59
  v_exp_f32 v62, v102
  v_exp_f32 v63, v103
  v_add_f32 v226, v226, v60
  v_add_f32 v226, v226, v61
  v_cvt_pk_bf16_f32 v146, v60, v61
  v_exp_f32 v56, v104
  v_exp_f32 v57, v105
  v_add_f32 v226, v226, v62
  v_add_f32 v226, v226, v63
  v_cvt_pk_bf16_f32 v147, v62, v63
  v_exp_f32 v58, v106
  v_exp_f32 v59, v107
  v_add_f32 v226, v226, v56
  v_add_f32 v226, v226, v57
  v_cvt_pk_bf16_f32 v148, v56, v57
  v_exp_f32 v60, v108
  v_exp_f32 v61, v109
  v_add_f32 v226, v226, v58
  v_add_f32 v226, v226, v59
  v_cvt_pk_bf16_f32 v149, v58, v59
  v_exp_f32 v62, v110
  v_exp_f32 v63, v111
  v_add_f32 v226, v226, v60
  v_add_f32 v226, v226, v61
  v_cvt_pk_bf16_f32 v150, v60, v61
  v_exp_f32 v56, v112
  v_exp_f32 v57, v113
  v_add_f32 v226, v226, v62
  v_add_f32 v226, v226, v63
  v_cvt_pk_bf16_f32 v151, v62, v63
  v_exp_f32 v58, v114
  v_exp_f32 v59, v115
  v_add_f32 v227, v56, v57
  v_cvt_pk_bf16_f32 v152, v56, v57
  v_exp_f32 v60, v116
  v_exp_f32 v61, v117
  v_add_f32 v227, v227, v58
  v_add_f32 v227, v227, v59
  v_cvt_pk_bf16_f32 v153, v58, v59
  v_exp_f32 v62, v118
  v_exp_f32 v63, v119
  v_add_f32 v227, v227, v60
  v_add_f32 v227, v227, v61
  v_cvt_pk_bf16_f32 v154, v60, v61
  v_exp_f32 v56, v120
  v_exp_f32 v57, v121
  v_add_f32 v227, v227, v62
  v_add_f32 v227, v227, v63
  v_cvt_pk_bf16_f32 v155, v62, v63
  v_exp_f32 v58, v122
  v_exp_f32 v59, v123
  v_add_f32 v227, v227, v56
  v_add_f32 v227, v227, v57
  v_cvt_pk_bf16_f32 v156, v56, v57
  v_exp_f32 v60, v124
  v_exp_f32 v61, v125
  v_add_f32 v227, v227, v58
  v_add_f32 v227, v227, v59
  v_cvt_pk_bf16_f32 v157, v58, v59
  v_exp_f32 v62, v126
  v_exp_f32 v63, v127
  v_add_f32 v227, v227, v60
  v_add_f32 v227, v227, v61
  v_cvt_pk_bf16_f32 v158, v60, v61
  s_nop 0
  v_add_f32 v227, v227, v62
  v_add_f32 v227, v227, v63
  v_cvt_pk_bf16_f32 v159, v62, v63
  s_nop 7
  s_branch RARE1_ret
RARE0:
  s_nop 15
  s_nop 15
  v_max3_f32 v229, v64, v65, v66
  v_max3_f32 v229, v229, v67, v68
  v_max3_f32 v229, v229, v69, v70
  v_max3_f32 v229, v229, v71, v72
  v_max3_f32 v229, v229, v73, v74
  v_max3_f32 v229, v229, v75, v76
  v_max3_f32 v229, v229, v77, v78
  v_max_f32 v229, v229, v79
  v_mov_b32 v230, v229
  s_nop 1
  v_permlane32_swap_b32 v229, v230
  s_nop 1
  v_max_f32 v229, v229, v230
  v_max_f32 v229, 0, v229
  v_sub_f32 v231, 0, v229
  v_exp_f32 v231, v231
  s_nop 1
  v_sub_f32 v64, v64, v229
  v_sub_f32 v96, v96, v229
  v_sub_f32 v160, v160, v229
  v_sub_f32 v65, v65, v229
  v_sub_f32 v97, v97, v229
  v_sub_f32 v161, v161, v229
  v_sub_f32 v66, v66, v229
  v_sub_f32 v98, v98, v229
  v_sub_f32 v162, v162, v229
  v_sub_f32 v67, v67, v229
  v_sub_f32 v99, v99, v229
  v_sub_f32 v163, v163, v229
  v_sub_f32 v68, v68, v229
  v_sub_f32 v100, v100, v229
  v_sub_f32 v164, v164, v229
  v_sub_f32 v69, v69, v229
  v_sub_f32 v101, v101, v229
  v_sub_f32 v165, v165, v229
  v_sub_f32 v70, v70, v229
  v_sub_f32 v102, v102, v229
  v_sub_f32 v166, v166, v229
  v_sub_f32 v71, v71, v229
  v_sub_f32 v103, v103, v229
  v_sub_f32 v167, v167, v229
  v_sub_f32 v72, v72, v229
  v_sub_f32 v104, v104, v229
  v_sub_f32 v168, v168, v229
  v_sub_f32 v73, v73, v229
  v_sub_f32 v105, v105, v229
  v_sub_f32 v169, v169, v229
  v_sub_f32 v74, v74, v229
  v_sub_f32 v106, v106, v229
  v_sub_f32 v170, v170, v229
  v_sub_f32 v75, v75, v229
  v_sub_f32 v107, v107, v229
  v_sub_f32 v171, v171, v229
  v_sub_f32 v76, v76, v229
  v_sub_f32 v108, v108, v229
  v_sub_f32 v172, v172, v229
  v_sub_f32 v77, v77, v229
  v_sub_f32 v109, v109, v229
  v_sub_f32 v173, v173, v229
  v_sub_f32 v78, v78, v229
  v_sub_f32 v110, v110, v229
  v_sub_f32 v174, v174, v229
  v_sub_f32 v79, v79, v229
  v_sub_f32 v111, v111, v229
  v_sub_f32 v175, v175, v229
  v_mul_f32 v224, v224, v231
  v_accvgpr_read_b32 v230, a0
  v_mul_f32 v230, v230, v231
  v_accvgpr_write_b32 a0, v230
  v_accvgpr_read_b32 v230, a1
  v_mul_f32 v230, v230, v231
  v_accvgpr_write_b32 a1, v230
  v_accvgpr_read_b32 v230, a2
  v_mul_f32 v230, v230, v231
  v_accvgpr_write_b32 a2, v230
  v_accvgpr_read_b32 v230, a3
  v_mul_f32 v230, v230, v231
  v_accvgpr_write_b32 a3, v230
  v_accvgpr_read_b32 v230, a4
  v_mul_f32 v230, v230, v231
  v_accvgpr_write_b32 a4, v230
  v_accvgpr_read_b32 v230, a5
  v_mul_f32 v230, v230, v231
  v_accvgpr_write_b32 a5, v230
  v_accvgpr_read_b32 v230, a6
  v_mul_f32 v230, v230, v231
  v_accvgpr_write_b32 a6, v230
  v_accvgpr_read_b32 v230, a7
  v_mul_f32 v230, v230, v231
  v_accvgpr_write_b32 a7, v230
  v_accvgpr_read_b32 v230, a8
  v_mul_f32 v230, v230, v231
  v_accvgpr_write_b32 a8, v230
  v_accvgpr_read_b32 v230, a9
  v_mul_f32 v230, v230, v231
  v_accvgpr_write_b32 a9, v230
  v_accvgpr_read_b32 v230, a10
  v_mul_f32 v230, v230, v231
  v_accvgpr_write_b32 a10, v230
  v_accvgpr_read_b32 v230, a11
  v_mul_f32 v230, v230, v231
  v_accvgpr_write_b32 a11, v230
  v_accvgpr_read_b32 v230, a12
  v_mul_f32 v230, v230, v231
  v_accvgpr_write_b32 a12, v230
  v_accvgpr_read_b32 v230, a13
  v_mul_f32 v230, v230, v231
  v_accvgpr_write_b32 a13, v230
  v_accvgpr_read_b32 v230, a14
  v_mul_f32 v230, v230, v231
  v_accvgpr_write_b32 a14, v230
  v_accvgpr_read_b32 v230, a15
  v_mul_f32 v230, v230, v231
  v_accvgpr_write_b32 a15, v230
  v_accvgpr_read_b32 v230, a32
  v_mul_f32 v230, v230, v231
  v_accvgpr_write_b32 a32, v230
  v_accvgpr_read_b32 v230, a33
  v_mul_f32 v230, v230, v231
  v_accvgpr_write_b32 a33, v230
  v_accvgpr_read_b32 v230, a34
  v_mul_f32 v230, v230, v231
  v_accvgpr_write_b32 a34, v230
  v_accvgpr_read_b32 v230, a35
  v_mul_f32 v230, v230, v231
  v_accvgpr_write_b32 a35, v230
  v_accvgpr_read_b32 v230, a36
  v_mul_f32 v230, v230, v231
  v_accvgpr_write_b32 a36, v230
  v_accvgpr_read_b32 v230, a37
  v_mul_f32 v230, v230, v231
  v_accvgpr_write_b32 a37, v230
  v_accvgpr_read_b32 v230, a38
  v_mul_f32 v230, v230, v231
  v_accvgpr_write_b32 a38, v230
  v_accvgpr_read_b32 v230, a39
  v_mul_f32 v230, v230, v231
  v_accvgpr_write_b32 a39, v230
  v_accvgpr_read_b32 v230, a40
  v_mul_f32 v230, v230, v231
  v_accvgpr_write_b32 a40, v230
  v_accvgpr_read_b32 v230, a41
  v_mul_f32 v230, v230, v231
  v_accvgpr_write_b32 a41, v230
  v_accvgpr_read_b32 v230, a42
  v_mul_f32 v230, v230, v231
  v_accvgpr_write_b32 a42, v230
  v_accvgpr_read_b32 v230, a43
  v_mul_f32 v230, v230, v231
  v_accvgpr_write_b32 a43, v230
  v_accvgpr_read_b32 v230, a44
  v_mul_f32 v230, v230, v231
  v_accvgpr_write_b32 a44, v230
  v_accvgpr_read_b32 v230, a45
  v_mul_f32 v230, v230, v231
  v_accvgpr_write_b32 a45, v230
  v_accvgpr_read_b32 v230, a46
  v_mul_f32 v230, v230, v231
  v_accvgpr_write_b32 a46, v230
  v_accvgpr_read_b32 v230, a47
  v_mul_f32 v230, v230, v231
  v_accvgpr_write_b32 a47, v230
  v_accvgpr_read_b32 v230, a64
  v_mul_f32 v230, v230, v231
  v_accvgpr_write_b32 a64, v230
  v_accvgpr_read_b32 v230, a65
  v_mul_f32 v230, v230, v231
  v_accvgpr_write_b32 a65, v230
  v_accvgpr_read_b32 v230, a66
  v_mul_f32 v230, v230, v231
  v_accvgpr_write_b32 a66, v230
  v_accvgpr_read_b32 v230, a67
  v_mul_f32 v230, v230, v231
  v_accvgpr_write_b32 a67, v230
  v_accvgpr_read_b32 v230, a68
  v_mul_f32 v230, v230, v231
  v_accvgpr_write_b32 a68, v230
  v_accvgpr_read_b32 v230, a69
  v_mul_f32 v230, v230, v231
  v_accvgpr_write_b32 a69, v230
  v_accvgpr_read_b32 v230, a70
  v_mul_f32 v230, v230, v231
  v_accvgpr_write_b32 a70, v230
  v_accvgpr_read_b32 v230, a71
  v_mul_f32 v230, v230, v231
  v_accvgpr_write_b32 a71, v230
  v_accvgpr_read_b32 v230, a72
  v_mul_f32 v230, v230, v231
  v_accvgpr_write_b32 a72, v230
  v_accvgpr_read_b32 v230, a73
  v_mul_f32 v230, v230, v231
  v_accvgpr_write_b32 a73, v230
  v_accvgpr_read_b32 v230, a74
  v_mul_f32 v230, v230, v231
  v_accvgpr_write_b32 a74, v230
  v_accvgpr_read_b32 v230, a75
  v_mul_f32 v230, v230, v231
  v_accvgpr_write_b32 a75, v230
  v_accvgpr_read_b32 v230, a76
  v_mul_f32 v230, v230, v231
  v_accvgpr_write_b32 a76, v230
  v_accvgpr_read_b32 v230, a77
  v_mul_f32 v230, v230, v231
  v_accvgpr_write_b32 a77, v230
  v_accvgpr_read_b32 v230, a78
  v_mul_f32 v230, v230, v231
  v_accvgpr_write_b32 a78, v230
  v_accvgpr_read_b32 v230, a79
  v_mul_f32 v230, v230, v231
  v_accvgpr_write_b32 a79, v230
  v_accvgpr_read_b32 v230, a96
  v_mul_f32 v230, v230, v231
  v_accvgpr_write_b32 a96, v230
  v_accvgpr_read_b32 v230, a97
  v_mul_f32 v230, v230, v231
  v_accvgpr_write_b32 a97, v230
  v_accvgpr_read_b32 v230, a98
  v_mul_f32 v230, v230, v231
  v_accvgpr_write_b32 a98, v230
  v_accvgpr_read_b32 v230, a99
  v_mul_f32 v230, v230, v231
  v_accvgpr_write_b32 a99, v230
  v_accvgpr_read_b32 v230, a100
  v_mul_f32 v230, v230, v231
  v_accvgpr_write_b32 a100, v230
  v_accvgpr_read_b32 v230, a101
  v_mul_f32 v230, v230, v231
  v_accvgpr_write_b32 a101, v230
  v_accvgpr_read_b32 v230, a102
  v_mul_f32 v230, v230, v231
  v_accvgpr_write_b32 a102, v230
  v_accvgpr_read_b32 v230, a103
  v_mul_f32 v230, v230, v231
  v_accvgpr_write_b32 a103, v230
  v_accvgpr_read_b32 v230, a104
  v_mul_f32 v230, v230, v231
  v_accvgpr_write_b32 a104, v230
  v_accvgpr_read_b32 v230, a105
  v_mul_f32 v230, v230, v231
  v_accvgpr_write_b32 a105, v230
  v_accvgpr_read_b32 v230, a106
  v_mul_f32 v230, v230, v231
  v_accvgpr_write_b32 a106, v230
  v_accvgpr_read_b32 v230, a107
  v_mul_f32 v230, v230, v231
  v_accvgpr_write_b32 a107, v230
  v_accvgpr_read_b32 v230, a108
  v_mul_f32 v230, v230, v231
  v_accvgpr_write_b32 a108, v230
  v_accvgpr_read_b32 v230, a109
  v_mul_f32 v230, v230, v231
  v_accvgpr_write_b32 a109, v230
  v_accvgpr_read_b32 v230, a110
  v_mul_f32 v230, v230, v231
  v_accvgpr_write_b32 a110, v230
  v_accvgpr_read_b32 v230, a111
  v_mul_f32 v230, v230, v231
  v_accvgpr_write_b32 a111, v230
  v_accvgpr_read_b32 v230, a128
  v_mul_f32 v230, v230, v231
  v_accvgpr_write_b32 a128, v230
  v_accvgpr_read_b32 v230, a129
  v_mul_f32 v230, v230, v231
  v_accvgpr_write_b32 a129, v230
  v_accvgpr_read_b32 v230, a130
  v_mul_f32 v230, v230, v231
  v_accvgpr_write_b32 a130, v230
  v_accvgpr_read_b32 v230, a131
  v_mul_f32 v230, v230, v231
  v_accvgpr_write_b32 a131, v230
  v_accvgpr_read_b32 v230, a132
  v_mul_f32 v230, v230, v231
  v_accvgpr_write_b32 a132, v230
  v_accvgpr_read_b32 v230, a133
  v_mul_f32 v230, v230, v231
  v_accvgpr_write_b32 a133, v230
  v_accvgpr_read_b32 v230, a134
  v_mul_f32 v230, v230, v231
  v_accvgpr_write_b32 a134, v230
  v_accvgpr_read_b32 v230, a135
  v_mul_f32 v230, v230, v231
  v_accvgpr_write_b32 a135, v230
  v_accvgpr_read_b32 v230, a136
  v_mul_f32 v230, v230, v231
  v_accvgpr_write_b32 a136, v230
  v_accvgpr_read_b32 v230, a137
  v_mul_f32 v230, v230, v231
  v_accvgpr_write_b32 a137, v230
  v_accvgpr_read_b32 v230, a138
  v_mul_f32 v230, v230, v231
  v_accvgpr_write_b32 a138, v230
  v_accvgpr_read_b32 v230, a139
  v_mul_f32 v230, v230, v231
  v_accvgpr_write_b32 a139, v230
  v_accvgpr_read_b32 v230, a140
  v_mul_f32 v230, v230, v231
  v_accvgpr_write_b32 a140, v230
  v_accvgpr_read_b32 v230, a141
  v_mul_f32 v230, v230, v231
  v_accvgpr_write_b32 a141, v230
  v_accvgpr_read_b32 v230, a142
  v_mul_f32 v230, v230, v231
  v_accvgpr_write_b32 a142, v230
  v_accvgpr_read_b32 v230, a143
  v_mul_f32 v230, v230, v231
  v_accvgpr_write_b32 a143, v230
  v_accvgpr_read_b32 v230, a160
  v_mul_f32 v230, v230, v231
  v_accvgpr_write_b32 a160, v230
  v_accvgpr_read_b32 v230, a161
  v_mul_f32 v230, v230, v231
  v_accvgpr_write_b32 a161, v230
  v_accvgpr_read_b32 v230, a162
  v_mul_f32 v230, v230, v231
  v_accvgpr_write_b32 a162, v230
  v_accvgpr_read_b32 v230, a163
  v_mul_f32 v230, v230, v231
  v_accvgpr_write_b32 a163, v230
  v_accvgpr_read_b32 v230, a164
  v_mul_f32 v230, v230, v231
  v_accvgpr_write_b32 a164, v230
  v_accvgpr_read_b32 v230, a165
  v_mul_f32 v230, v230, v231
  v_accvgpr_write_b32 a165, v230
  v_accvgpr_read_b32 v230, a166
  v_mul_f32 v230, v230, v231
  v_accvgpr_write_b32 a166, v230
  v_accvgpr_read_b32 v230, a167
  v_mul_f32 v230, v230, v231
  v_accvgpr_write_b32 a167, v230
  v_accvgpr_read_b32 v230, a168
  v_mul_f32 v230, v230, v231
  v_accvgpr_write_b32 a168, v230
  v_accvgpr_read_b32 v230, a169
  v_mul_f32 v230, v230, v231
  v_accvgpr_write_b32 a169, v230
  v_accvgpr_read_b32 v230, a170
  v_mul_f32 v230, v230, v231
  v_accvgpr_write_b32 a170, v230
  v_accvgpr_read_b32 v230, a171
  v_mul_f32 v230, v230, v231
  v_accvgpr_write_b32 a171, v230
  v_accvgpr_read_b32 v230, a172
  v_mul_f32 v230, v230, v231
  v_accvgpr_write_b32 a172, v230
  v_accvgpr_read_b32 v230, a173
  v_mul_f32 v230, v230, v231
  v_accvgpr_write_b32 a173, v230
  v_accvgpr_read_b32 v230, a174
  v_mul_f32 v230, v230, v231
  v_accvgpr_write_b32 a174, v230
  v_accvgpr_read_b32 v230, a175
  v_mul_f32 v230, v230, v231
  v_accvgpr_write_b32 a175, v230
  v_max3_f32 v229, v80, v81, v82
  v_max3_f32 v229, v229, v83, v84
  v_max3_f32 v229, v229, v85, v86
  v_max3_f32 v229, v229, v87, v88
  v_max3_f32 v229, v229, v89, v90
  v_max3_f32 v229, v229, v91, v92
  v_max3_f32 v229, v229, v93, v94
  v_max_f32 v229, v229, v95
  v_mov_b32 v230, v229
  s_nop 1
  v_permlane32_swap_b32 v229, v230
  s_nop 1
  v_max_f32 v229, v229, v230
  v_max_f32 v229, 0, v229
  v_sub_f32 v231, 0, v229
  v_exp_f32 v231, v231
  s_nop 1
  v_sub_f32 v80, v80, v229
  v_sub_f32 v112, v112, v229
  v_sub_f32 v176, v176, v229
  v_sub_f32 v81, v81, v229
  v_sub_f32 v113, v113, v229
  v_sub_f32 v177, v177, v229
  v_sub_f32 v82, v82, v229
  v_sub_f32 v114, v114, v229
  v_sub_f32 v178, v178, v229
  v_sub_f32 v83, v83, v229
  v_sub_f32 v115, v115, v229
  v_sub_f32 v179, v179, v229
  v_sub_f32 v84, v84, v229
  v_sub_f32 v116, v116, v229
  v_sub_f32 v180, v180, v229
  v_sub_f32 v85, v85, v229
  v_sub_f32 v117, v117, v229
  v_sub_f32 v181, v181, v229
  v_sub_f32 v86, v86, v229
  v_sub_f32 v118, v118, v229
  v_sub_f32 v182, v182, v229
  v_sub_f32 v87, v87, v229
  v_sub_f32 v119, v119, v229
  v_sub_f32 v183, v183, v229
  v_sub_f32 v88, v88, v229
  v_sub_f32 v120, v120, v229
  v_sub_f32 v184, v184, v229
  v_sub_f32 v89, v89, v229
  v_sub_f32 v121, v121, v229
  v_sub_f32 v185, v185, v229
  v_sub_f32 v90, v90, v229
  v_sub_f32 v122, v122, v229
  v_sub_f32 v186, v186, v229
  v_sub_f32 v91, v91, v229
  v_sub_f32 v123, v123, v229
  v_sub_f32 v187, v187, v229
  v_sub_f32 v92, v92, v229
  v_sub_f32 v124, v124, v229
  v_sub_f32 v188, v188, v229
  v_sub_f32 v93, v93, v229
  v_sub_f32 v125, v125, v229
  v_sub_f32 v189, v189, v229
  v_sub_f32 v94, v94, v229
  v_sub_f32 v126, v126, v229
  v_sub_f32 v190, v190, v229
  v_sub_f32 v95, v95, v229
  v_sub_f32 v127, v127, v229
  v_sub_f32 v191, v191, v229
  v_mul_f32 v225, v225, v231
  v_accvgpr_read_b32 v230, a16
  v_mul_f32 v230, v230, v231
  v_accvgpr_write_b32 a16, v230
  v_accvgpr_read_b32 v230, a17
  v_mul_f32 v230, v230, v231
  v_accvgpr_write_b32 a17, v230
  v_accvgpr_read_b32 v230, a18
  v_mul_f32 v230, v230, v231
  v_accvgpr_write_b32 a18, v230
  v_accvgpr_read_b32 v230, a19
  v_mul_f32 v230, v230, v231
  v_accvgpr_write_b32 a19, v230
  v_accvgpr_read_b32 v230, a20
  v_mul_f32 v230, v230, v231
  v_accvgpr_write_b32 a20, v230
  v_accvgpr_read_b32 v230, a21
  v_mul_f32 v230, v230, v231
  v_accvgpr_write_b32 a21, v230
  v_accvgpr_read_b32 v230, a22
  v_mul_f32 v230, v230, v231
  v_accvgpr_write_b32 a22, v230
  v_accvgpr_read_b32 v230, a23
  v_mul_f32 v230, v230, v231
  v_accvgpr_write_b32 a23, v230
  v_accvgpr_read_b32 v230, a24
  v_mul_f32 v230, v230, v231
  v_accvgpr_write_b32 a24, v230
  v_accvgpr_read_b32 v230, a25
  v_mul_f32 v230, v230, v231
  v_accvgpr_write_b32 a25, v230
  v_accvgpr_read_b32 v230, a26
  v_mul_f32 v230, v230, v231
  v_accvgpr_write_b32 a26, v230
  v_accvgpr_read_b32 v230, a27
  v_mul_f32 v230, v230, v231
  v_accvgpr_write_b32 a27, v230
  v_accvgpr_read_b32 v230, a28
  v_mul_f32 v230, v230, v231
  v_accvgpr_write_b32 a28, v230
  v_accvgpr_read_b32 v230, a29
  v_mul_f32 v230, v230, v231
  v_accvgpr_write_b32 a29, v230
  v_accvgpr_read_b32 v230, a30
  v_mul_f32 v230, v230, v231
  v_accvgpr_write_b32 a30, v230
  v_accvgpr_read_b32 v230, a31
  v_mul_f32 v230, v230, v231
  v_accvgpr_write_b32 a31, v230
  v_accvgpr_read_b32 v230, a48
  v_mul_f32 v230, v230, v231
  v_accvgpr_write_b32 a48, v230
  v_accvgpr_read_b32 v230, a49
  v_mul_f32 v230, v230, v231
  v_accvgpr_write_b32 a49, v230
  v_accvgpr_read_b32 v230, a50
  v_mul_f32 v230, v230, v231
  v_accvgpr_write_b32 a50, v230
  v_accvgpr_read_b32 v230, a51
  v_mul_f32 v230, v230, v231
  v_accvgpr_write_b32 a51, v230
  v_accvgpr_read_b32 v230, a52
  v_mul_f32 v230, v230, v231
  v_accvgpr_write_b32 a52, v230
  v_accvgpr_read_b32 v230, a53
  v_mul_f32 v230, v230, v231
  v_accvgpr_write_b32 a53, v230
  v_accvgpr_read_b32 v230, a54
  v_mul_f32 v230, v230, v231
  v_accvgpr_write_b32 a54, v230
  v_accvgpr_read_b32 v230, a55
  v_mul_f32 v230, v230, v231
  v_accvgpr_write_b32 a55, v230
  v_accvgpr_read_b32 v230, a56
  v_mul_f32 v230, v230, v231
  v_accvgpr_write_b32 a56, v230
  v_accvgpr_read_b32 v230, a57
  v_mul_f32 v230, v230, v231
  v_accvgpr_write_b32 a57, v230
  v_accvgpr_read_b32 v230, a58
  v_mul_f32 v230, v230, v231
  v_accvgpr_write_b32 a58, v230
  v_accvgpr_read_b32 v230, a59
  v_mul_f32 v230, v230, v231
  v_accvgpr_write_b32 a59, v230
  v_accvgpr_read_b32 v230, a60
  v_mul_f32 v230, v230, v231
  v_accvgpr_write_b32 a60, v230
  v_accvgpr_read_b32 v230, a61
  v_mul_f32 v230, v230, v231
  v_accvgpr_write_b32 a61, v230
  v_accvgpr_read_b32 v230, a62
  v_mul_f32 v230, v230, v231
  v_accvgpr_write_b32 a62, v230
  v_accvgpr_read_b32 v230, a63
  v_mul_f32 v230, v230, v231
  v_accvgpr_write_b32 a63, v230
  v_accvgpr_read_b32 v230, a80
  v_mul_f32 v230, v230, v231
  v_accvgpr_write_b32 a80, v230
  v_accvgpr_read_b32 v230, a81
  v_mul_f32 v230, v230, v231
  v_accvgpr_write_b32 a81, v230
  v_accvgpr_read_b32 v230, a82
  v_mul_f32 v230, v230, v231
  v_accvgpr_write_b32 a82, v230
  v_accvgpr_read_b32 v230, a83
  v_mul_f32 v230, v230, v231
  v_accvgpr_write_b32 a83, v230
  v_accvgpr_read_b32 v230, a84
  v_mul_f32 v230, v230, v231
  v_accvgpr_write_b32 a84, v230
  v_accvgpr_read_b32 v230, a85
  v_mul_f32 v230, v230, v231
  v_accvgpr_write_b32 a85, v230
  v_accvgpr_read_b32 v230, a86
  v_mul_f32 v230, v230, v231
  v_accvgpr_write_b32 a86, v230
  v_accvgpr_read_b32 v230, a87
  v_mul_f32 v230, v230, v231
  v_accvgpr_write_b32 a87, v230
  v_accvgpr_read_b32 v230, a88
  v_mul_f32 v230, v230, v231
  v_accvgpr_write_b32 a88, v230
  v_accvgpr_read_b32 v230, a89
  v_mul_f32 v230, v230, v231
  v_accvgpr_write_b32 a89, v230
  v_accvgpr_read_b32 v230, a90
  v_mul_f32 v230, v230, v231
  v_accvgpr_write_b32 a90, v230
  v_accvgpr_read_b32 v230, a91
  v_mul_f32 v230, v230, v231
  v_accvgpr_write_b32 a91, v230
  v_accvgpr_read_b32 v230, a92
  v_mul_f32 v230, v230, v231
  v_accvgpr_write_b32 a92, v230
  v_accvgpr_read_b32 v230, a93
  v_mul_f32 v230, v230, v231
  v_accvgpr_write_b32 a93, v230
  v_accvgpr_read_b32 v230, a94
  v_mul_f32 v230, v230, v231
  v_accvgpr_write_b32 a94, v230
  v_accvgpr_read_b32 v230, a95
  v_mul_f32 v230, v230, v231
  v_accvgpr_write_b32 a95, v230
  v_accvgpr_read_b32 v230, a112
  v_mul_f32 v230, v230, v231
  v_accvgpr_write_b32 a112, v230
  v_accvgpr_read_b32 v230, a113
  v_mul_f32 v230, v230, v231
  v_accvgpr_write_b32 a113, v230
  v_accvgpr_read_b32 v230, a114
  v_mul_f32 v230, v230, v231
  v_accvgpr_write_b32 a114, v230
  v_accvgpr_read_b32 v230, a115
  v_mul_f32 v230, v230, v231
  v_accvgpr_write_b32 a115, v230
  v_accvgpr_read_b32 v230, a116
  v_mul_f32 v230, v230, v231
  v_accvgpr_write_b32 a116, v230
  v_accvgpr_read_b32 v230, a117
  v_mul_f32 v230, v230, v231
  v_accvgpr_write_b32 a117, v230
  v_accvgpr_read_b32 v230, a118
  v_mul_f32 v230, v230, v231
  v_accvgpr_write_b32 a118, v230
  v_accvgpr_read_b32 v230, a119
  v_mul_f32 v230, v230, v231
  v_accvgpr_write_b32 a119, v230
  v_accvgpr_read_b32 v230, a120
  v_mul_f32 v230, v230, v231
  v_accvgpr_write_b32 a120, v230
  v_accvgpr_read_b32 v230, a121
  v_mul_f32 v230, v230, v231
  v_accvgpr_write_b32 a121, v230
  v_accvgpr_read_b32 v230, a122
  v_mul_f32 v230, v230, v231
  v_accvgpr_write_b32 a122, v230
  v_accvgpr_read_b32 v230, a123
  v_mul_f32 v230, v230, v231
  v_accvgpr_write_b32 a123, v230
  v_accvgpr_read_b32 v230, a124
  v_mul_f32 v230, v230, v231
  v_accvgpr_write_b32 a124, v230
  v_accvgpr_read_b32 v230, a125
  v_mul_f32 v230, v230, v231
  v_accvgpr_write_b32 a125, v230
  v_accvgpr_read_b32 v230, a126
  v_mul_f32 v230, v230, v231
  v_accvgpr_write_b32 a126, v230
  v_accvgpr_read_b32 v230, a127
  v_mul_f32 v230, v230, v231
  v_accvgpr_write_b32 a127, v230
  v_accvgpr_read_b32 v230, a144
  v_mul_f32 v230, v230, v231
  v_accvgpr_write_b32 a144, v230
  v_accvgpr_read_b32 v230, a145
  v_mul_f32 v230, v230, v231
  v_accvgpr_write_b32 a145, v230
  v_accvgpr_read_b32 v230, a146
  v_mul_f32 v230, v230, v231
  v_accvgpr_write_b32 a146, v230
  v_accvgpr_read_b32 v230, a147
  v_mul_f32 v230, v230, v231
  v_accvgpr_write_b32 a147, v230
  v_accvgpr_read_b32 v230, a148
  v_mul_f32 v230, v230, v231
  v_accvgpr_write_b32 a148, v230
  v_accvgpr_read_b32 v230, a149
  v_mul_f32 v230, v230, v231
  v_accvgpr_write_b32 a149, v230
  v_accvgpr_read_b32 v230, a150
  v_mul_f32 v230, v230, v231
  v_accvgpr_write_b32 a150, v230
  v_accvgpr_read_b32 v230, a151
  v_mul_f32 v230, v230, v231
  v_accvgpr_write_b32 a151, v230
  v_accvgpr_read_b32 v230, a152
  v_mul_f32 v230, v230, v231
  v_accvgpr_write_b32 a152, v230
  v_accvgpr_read_b32 v230, a153
  v_mul_f32 v230, v230, v231
  v_accvgpr_write_b32 a153, v230
  v_accvgpr_read_b32 v230, a154
  v_mul_f32 v230, v230, v231
  v_accvgpr_write_b32 a154, v230
  v_accvgpr_read_b32 v230, a155
  v_mul_f32 v230, v230, v231
  v_accvgpr_write_b32 a155, v230
  v_accvgpr_read_b32 v230, a156
  v_mul_f32 v230, v230, v231
  v_accvgpr_write_b32 a156, v230
  v_accvgpr_read_b32 v230, a157
  v_mul_f32 v230, v230, v231
  v_accvgpr_write_b32 a157, v230
  v_accvgpr_read_b32 v230, a158
  v_mul_f32 v230, v230, v231
  v_accvgpr_write_b32 a158, v230
  v_accvgpr_read_b32 v230, a159
  v_mul_f32 v230, v230, v231
  v_accvgpr_write_b32 a159, v230
  v_accvgpr_read_b32 v230, a176
  v_mul_f32 v230, v230, v231
  v_accvgpr_write_b32 a176, v230
  v_accvgpr_read_b32 v230, a177
  v_mul_f32 v230, v230, v231
  v_accvgpr_write_b32 a177, v230
  v_accvgpr_read_b32 v230, a178
  v_mul_f32 v230, v230, v231
  v_accvgpr_write_b32 a178, v230
  v_accvgpr_read_b32 v230, a179
  v_mul_f32 v230, v230, v231
  v_accvgpr_write_b32 a179, v230
  v_accvgpr_read_b32 v230, a180
  v_mul_f32 v230, v230, v231
  v_accvgpr_write_b32 a180, v230
  v_accvgpr_read_b32 v230, a181
  v_mul_f32 v230, v230, v231
  v_accvgpr_write_b32 a181, v230
  v_accvgpr_read_b32 v230, a182
  v_mul_f32 v230, v230, v231
  v_accvgpr_write_b32 a182, v230
  v_accvgpr_read_b32 v230, a183
  v_mul_f32 v230, v230, v231
  v_accvgpr_write_b32 a183, v230
  v_accvgpr_read_b32 v230, a184
  v_mul_f32 v230, v230, v231
  v_accvgpr_write_b32 a184, v230
  v_accvgpr_read_b32 v230, a185
  v_mul_f32 v230, v230, v231
  v_accvgpr_write_b32 a185, v230
  v_accvgpr_read_b32 v230, a186
  v_mul_f32 v230, v230, v231
  v_accvgpr_write_b32 a186, v230
  v_accvgpr_read_b32 v230, a187
  v_mul_f32 v230, v230, v231
  v_accvgpr_write_b32 a187, v230
  v_accvgpr_read_b32 v230, a188
  v_mul_f32 v230, v230, v231
  v_accvgpr_write_b32 a188, v230
  v_accvgpr_read_b32 v230, a189
  v_mul_f32 v230, v230, v231
  v_accvgpr_write_b32 a189, v230
  v_accvgpr_read_b32 v230, a190
  v_mul_f32 v230, v230, v231
  v_accvgpr_write_b32 a190, v230
  v_accvgpr_read_b32 v230, a191
  v_mul_f32 v230, v230, v231
  v_accvgpr_write_b32 a191, v230
  v_exp_f32 v56, v64
  v_exp_f32 v57, v65
  v_exp_f32 v58, v66
  v_exp_f32 v59, v67
  v_add_f32 v226, v56, v57
  v_cvt_pk_bf16_f32 v128, v56, v57
  v_exp_f32 v60, v68
  v_exp_f32 v61, v69
  v_add_f32 v226, v226, v58
  v_add_f32 v226, v226, v59
  v_cvt_pk_bf16_f32 v129, v58, v59
  v_exp_f32 v62, v70
  v_exp_f32 v63, v71
  v_add_f32 v226, v226, v60
  v_add_f32 v226, v226, v61
  v_cvt_pk_bf16_f32 v130, v60, v61
  v_exp_f32 v56, v72
  v_exp_f32 v57, v73
  v_add_f32 v226, v226, v62
  v_add_f32 v226, v226, v63
  v_cvt_pk_bf16_f32 v131, v62, v63
  v_exp_f32 v58, v74
  v_exp_f32 v59, v75
  v_add_f32 v226, v226, v56
  v_add_f32 v226, v226, v57
  v_cvt_pk_bf16_f32 v132, v56, v57
  v_exp_f32 v60, v76
  v_exp_f32 v61, v77
  v_add_f32 v226, v226, v58
  v_add_f32 v226, v226, v59
  v_cvt_pk_bf16_f32 v133, v58, v59
  v_exp_f32 v62, v78
  v_exp_f32 v63, v79
  v_add_f32 v226, v226, v60
  v_add_f32 v226, v226, v61
  v_cvt_pk_bf16_f32 v134, v60, v61
  v_exp_f32 v56, v80
  v_exp_f32 v57, v81
  v_add_f32 v226, v226, v62
  v_add_f32 v226, v226, v63
  v_cvt_pk_bf16_f32 v135, v62, v63
  v_exp_f32 v58, v82
  v_exp_f32 v59, v83
  v_add_f32 v227, v56, v57
  v_cvt_pk_bf16_f32 v136, v56, v57
  v_exp_f32 v60, v84
  v_exp_f32 v61, v85
  v_add_f32 v227, v227, v58
  v_add_f32 v227, v227, v59
  v_cvt_pk_bf16_f32 v137, v58, v59
  v_exp_f32 v62, v86
  v_exp_f32 v63, v87
  v_add_f32 v227, v227, v60
  v_add_f32 v227, v227, v61
  v_cvt_pk_bf16_f32 v138, v60, v61
  v_exp_f32 v56, v88
  v_exp_f32 v57, v89
  v_add_f32 v227, v227, v62
  v_add_f32 v227, v227, v63
  v_cvt_pk_bf16_f32 v139, v62, v63
  v_exp_f32 v58, v90
  v_exp_f32 v59, v91
  v_add_f32 v227, v227, v56
  v_add_f32 v227, v227, v57
  v_cvt_pk_bf16_f32 v140, v56, v57
  v_exp_f32 v60, v92
  v_exp_f32 v61, v93
  v_add_f32 v227, v227, v58
  v_add_f32 v227, v227, v59
  v_cvt_pk_bf16_f32 v141, v58, v59
  v_exp_f32 v62, v94
  v_exp_f32 v63, v95
  v_add_f32 v227, v227, v60
  v_add_f32 v227, v227, v61
  v_cvt_pk_bf16_f32 v142, v60, v61
  s_nop 0
  v_add_f32 v227, v227, v62
  v_add_f32 v227, v227, v63
  v_cvt_pk_bf16_f32 v143, v62, v63
  s_nop 7
  s_branch RARE0_ret
RARE2:
  s_nop 15
  s_nop 15
  v_max3_f32 v229, v96, v97, v98
  v_max3_f32 v229, v229, v99, v100
  v_max3_f32 v229, v229, v101, v102
  v_max3_f32 v229, v229, v103, v104
  v_max3_f32 v229, v229, v105, v106
  v_max3_f32 v229, v229, v107, v108
  v_max3_f32 v229, v229, v109, v110
  v_max_f32 v229, v229, v111
  v_mov_b32 v230, v229
  s_nop 1
  v_permlane32_swap_b32 v229, v230
  s_nop 1
  v_max_f32 v229, v229, v230
  v_max_f32 v229, 0, v229
  v_sub_f32 v231, 0, v229
  v_exp_f32 v231, v231
  s_nop 1
  v_sub_f32 v96, v96, v229
  v_sub_f32 v160, v160, v229
  v_sub_f32 v97, v97, v229
  v_sub_f32 v161, v161, v229
  v_sub_f32 v98, v98, v229
  v_sub_f32 v162, v162, v229
  v_sub_f32 v99, v99, v229
  v_sub_f32 v163, v163, v229
  v_sub_f32 v100, v100, v229
  v_sub_f32 v164, v164, v229
  v_sub_f32 v101, v101, v229
  v_sub_f32 v165, v165, v229
  v_sub_f32 v102, v102, v229
  v_sub_f32 v166, v166, v229
  v_sub_f32 v103, v103, v229
  v_sub_f32 v167, v167, v229
  v_sub_f32 v104, v104, v229
  v_sub_f32 v168, v168, v229
  v_sub_f32 v105, v105, v229
  v_sub_f32 v169, v169, v229
  v_sub_f32 v106, v106, v229
  v_sub_f32 v170, v170, v229
  v_sub_f32 v107, v107, v229
  v_sub_f32 v171, v171, v229
  v_sub_f32 v108, v108, v229
  v_sub_f32 v172, v172, v229
  v_sub_f32 v109, v109, v229
  v_sub_f32 v173, v173, v229
  v_sub_f32 v110, v110, v229
  v_sub_f32 v174, v174, v229
  v_sub_f32 v111, v111, v229
  v_sub_f32 v175, v175, v229
  v_mul_f32 v224, v224, v231
  v_accvgpr_read_b32 v230, a0
  v_mul_f32 v230, v230, v231
  v_accvgpr_write_b32 a0, v230
  v_accvgpr_read_b32 v230, a1
  v_mul_f32 v230, v230, v231
  v_accvgpr_write_b32 a1, v230
  v_accvgpr_read_b32 v230, a2
  v_mul_f32 v230, v230, v231
  v_accvgpr_write_b32 a2, v230
  v_accvgpr_read_b32 v230, a3
  v_mul_f32 v230, v230, v231
  v_accvgpr_write_b32 a3, v230
  v_accvgpr_read_b32 v230, a4
  v_mul_f32 v230, v230, v231
  v_accvgpr_write_b32 a4, v230
  v_accvgpr_read_b32 v230, a5
  v_mul_f32 v230, v230, v231
  v_accvgpr_write_b32 a5, v230
  v_accvgpr_read_b32 v230, a6
  v_mul_f32 v230, v230, v231
  v_accvgpr_write_b32 a6, v230
  v_accvgpr_read_b32 v230, a7
  v_mul_f32 v230, v230, v231
  v_accvgpr_write_b32 a7, v230
  v_accvgpr_read_b32 v230, a8
  v_mul_f32 v230, v230, v231
  v_accvgpr_write_b32 a8, v230
  v_accvgpr_read_b32 v230, a9
  v_mul_f32 v230, v230, v231
  v_accvgpr_write_b32 a9, v230
  v_accvgpr_read_b32 v230, a10
  v_mul_f32 v230, v230, v231
  v_accvgpr_write_b32 a10, v230
  v_accvgpr_read_b32 v230, a11
  v_mul_f32 v230, v230, v231
  v_accvgpr_write_b32 a11, v230
  v_accvgpr_read_b32 v230, a12
  v_mul_f32 v230, v230, v231
  v_accvgpr_write_b32 a12, v230
  v_accvgpr_read_b32 v230, a13
  v_mul_f32 v230, v230, v231
  v_accvgpr_write_b32 a13, v230
  v_accvgpr_read_b32 v230, a14
  v_mul_f32 v230, v230, v231
  v_accvgpr_write_b32 a14, v230
  v_accvgpr_read_b32 v230, a15
  v_mul_f32 v230, v230, v231
  v_accvgpr_write_b32 a15, v230
  v_accvgpr_read_b32 v230, a32
  v_mul_f32 v230, v230, v231
  v_accvgpr_write_b32 a32, v230
  v_accvgpr_read_b32 v230, a33
  v_mul_f32 v230, v230, v231
  v_accvgpr_write_b32 a33, v230
  v_accvgpr_read_b32 v230, a34
  v_mul_f32 v230, v230, v231
  v_accvgpr_write_b32 a34, v230
  v_accvgpr_read_b32 v230, a35
  v_mul_f32 v230, v230, v231
  v_accvgpr_write_b32 a35, v230
  v_accvgpr_read_b32 v230, a36
  v_mul_f32 v230, v230, v231
  v_accvgpr_write_b32 a36, v230
  v_accvgpr_read_b32 v230, a37
  v_mul_f32 v230, v230, v231
  v_accvgpr_write_b32 a37, v230
  v_accvgpr_read_b32 v230, a38
  v_mul_f32 v230, v230, v231
  v_accvgpr_write_b32 a38, v230
  v_accvgpr_read_b32 v230, a39
  v_mul_f32 v230, v230, v231
  v_accvgpr_write_b32 a39, v230
  v_accvgpr_read_b32 v230, a40
  v_mul_f32 v230, v230, v231
  v_accvgpr_write_b32 a40, v230
  v_accvgpr_read_b32 v230, a41
  v_mul_f32 v230, v230, v231
  v_accvgpr_write_b32 a41, v230
  v_accvgpr_read_b32 v230, a42
  v_mul_f32 v230, v230, v231
  v_accvgpr_write_b32 a42, v230
  v_accvgpr_read_b32 v230, a43
  v_mul_f32 v230, v230, v231
  v_accvgpr_write_b32 a43, v230
  v_accvgpr_read_b32 v230, a44
  v_mul_f32 v230, v230, v231
  v_accvgpr_write_b32 a44, v230
  v_accvgpr_read_b32 v230, a45
  v_mul_f32 v230, v230, v231
  v_accvgpr_write_b32 a45, v230
  v_accvgpr_read_b32 v230, a46
  v_mul_f32 v230, v230, v231
  v_accvgpr_write_b32 a46, v230
  v_accvgpr_read_b32 v230, a47
  v_mul_f32 v230, v230, v231
  v_accvgpr_write_b32 a47, v230
  v_accvgpr_read_b32 v230, a64
  v_mul_f32 v230, v230, v231
  v_accvgpr_write_b32 a64, v230
  v_accvgpr_read_b32 v230, a65
  v_mul_f32 v230, v230, v231
  v_accvgpr_write_b32 a65, v230
  v_accvgpr_read_b32 v230, a66
  v_mul_f32 v230, v230, v231
  v_accvgpr_write_b32 a66, v230
  v_accvgpr_read_b32 v230, a67
  v_mul_f32 v230, v230, v231
  v_accvgpr_write_b32 a67, v230
  v_accvgpr_read_b32 v230, a68
  v_mul_f32 v230, v230, v231
  v_accvgpr_write_b32 a68, v230
  v_accvgpr_read_b32 v230, a69
  v_mul_f32 v230, v230, v231
  v_accvgpr_write_b32 a69, v230
  v_accvgpr_read_b32 v230, a70
  v_mul_f32 v230, v230, v231
  v_accvgpr_write_b32 a70, v230
  v_accvgpr_read_b32 v230, a71
  v_mul_f32 v230, v230, v231
  v_accvgpr_write_b32 a71, v230
  v_accvgpr_read_b32 v230, a72
  v_mul_f32 v230, v230, v231
  v_accvgpr_write_b32 a72, v230
  v_accvgpr_read_b32 v230, a73
  v_mul_f32 v230, v230, v231
  v_accvgpr_write_b32 a73, v230
  v_accvgpr_read_b32 v230, a74
  v_mul_f32 v230, v230, v231
  v_accvgpr_write_b32 a74, v230
  v_accvgpr_read_b32 v230, a75
  v_mul_f32 v230, v230, v231
  v_accvgpr_write_b32 a75, v230
  v_accvgpr_read_b32 v230, a76
  v_mul_f32 v230, v230, v231
  v_accvgpr_write_b32 a76, v230
  v_accvgpr_read_b32 v230, a77
  v_mul_f32 v230, v230, v231
  v_accvgpr_write_b32 a77, v230
  v_accvgpr_read_b32 v230, a78
  v_mul_f32 v230, v230, v231
  v_accvgpr_write_b32 a78, v230
  v_accvgpr_read_b32 v230, a79
  v_mul_f32 v230, v230, v231
  v_accvgpr_write_b32 a79, v230
  v_accvgpr_read_b32 v230, a96
  v_mul_f32 v230, v230, v231
  v_accvgpr_write_b32 a96, v230
  v_accvgpr_read_b32 v230, a97
  v_mul_f32 v230, v230, v231
  v_accvgpr_write_b32 a97, v230
  v_accvgpr_read_b32 v230, a98
  v_mul_f32 v230, v230, v231
  v_accvgpr_write_b32 a98, v230
  v_accvgpr_read_b32 v230, a99
  v_mul_f32 v230, v230, v231
  v_accvgpr_write_b32 a99, v230
  v_accvgpr_read_b32 v230, a100
  v_mul_f32 v230, v230, v231
  v_accvgpr_write_b32 a100, v230
  v_accvgpr_read_b32 v230, a101
  v_mul_f32 v230, v230, v231
  v_accvgpr_write_b32 a101, v230
  v_accvgpr_read_b32 v230, a102
  v_mul_f32 v230, v230, v231
  v_accvgpr_write_b32 a102, v230
  v_accvgpr_read_b32 v230, a103
  v_mul_f32 v230, v230, v231
  v_accvgpr_write_b32 a103, v230
  v_accvgpr_read_b32 v230, a104
  v_mul_f32 v230, v230, v231
  v_accvgpr_write_b32 a104, v230
  v_accvgpr_read_b32 v230, a105
  v_mul_f32 v230, v230, v231
  v_accvgpr_write_b32 a105, v230
  v_accvgpr_read_b32 v230, a106
  v_mul_f32 v230, v230, v231
  v_accvgpr_write_b32 a106, v230
  v_accvgpr_read_b32 v230, a107
  v_mul_f32 v230, v230, v231
  v_accvgpr_write_b32 a107, v230
  v_accvgpr_read_b32 v230, a108
  v_mul_f32 v230, v230, v231
  v_accvgpr_write_b32 a108, v230
  v_accvgpr_read_b32 v230, a109
  v_mul_f32 v230, v230, v231
  v_accvgpr_write_b32 a109, v230
  v_accvgpr_read_b32 v230, a110
  v_mul_f32 v230, v230, v231
  v_accvgpr_write_b32 a110, v230
  v_accvgpr_read_b32 v230, a111
  v_mul_f32 v230, v230, v231
  v_accvgpr_write_b32 a111, v230
  v_accvgpr_read_b32 v230, a128
  v_mul_f32 v230, v230, v231
  v_accvgpr_write_b32 a128, v230
  v_accvgpr_read_b32 v230, a129
  v_mul_f32 v230, v230, v231
  v_accvgpr_write_b32 a129, v230
  v_accvgpr_read_b32 v230, a130
  v_mul_f32 v230, v230, v231
  v_accvgpr_write_b32 a130, v230
  v_accvgpr_read_b32 v230, a131
  v_mul_f32 v230, v230, v231
  v_accvgpr_write_b32 a131, v230
  v_accvgpr_read_b32 v230, a132
  v_mul_f32 v230, v230, v231
  v_accvgpr_write_b32 a132, v230
  v_accvgpr_read_b32 v230, a133
  v_mul_f32 v230, v230, v231
  v_accvgpr_write_b32 a133, v230
  v_accvgpr_read_b32 v230, a134
  v_mul_f32 v230, v230, v231
  v_accvgpr_write_b32 a134, v230
  v_accvgpr_read_b32 v230, a135
  v_mul_f32 v230, v230, v231
  v_accvgpr_write_b32 a135, v230
  v_accvgpr_read_b32 v230, a136
  v_mul_f32 v230, v230, v231
  v_accvgpr_write_b32 a136, v230
  v_accvgpr_read_b32 v230, a137
  v_mul_f32 v230, v230, v231
  v_accvgpr_write_b32 a137, v230
  v_accvgpr_read_b32 v230, a138
  v_mul_f32 v230, v230, v231
  v_accvgpr_write_b32 a138, v230
  v_accvgpr_read_b32 v230, a139
  v_mul_f32 v230, v230, v231
  v_accvgpr_write_b32 a139, v230
  v_accvgpr_read_b32 v230, a140
  v_mul_f32 v230, v230, v231
  v_accvgpr_write_b32 a140, v230
  v_accvgpr_read_b32 v230, a141
  v_mul_f32 v230, v230, v231
  v_accvgpr_write_b32 a141, v230
  v_accvgpr_read_b32 v230, a142
  v_mul_f32 v230, v230, v231
  v_accvgpr_write_b32 a142, v230
  v_accvgpr_read_b32 v230, a143
  v_mul_f32 v230, v230, v231
  v_accvgpr_write_b32 a143, v230
  v_accvgpr_read_b32 v230, a160
  v_mul_f32 v230, v230, v231
  v_accvgpr_write_b32 a160, v230
  v_accvgpr_read_b32 v230, a161
  v_mul_f32 v230, v230, v231
  v_accvgpr_write_b32 a161, v230
  v_accvgpr_read_b32 v230, a162
  v_mul_f32 v230, v230, v231
  v_accvgpr_write_b32 a162, v230
  v_accvgpr_read_b32 v230, a163
  v_mul_f32 v230, v230, v231
  v_accvgpr_write_b32 a163, v230
  v_accvgpr_read_b32 v230, a164
  v_mul_f32 v230, v230, v231
  v_accvgpr_write_b32 a164, v230
  v_accvgpr_read_b32 v230, a165
  v_mul_f32 v230, v230, v231
  v_accvgpr_write_b32 a165, v230
  v_accvgpr_read_b32 v230, a166
  v_mul_f32 v230, v230, v231
  v_accvgpr_write_b32 a166, v230
  v_accvgpr_read_b32 v230, a167
  v_mul_f32 v230, v230, v231
  v_accvgpr_write_b32 a167, v230
  v_accvgpr_read_b32 v230, a168
  v_mul_f32 v230, v230, v231
  v_accvgpr_write_b32 a168, v230
  v_accvgpr_read_b32 v230, a169
  v_mul_f32 v230, v230, v231
  v_accvgpr_write_b32 a169, v230
  v_accvgpr_read_b32 v230, a170
  v_mul_f32 v230, v230, v231
  v_accvgpr_write_b32 a170, v230
  v_accvgpr_read_b32 v230, a171
  v_mul_f32 v230, v230, v231
  v_accvgpr_write_b32 a171, v230
  v_accvgpr_read_b32 v230, a172
  v_mul_f32 v230, v230, v231
  v_accvgpr_write_b32 a172, v230
  v_accvgpr_read_b32 v230, a173
  v_mul_f32 v230, v230, v231
  v_accvgpr_write_b32 a173, v230
  v_accvgpr_read_b32 v230, a174
  v_mul_f32 v230, v230, v231
  v_accvgpr_write_b32 a174, v230
  v_accvgpr_read_b32 v230, a175
  v_mul_f32 v230, v230, v231
  v_accvgpr_write_b32 a175, v230
  v_max3_f32 v229, v112, v113, v114
  v_max3_f32 v229, v229, v115, v116
  v_max3_f32 v229, v229, v117, v118
  v_max3_f32 v229, v229, v119, v120
  v_max3_f32 v229, v229, v121, v122
  v_max3_f32 v229, v229, v123, v124
  v_max3_f32 v229, v229, v125, v126
  v_max_f32 v229, v229, v127
  v_mov_b32 v230, v229
  s_nop 1
  v_permlane32_swap_b32 v229, v230
  s_nop 1
  v_max_f32 v229, v229, v230
  v_max_f32 v229, 0, v229
  v_sub_f32 v231, 0, v229
  v_exp_f32 v231, v231
  s_nop 1
  v_sub_f32 v112, v112, v229
  v_sub_f32 v176, v176, v229
  v_sub_f32 v113, v113, v229
  v_sub_f32 v177, v177, v229
  v_sub_f32 v114, v114, v229
  v_sub_f32 v178, v178, v229
  v_sub_f32 v115, v115, v229
  v_sub_f32 v179, v179, v229
  v_sub_f32 v116, v116, v229
  v_sub_f32 v180, v180, v229
  v_sub_f32 v117, v117, v229
  v_sub_f32 v181, v181, v229
  v_sub_f32 v118, v118, v229
  v_sub_f32 v182, v182, v229
  v_sub_f32 v119, v119, v229
  v_sub_f32 v183, v183, v229
  v_sub_f32 v120, v120, v229
  v_sub_f32 v184, v184, v229
  v_sub_f32 v121, v121, v229
  v_sub_f32 v185, v185, v229
  v_sub_f32 v122, v122, v229
  v_sub_f32 v186, v186, v229
  v_sub_f32 v123, v123, v229
  v_sub_f32 v187, v187, v229
  v_sub_f32 v124, v124, v229
  v_sub_f32 v188, v188, v229
  v_sub_f32 v125, v125, v229
  v_sub_f32 v189, v189, v229
  v_sub_f32 v126, v126, v229
  v_sub_f32 v190, v190, v229
  v_sub_f32 v127, v127, v229
  v_sub_f32 v191, v191, v229
  v_mul_f32 v225, v225, v231
  v_accvgpr_read_b32 v230, a16
  v_mul_f32 v230, v230, v231
  v_accvgpr_write_b32 a16, v230
  v_accvgpr_read_b32 v230, a17
  v_mul_f32 v230, v230, v231
  v_accvgpr_write_b32 a17, v230
  v_accvgpr_read_b32 v230, a18
  v_mul_f32 v230, v230, v231
  v_accvgpr_write_b32 a18, v230
  v_accvgpr_read_b32 v230, a19
  v_mul_f32 v230, v230, v231
  v_accvgpr_write_b32 a19, v230
  v_accvgpr_read_b32 v230, a20
  v_mul_f32 v230, v230, v231
  v_accvgpr_write_b32 a20, v230
  v_accvgpr_read_b32 v230, a21
  v_mul_f32 v230, v230, v231
  v_accvgpr_write_b32 a21, v230
  v_accvgpr_read_b32 v230, a22
  v_mul_f32 v230, v230, v231
  v_accvgpr_write_b32 a22, v230
  v_accvgpr_read_b32 v230, a23
  v_mul_f32 v230, v230, v231
  v_accvgpr_write_b32 a23, v230
  v_accvgpr_read_b32 v230, a24
  v_mul_f32 v230, v230, v231
  v_accvgpr_write_b32 a24, v230
  v_accvgpr_read_b32 v230, a25
  v_mul_f32 v230, v230, v231
  v_accvgpr_write_b32 a25, v230
  v_accvgpr_read_b32 v230, a26
  v_mul_f32 v230, v230, v231
  v_accvgpr_write_b32 a26, v230
  v_accvgpr_read_b32 v230, a27
  v_mul_f32 v230, v230, v231
  v_accvgpr_write_b32 a27, v230
  v_accvgpr_read_b32 v230, a28
  v_mul_f32 v230, v230, v231
  v_accvgpr_write_b32 a28, v230
  v_accvgpr_read_b32 v230, a29
  v_mul_f32 v230, v230, v231
  v_accvgpr_write_b32 a29, v230
  v_accvgpr_read_b32 v230, a30
  v_mul_f32 v230, v230, v231
  v_accvgpr_write_b32 a30, v230
  v_accvgpr_read_b32 v230, a31
  v_mul_f32 v230, v230, v231
  v_accvgpr_write_b32 a31, v230
  v_accvgpr_read_b32 v230, a48
  v_mul_f32 v230, v230, v231
  v_accvgpr_write_b32 a48, v230
  v_accvgpr_read_b32 v230, a49
  v_mul_f32 v230, v230, v231
  v_accvgpr_write_b32 a49, v230
  v_accvgpr_read_b32 v230, a50
  v_mul_f32 v230, v230, v231
  v_accvgpr_write_b32 a50, v230
  v_accvgpr_read_b32 v230, a51
  v_mul_f32 v230, v230, v231
  v_accvgpr_write_b32 a51, v230
  v_accvgpr_read_b32 v230, a52
  v_mul_f32 v230, v230, v231
  v_accvgpr_write_b32 a52, v230
  v_accvgpr_read_b32 v230, a53
  v_mul_f32 v230, v230, v231
  v_accvgpr_write_b32 a53, v230
  v_accvgpr_read_b32 v230, a54
  v_mul_f32 v230, v230, v231
  v_accvgpr_write_b32 a54, v230
  v_accvgpr_read_b32 v230, a55
  v_mul_f32 v230, v230, v231
  v_accvgpr_write_b32 a55, v230
  v_accvgpr_read_b32 v230, a56
  v_mul_f32 v230, v230, v231
  v_accvgpr_write_b32 a56, v230
  v_accvgpr_read_b32 v230, a57
  v_mul_f32 v230, v230, v231
  v_accvgpr_write_b32 a57, v230
  v_accvgpr_read_b32 v230, a58
  v_mul_f32 v230, v230, v231
  v_accvgpr_write_b32 a58, v230
  v_accvgpr_read_b32 v230, a59
  v_mul_f32 v230, v230, v231
  v_accvgpr_write_b32 a59, v230
  v_accvgpr_read_b32 v230, a60
  v_mul_f32 v230, v230, v231
  v_accvgpr_write_b32 a60, v230
  v_accvgpr_read_b32 v230, a61
  v_mul_f32 v230, v230, v231
  v_accvgpr_write_b32 a61, v230
  v_accvgpr_read_b32 v230, a62
  v_mul_f32 v230, v230, v231
  v_accvgpr_write_b32 a62, v230
  v_accvgpr_read_b32 v230, a63
  v_mul_f32 v230, v230, v231
  v_accvgpr_write_b32 a63, v230
  v_accvgpr_read_b32 v230, a80
  v_mul_f32 v230, v230, v231
  v_accvgpr_write_b32 a80, v230
  v_accvgpr_read_b32 v230, a81
  v_mul_f32 v230, v230, v231
  v_accvgpr_write_b32 a81, v230
  v_accvgpr_read_b32 v230, a82
  v_mul_f32 v230, v230, v231
  v_accvgpr_write_b32 a82, v230
  v_accvgpr_read_b32 v230, a83
  v_mul_f32 v230, v230, v231
  v_accvgpr_write_b32 a83, v230
  v_accvgpr_read_b32 v230, a84
  v_mul_f32 v230, v230, v231
  v_accvgpr_write_b32 a84, v230
  v_accvgpr_read_b32 v230, a85
  v_mul_f32 v230, v230, v231
  v_accvgpr_write_b32 a85, v230
  v_accvgpr_read_b32 v230, a86
  v_mul_f32 v230, v230, v231
  v_accvgpr_write_b32 a86, v230
  v_accvgpr_read_b32 v230, a87
  v_mul_f32 v230, v230, v231
  v_accvgpr_write_b32 a87, v230
  v_accvgpr_read_b32 v230, a88
  v_mul_f32 v230, v230, v231
  v_accvgpr_write_b32 a88, v230
  v_accvgpr_read_b32 v230, a89
  v_mul_f32 v230, v230, v231
  v_accvgpr_write_b32 a89, v230
  v_accvgpr_read_b32 v230, a90
  v_mul_f32 v230, v230, v231
  v_accvgpr_write_b32 a90, v230
  v_accvgpr_read_b32 v230, a91
  v_mul_f32 v230, v230, v231
  v_accvgpr_write_b32 a91, v230
  v_accvgpr_read_b32 v230, a92
  v_mul_f32 v230, v230, v231
  v_accvgpr_write_b32 a92, v230
  v_accvgpr_read_b32 v230, a93
  v_mul_f32 v230, v230, v231
  v_accvgpr_write_b32 a93, v230
  v_accvgpr_read_b32 v230, a94
  v_mul_f32 v230, v230, v231
  v_accvgpr_write_b32 a94, v230
  v_accvgpr_read_b32 v230, a95
  v_mul_f32 v230, v230, v231
  v_accvgpr_write_b32 a95, v230
  v_accvgpr_read_b32 v230, a112
  v_mul_f32 v230, v230, v231
  v_accvgpr_write_b32 a112, v230
  v_accvgpr_read_b32 v230, a113
  v_mul_f32 v230, v230, v231
  v_accvgpr_write_b32 a113, v230
  v_accvgpr_read_b32 v230, a114
  v_mul_f32 v230, v230, v231
  v_accvgpr_write_b32 a114, v230
  v_accvgpr_read_b32 v230, a115
  v_mul_f32 v230, v230, v231
  v_accvgpr_write_b32 a115, v230
  v_accvgpr_read_b32 v230, a116
  v_mul_f32 v230, v230, v231
  v_accvgpr_write_b32 a116, v230
  v_accvgpr_read_b32 v230, a117
  v_mul_f32 v230, v230, v231
  v_accvgpr_write_b32 a117, v230
  v_accvgpr_read_b32 v230, a118
  v_mul_f32 v230, v230, v231
  v_accvgpr_write_b32 a118, v230
  v_accvgpr_read_b32 v230, a119
  v_mul_f32 v230, v230, v231
  v_accvgpr_write_b32 a119, v230
  v_accvgpr_read_b32 v230, a120
  v_mul_f32 v230, v230, v231
  v_accvgpr_write_b32 a120, v230
  v_accvgpr_read_b32 v230, a121
  v_mul_f32 v230, v230, v231
  v_accvgpr_write_b32 a121, v230
  v_accvgpr_read_b32 v230, a122
  v_mul_f32 v230, v230, v231
  v_accvgpr_write_b32 a122, v230
  v_accvgpr_read_b32 v230, a123
  v_mul_f32 v230, v230, v231
  v_accvgpr_write_b32 a123, v230
  v_accvgpr_read_b32 v230, a124
  v_mul_f32 v230, v230, v231
  v_accvgpr_write_b32 a124, v230
  v_accvgpr_read_b32 v230, a125
  v_mul_f32 v230, v230, v231
  v_accvgpr_write_b32 a125, v230
  v_accvgpr_read_b32 v230, a126
  v_mul_f32 v230, v230, v231
  v_accvgpr_write_b32 a126, v230
  v_accvgpr_read_b32 v230, a127
  v_mul_f32 v230, v230, v231
  v_accvgpr_write_b32 a127, v230
  v_accvgpr_read_b32 v230, a144
  v_mul_f32 v230, v230, v231
  v_accvgpr_write_b32 a144, v230
  v_accvgpr_read_b32 v230, a145
  v_mul_f32 v230, v230, v231
  v_accvgpr_write_b32 a145, v230
  v_accvgpr_read_b32 v230, a146
  v_mul_f32 v230, v230, v231
  v_accvgpr_write_b32 a146, v230
  v_accvgpr_read_b32 v230, a147
  v_mul_f32 v230, v230, v231
  v_accvgpr_write_b32 a147, v230
  v_accvgpr_read_b32 v230, a148
  v_mul_f32 v230, v230, v231
  v_accvgpr_write_b32 a148, v230
  v_accvgpr_read_b32 v230, a149
  v_mul_f32 v230, v230, v231
  v_accvgpr_write_b32 a149, v230
  v_accvgpr_read_b32 v230, a150
  v_mul_f32 v230, v230, v231
  v_accvgpr_write_b32 a150, v230
  v_accvgpr_read_b32 v230, a151
  v_mul_f32 v230, v230, v231
  v_accvgpr_write_b32 a151, v230
  v_accvgpr_read_b32 v230, a152
  v_mul_f32 v230, v230, v231
  v_accvgpr_write_b32 a152, v230
  v_accvgpr_read_b32 v230, a153
  v_mul_f32 v230, v230, v231
  v_accvgpr_write_b32 a153, v230
  v_accvgpr_read_b32 v230, a154
  v_mul_f32 v230, v230, v231
  v_accvgpr_write_b32 a154, v230
  v_accvgpr_read_b32 v230, a155
  v_mul_f32 v230, v230, v231
  v_accvgpr_write_b32 a155, v230
  v_accvgpr_read_b32 v230, a156
  v_mul_f32 v230, v230, v231
  v_accvgpr_write_b32 a156, v230
  v_accvgpr_read_b32 v230, a157
  v_mul_f32 v230, v230, v231
  v_accvgpr_write_b32 a157, v230
  v_accvgpr_read_b32 v230, a158
  v_mul_f32 v230, v230, v231
  v_accvgpr_write_b32 a158, v230
  v_accvgpr_read_b32 v230, a159
  v_mul_f32 v230, v230, v231
  v_accvgpr_write_b32 a159, v230
  v_accvgpr_read_b32 v230, a176
  v_mul_f32 v230, v230, v231
  v_accvgpr_write_b32 a176, v230
  v_accvgpr_read_b32 v230, a177
  v_mul_f32 v230, v230, v231
  v_accvgpr_write_b32 a177, v230
  v_accvgpr_read_b32 v230, a178
  v_mul_f32 v230, v230, v231
  v_accvgpr_write_b32 a178, v230
  v_accvgpr_read_b32 v230, a179
  v_mul_f32 v230, v230, v231
  v_accvgpr_write_b32 a179, v230
  v_accvgpr_read_b32 v230, a180
  v_mul_f32 v230, v230, v231
  v_accvgpr_write_b32 a180, v230
  v_accvgpr_read_b32 v230, a181
  v_mul_f32 v230, v230, v231
  v_accvgpr_write_b32 a181, v230
  v_accvgpr_read_b32 v230, a182
  v_mul_f32 v230, v230, v231
  v_accvgpr_write_b32 a182, v230
  v_accvgpr_read_b32 v230, a183
  v_mul_f32 v230, v230, v231
  v_accvgpr_write_b32 a183, v230
  v_accvgpr_read_b32 v230, a184
  v_mul_f32 v230, v230, v231
  v_accvgpr_write_b32 a184, v230
  v_accvgpr_read_b32 v230, a185
  v_mul_f32 v230, v230, v231
  v_accvgpr_write_b32 a185, v230
  v_accvgpr_read_b32 v230, a186
  v_mul_f32 v230, v230, v231
  v_accvgpr_write_b32 a186, v230
  v_accvgpr_read_b32 v230, a187
  v_mul_f32 v230, v230, v231
  v_accvgpr_write_b32 a187, v230
  v_accvgpr_read_b32 v230, a188
  v_mul_f32 v230, v230, v231
  v_accvgpr_write_b32 a188, v230
  v_accvgpr_read_b32 v230, a189
  v_mul_f32 v230, v230, v231
  v_accvgpr_write_b32 a189, v230
  v_accvgpr_read_b32 v230, a190
  v_mul_f32 v230, v230, v231
  v_accvgpr_write_b32 a190, v230
  v_accvgpr_read_b32 v230, a191
  v_mul_f32 v230, v230, v231
  v_accvgpr_write_b32 a191, v230
  v_exp_f32 v56, v96
  v_exp_f32 v57, v97
  v_exp_f32 v58, v98
  v_exp_f32 v59, v99
  v_add_f32 v226, v56, v57
  v_cvt_pk_bf16_f32 v144, v56, v57
  v_exp_f32 v60, v100
  v_exp_f32 v61, v101
  v_add_f32 v226, v226, v58
  v_add_f32 v226, v226, v59
  v_cvt_pk_bf16_f32 v145, v58, v59
  v_exp_f32 v62, v102
  v_exp_f32 v63, v103
  v_add_f32 v226, v226, v60
  v_add_f32 v226, v226, v61
  v_cvt_pk_bf16_f32 v146, v60, v61
  v_exp_f32 v56, v104
  v_exp_f32 v57, v105
  v_add_f32 v226, v226, v62
  v_add_f32 v226, v226, v63
  v_cvt_pk_bf16_f32 v147, v62, v63
  v_exp_f32 v58, v106
  v_exp_f32 v59, v107
  v_add_f32 v226, v226, v56
  v_add_f32 v226, v226, v57
  v_cvt_pk_bf16_f32 v148, v56, v57
  v_exp_f32 v60, v108
  v_exp_f32 v61, v109
  v_add_f32 v226, v226, v58
  v_add_f32 v226, v226, v59
  v_cvt_pk_bf16_f32 v149, v58, v59
  v_exp_f32 v62, v110
  v_exp_f32 v63, v111
  v_add_f32 v226, v226, v60
  v_add_f32 v226, v226, v61
  v_cvt_pk_bf16_f32 v150, v60, v61
  v_exp_f32 v56, v112
  v_exp_f32 v57, v113
  v_add_f32 v226, v226, v62
  v_add_f32 v226, v226, v63
  v_cvt_pk_bf16_f32 v151, v62, v63
  v_exp_f32 v58, v114
  v_exp_f32 v59, v115
  v_add_f32 v227, v56, v57
  v_cvt_pk_bf16_f32 v152, v56, v57
  v_exp_f32 v60, v116
  v_exp_f32 v61, v117
  v_add_f32 v227, v227, v58
  v_add_f32 v227, v227, v59
  v_cvt_pk_bf16_f32 v153, v58, v59
  v_exp_f32 v62, v118
  v_exp_f32 v63, v119
  v_add_f32 v227, v227, v60
  v_add_f32 v227, v227, v61
  v_cvt_pk_bf16_f32 v154, v60, v61
  v_exp_f32 v56, v120
  v_exp_f32 v57, v121
  v_add_f32 v227, v227, v62
  v_add_f32 v227, v227, v63
  v_cvt_pk_bf16_f32 v155, v62, v63
  v_exp_f32 v58, v122
  v_exp_f32 v59, v123
  v_add_f32 v227, v227, v56
  v_add_f32 v227, v227, v57
  v_cvt_pk_bf16_f32 v156, v56, v57
  v_exp_f32 v60, v124
  v_exp_f32 v61, v125
  v_add_f32 v227, v227, v58
  v_add_f32 v227, v227, v59
  v_cvt_pk_bf16_f32 v157, v58, v59
  v_exp_f32 v62, v126
  v_exp_f32 v63, v127
  v_add_f32 v227, v227, v60
  v_add_f32 v227, v227, v61
  v_cvt_pk_bf16_f32 v158, v60, v61
  s_nop 0
  v_add_f32 v227, v227, v62
  v_add_f32 v227, v227, v63
  v_cvt_pk_bf16_f32 v159, v62, v63
  s_nop 7
  s_branch RARE2_ret
.globl oproj_kernel
.p2align 8
.type oproj_kernel,@function
oproj_kernel:
  s_cmp_ge_u32 s2, 256
  s_cbranch_scc1 B_END
  s_load_dwordx2 s[4:5], s[0:1], 40
  s_load_dwordx2 s[6:7], s[0:1], 56
  v_lshrrev_b32 v1, 6, v0
  v_and_b32 v0, 63, v0
  s_nop 0
  v_readfirstlane_b32 s3, v1
  s_waitcnt lgkmcnt(0)
  s_mov_b32 s8, s4
  s_and_b32 s9, s5, 0xffff
  s_mov_b32 s10, 2621440
  s_mov_b32 s11, 0x20000
  s_mov_b32 s12, s6
  s_and_b32 s13, s7, 0xffff
  s_mov_b32 s14, 402653184
  s_mov_b32 s15, 0x20000
  s_and_b32 s16, s2, 7
  s_lshr_b32 s17, s2, 3
  s_and_b32 s18, s17, 3
  s_lshl_b32 s16, s16, 2
  s_add_u32 s16, s16, s18
  s_lshr_b32 s17, s17, 2
  s_mul_i32 s20, s16, 786432
  s_mul_i32 s22, s3, 49152
  s_add_u32 s20, s20, s22
  s_mul_i32 s21, s17, 983040
  s_add_u32 s21, s21, s22
  s_add_u32 s21, s21, 25165824
  v_lshlrev_b32 v1, 4, v0
  v_add_u32 v2, 196608, v1
  v_add_u32 v3, 393216, v1
  v_add_u32 v4, 589824, v1
  v_add_u32 v5, 786432, v1
  buffer_load_dwordx4 v[96:99], v1, s[12:15], s20 offen
  buffer_load_dwordx4 v[100:103], v2, s[12:15], s20 offen
  buffer_load_dwordx4 v[104:107], v3, s[12:15], s20 offen
  buffer_load_dwordx4 v[108:111], v4, s[12:15], s20 offen
  buffer_load_dwordx4 v[112:115], v1, s[12:15], s21 offen
  buffer_load_dwordx4 v[116:119], v2, s[12:15], s21 offen
  buffer_load_dwordx4 v[120:123], v3, s[12:15], s21 offen
  buffer_load_dwordx4 v[124:127], v4, s[12:15], s21 offen
  buffer_load_dwordx4 v[128:131], v5, s[12:15], s21 offen
  s_add_u32 s20, s20, 1024
  s_add_u32 s21, s21, 1024
  buffer_load_dwordx4 v[132:135], v1, s[12:15], s20 offen
  buffer_load_dwordx4 v[136:139], v2, s[12:15], s20 offen
  buffer_load_dwordx4 v[140:143], v3, s[12:15], s20 offen
  buffer_load_dwordx4 v[144:147], v4, s[12:15], s20 offen
  buffer_load_dwordx4 v[148:151], v1, s[12:15], s21 offen
  buffer_load_dwordx4 v[152:155], v2, s[12:15], s21 offen
  buffer_load_dwordx4 v[156:159], v3, s[12:15], s21 offen
  buffer_load_dwordx4 v[160:163], v4, s[12:15], s21 offen
  buffer_load_dwordx4 v[164:167], v5, s[12:15], s21 offen
  s_add_u32 s20, s20, 1024
  s_add_u32 s21, s21, 1024
  buffer_load_dwordx4 v[168:171], v1, s[12:15], s20 offen
  buffer_load_dwordx4 v[172:175], v2, s[12:15], s20 offen
  buffer_load_dwordx4 v[176:179], v3, s[12:15], s20 offen
  buffer_load_dwordx4 v[180:183], v4, s[12:15], s20 offen
  buffer_load_dwordx4 v[184:187], v1, s[12:15], s21 offen
  buffer_load_dwordx4 v[188:191], v2, s[12:15], s21 offen
  buffer_load_dwordx4 v[192:195], v3, s[12:15], s21 offen
  buffer_load_dwordx4 v[196:199], v4, s[12:15], s21 offen
  buffer_load_dwordx4 v[200:203], v5, s[12:15], s21 offen
  s_add_u32 s20, s20, 1024
  s_add_u32 s21, s21, 1024
  s_waitcnt vmcnt(18)
  v_mfma_f32_16x16x32_bf16 v[16:19], v[112:115], v[96:99], 0
  v_mfma_f32_16x16x32_bf16 v[36:39], v[112:115], v[100:103], 0
  buffer_load_dwordx4 v[204:207], v1, s[12:15], s20 offen
  v_mfma_f32_16x16x32_bf16 v[56:59], v[112:115], v[104:107], 0
  v_mfma_f32_16x16x32_bf16 v[76:79], v[112:115], v[108:111], 0
  buffer_load_dwordx4 v[208:211], v2, s[12:15], s20 offen
  v_mfma_f32_16x16x32_bf16 v[20:23], v[116:119], v[96:99], 0
  v_mfma_f32_16x16x32_bf16 v[40:43], v[116:119], v[100:103], 0
  buffer_load_dwordx4 v[212:215], v3, s[12:15], s20 offen
  v_mfma_f32_16x16x32_bf16 v[60:63], v[116:119], v[104:107], 0
  v_mfma_f32_16x16x32_bf16 v[80:83], v[116:119], v[108:111], 0
  buffer_load_dwordx4 v[216:219], v4, s[12:15], s20 offen
  v_mfma_f32_16x16x32_bf16 v[24:27], v[120:123], v[96:99], 0
  v_mfma_f32_16x16x32_bf16 v[44:47], v[120:123], v[100:103], 0
  buffer_load_dwordx4 v[220:223], v1, s[12:15], s21 offen
  v_mfma_f32_16x16x32_bf16 v[64:67], v[120:123], v[104:107], 0
  v_mfma_f32_16x16x32_bf16 v[84:87], v[120:123], v[108:111], 0
  buffer_load_dwordx4 v[224:227], v2, s[12:15], s21 offen
  v_mfma_f32_16x16x32_bf16 v[28:31], v[124:127], v[96:99], 0
  v_mfma_f32_16x16x32_bf16 v[48:51], v[124:127], v[100:103], 0
  buffer_load_dwordx4 v[228:231], v3, s[12:15], s21 offen
  v_mfma_f32_16x16x32_bf16 v[68:71], v[124:127], v[104:107], 0
  v_mfma_f32_16x16x32_bf16 v[88:91], v[124:127], v[108:111], 0
  buffer_load_dwordx4 v[232:235], v4, s[12:15], s21 offen
  v_mfma_f32_16x16x32_bf16 v[32:35], v[128:131], v[96:99], 0
  v_mfma_f32_16x16x32_bf16 v[52:55], v[128:131], v[100:103], 0
  buffer_load_dwordx4 v[236:239], v5, s[12:15], s21 offen
  v_mfma_f32_16x16x32_bf16 v[72:75], v[128:131], v[104:107], 0
  v_mfma_f32_16x16x32_bf16 v[92:95], v[128:131], v[108:111], 0
  s_add_u32 s20, s20, 1024
  s_add_u32 s21, s21, 1024
  s_waitcnt vmcnt(18)
  v_mfma_f32_16x16x32_bf16 v[16:19], v[148:151], v[132:135], v[16:19]
  v_mfma_f32_16x16x32_bf16 v[36:39], v[148:151], v[136:139], v[36:39]
  buffer_load_dwordx4 v[96:99], v1, s[12:15], s20 offen
  v_mfma_f32_16x16x32_bf16 v[56:59], v[148:151], v[140:143], v[56:59]
  v_mfma_f32_16x16x32_bf16 v[76:79], v[148:151], v[144:147], v[76:79]
  buffer_load_dwordx4 v[100:103], v2, s[12:15], s20 offen
  v_mfma_f32_16x16x32_bf16 v[20:23], v[152:155], v[132:135], v[20:23]
  v_mfma_f32_16x16x32_bf16 v[40:43], v[152:155], v[136:139], v[40:43]
  buffer_load_dwordx4 v[104:107], v3, s[12:15], s20 offen
  v_mfma_f32_16x16x32_bf16 v[60:63], v[152:155], v[140:143], v[60:63]
  v_mfma_f32_16x16x32_bf16 v[80:83], v[152:155], v[144:147], v[80:83]
  buffer_load_dwordx4 v[108:111], v4, s[12:15], s20 offen
  v_mfma_f32_16x16x32_bf16 v[24:27], v[156:159], v[132:135], v[24:27]
  v_mfma_f32_16x16x32_bf16 v[44:47], v[156:159], v[136:139], v[44:47]
  buffer_load_dwordx4 v[112:115], v1, s[12:15], s21 offen
  v_mfma_f32_16x16x32_bf16 v[64:67], v[156:159], v[140:143], v[64:67]
  v_mfma_f32_16x16x32_bf16 v[84:87], v[156:159], v[144:147], v[84:87]
  buffer_load_dwordx4 v[116:119], v2, s[12:15], s21 offen
  v_mfma_f32_16x16x32_bf16 v[28:31], v[160:163], v[132:135], v[28:31]
  v_mfma_f32_16x16x32_bf16 v[48:51], v[160:163], v[136:139], v[48:51]
  buffer_load_dwordx4 v[120:123], v3, s[12:15], s21 offen
  v_mfma_f32_16x16x32_bf16 v[68:71], v[160:163], v[140:143], v[68:71]
  v_mfma_f32_16x16x32_bf16 v[88:91], v[160:163], v[144:147], v[88:91]
  buffer_load_dwordx4 v[124:127], v4, s[12:15], s21 offen
  v_mfma_f32_16x16x32_bf16 v[32:35], v[164:167], v[132:135], v[32:35]
  v_mfma_f32_16x16x32_bf16 v[52:55], v[164:167], v[136:139], v[52:55]
  buffer_load_dwordx4 v[128:131], v5, s[12:15], s21 offen
  v_mfma_f32_16x16x32_bf16 v[72:75], v[164:167], v[140:143], v[72:75]
  v_mfma_f32_16x16x32_bf16 v[92:95], v[164:167], v[144:147], v[92:95]
  s_add_u32 s20, s20, 1024
  s_add_u32 s21, s21, 1024
  s_waitcnt vmcnt(18)
  v_mfma_f32_16x16x32_bf16 v[16:19], v[184:187], v[168:171], v[16:19]
  v_mfma_f32_16x16x32_bf16 v[36:39], v[184:187], v[172:175], v[36:39]
  buffer_load_dwordx4 v[132:135], v1, s[12:15], s20 offen
  v_mfma_f32_16x16x32_bf16 v[56:59], v[184:187], v[176:179], v[56:59]
  v_mfma_f32_16x16x32_bf16 v[76:79], v[184:187], v[180:183], v[76:79]
  buffer_load_dwordx4 v[136:139], v2, s[12:15], s20 offen
  v_mfma_f32_16x16x32_bf16 v[20:23], v[188:191], v[168:171], v[20:23]
  v_mfma_f32_16x16x32_bf16 v[40:43], v[188:191], v[172:175], v[40:43]
  buffer_load_dwordx4 v[140:143], v3, s[12:15], s20 offen
  v_mfma_f32_16x16x32_bf16 v[60:63], v[188:191], v[176:179], v[60:63]
  v_mfma_f32_16x16x32_bf16 v[80:83], v[188:191], v[180:183], v[80:83]
  buffer_load_dwordx4 v[144:147], v4, s[12:15], s20 offen
  v_mfma_f32_16x16x32_bf16 v[24:27], v[192:195], v[168:171], v[24:27]
  v_mfma_f32_16x16x32_bf16 v[44:47], v[192:195], v[172:175], v[44:47]
  buffer_load_dwordx4 v[148:151], v1, s[12:15], s21 offen
  v_mfma_f32_16x16x32_bf16 v[64:67], v[192:195], v[176:179], v[64:67]
  v_mfma_f32_16x16x32_bf16 v[84:87], v[192:195], v[180:183], v[84:87]
  buffer_load_dwordx4 v[152:155], v2, s[12:15], s21 offen
  v_mfma_f32_16x16x32_bf16 v[28:31], v[196:199], v[168:171], v[28:31]
  v_mfma_f32_16x16x32_bf16 v[48:51], v[196:199], v[172:175], v[48:51]
  buffer_load_dwordx4 v[156:159], v3, s[12:15], s21 offen
  v_mfma_f32_16x16x32_bf16 v[68:71], v[196:199], v[176:179], v[68:71]
  v_mfma_f32_16x16x32_bf16 v[88:91], v[196:199], v[180:183], v[88:91]
  buffer_load_dwordx4 v[160:163], v4, s[12:15], s21 offen
  v_mfma_f32_16x16x32_bf16 v[32:35], v[200:203], v[168:171], v[32:35]
  v_mfma_f32_16x16x32_bf16 v[52:55], v[200:203], v[172:175], v[52:55]
  buffer_load_dwordx4 v[164:167], v5, s[12:15], s21 offen
  v_mfma_f32_16x16x32_bf16 v[72:75], v[200:203], v[176:179], v[72:75]
  v_mfma_f32_16x16x32_bf16 v[92:95], v[200:203], v[180:183], v[92:95]
  s_add_u32 s20, s20, 1024
  s_add_u32 s21, s21, 1024
  s_waitcnt vmcnt(18)
  v_mfma_f32_16x16x32_bf16 v[16:19], v[220:223], v[204:207], v[16:19]
  v_mfma_f32_16x16x32_bf16 v[36:39], v[220:223], v[208:211], v[36:39]
  buffer_load_dwordx4 v[168:171], v1, s[12:15], s20 offen
  v_mfma_f32_16x16x32_bf16 v[56:59], v[220:223], v[212:215], v[56:59]
  v_mfma_f32_16x16x32_bf16 v[76:79], v[220:223], v[216:219], v[76:79]
  buffer_load_dwordx4 v[172:175], v2, s[12:15], s20 offen
  v_mfma_f32_16x16x32_bf16 v[20:23], v[224:227], v[204:207], v[20:23]
  v_mfma_f32_16x16x32_bf16 v[40:43], v[224:227], v[208:211], v[40:43]
  buffer_load_dwordx4 v[176:179], v3, s[12:15], s20 offen
  v_mfma_f32_16x16x32_bf16 v[60:63], v[224:227], v[212:215], v[60:63]
  v_mfma_f32_16x16x32_bf16 v[80:83], v[224:227], v[216:219], v[80:83]
  buffer_load_dwordx4 v[180:183], v4, s[12:15], s20 offen
  v_mfma_f32_16x16x32_bf16 v[24:27], v[228:231], v[204:207], v[24:27]
  v_mfma_f32_16x16x32_bf16 v[44:47], v[228:231], v[208:211], v[44:47]
  buffer_load_dwordx4 v[184:187], v1, s[12:15], s21 offen
  v_mfma_f32_16x16x32_bf16 v[64:67], v[228:231], v[212:215], v[64:67]
  v_mfma_f32_16x16x32_bf16 v[84:87], v[228:231], v[216:219], v[84:87]
  buffer_load_dwordx4 v[188:191], v2, s[12:15], s21 offen
  v_mfma_f32_16x16x32_bf16 v[28:31], v[232:235], v[204:207], v[28:31]
  v_mfma_f32_16x16x32_bf16 v[48:51], v[232:235], v[208:211], v[48:51]
  buffer_load_dwordx4 v[192:195], v3, s[12:15], s21 offen
  v_mfma_f32_16x16x32_bf16 v[68:71], v[232:235], v[212:215], v[68:71]
  v_mfma_f32_16x16x32_bf16 v[88:91], v[232:235], v[216:219], v[88:91]
  buffer_load_dwordx4 v[196:199], v4, s[12:15], s21 offen
  v_mfma_f32_16x16x32_bf16 v[32:35], v[236:239], v[204:207], v[32:35]
  v_mfma_f32_16x16x32_bf16 v[52:55], v[236:239], v[208:211], v[52:55]
  buffer_load_dwordx4 v[200:203], v5, s[12:15], s21 offen
  v_mfma_f32_16x16x32_bf16 v[72:75], v[236:239], v[212:215], v[72:75]
  v_mfma_f32_16x16x32_bf16 v[92:95], v[236:239], v[216:219], v[92:95]
  s_add_u32 s20, s20, 1024
  s_add_u32 s21, s21, 1024
  s_mov_b32 s23, 10
B_LOOP:
  s_waitcnt vmcnt(18)
  v_mfma_f32_16x16x32_bf16 v[16:19], v[112:115], v[96:99], v[16:19]
  v_mfma_f32_16x16x32_bf16 v[36:39], v[112:115], v[100:103], v[36:39]
  buffer_load_dwordx4 v[204:207], v1, s[12:15], s20 offen
  v_mfma_f32_16x16x32_bf16 v[56:59], v[112:115], v[104:107], v[56:59]
  v_mfma_f32_16x16x32_bf16 v[76:79], v[112:115], v[108:111], v[76:79]
  buffer_load_dwordx4 v[208:211], v2, s[12:15], s20 offen
  v_mfma_f32_16x16x32_bf16 v[20:23], v[116:119], v[96:99], v[20:23]
  v_mfma_f32_16x16x32_bf16 v[40:43], v[116:119], v[100:103], v[40:43]
  buffer_load_dwordx4 v[212:215], v3, s[12:15], s20 offen
  v_mfma_f32_16x16x32_bf16 v[60:63], v[116:119], v[104:107], v[60:63]
  v_mfma_f32_16x16x32_bf16 v[80:83], v[116:119], v[108:111], v[80:83]
  buffer_load_dwordx4 v[216:219], v4, s[12:15], s20 offen
  v_mfma_f32_16x16x32_bf16 v[24:27], v[120:123], v[96:99], v[24:27]
  v_mfma_f32_16x16x32_bf16 v[44:47], v[120:123], v[100:103], v[44:47]
  buffer_load_dwordx4 v[220:223], v1, s[12:15], s21 offen
  v_mfma_f32_16x16x32_bf16 v[64:67], v[120:123], v[104:107], v[64:67]
  v_mfma_f32_16x16x32_bf16 v[84:87], v[120:123], v[108:111], v[84:87]
  buffer_load_dwordx4 v[224:227], v2, s[12:15], s21 offen
  v_mfma_f32_16x16x32_bf16 v[28:31], v[124:127], v[96:99], v[28:31]
  v_mfma_f32_16x16x32_bf16 v[48:51], v[124:127], v[100:103], v[48:51]
  buffer_load_dwordx4 v[228:231], v3, s[12:15], s21 offen
  v_mfma_f32_16x16x32_bf16 v[68:71], v[124:127], v[104:107], v[68:71]
  v_mfma_f32_16x16x32_bf16 v[88:91], v[124:127], v[108:111], v[88:91]
  buffer_load_dwordx4 v[232:235], v4, s[12:15], s21 offen
  v_mfma_f32_16x16x32_bf16 v[32:35], v[128:131], v[96:99], v[32:35]
  v_mfma_f32_16x16x32_bf16 v[52:55], v[128:131], v[100:103], v[52:55]
  buffer_load_dwordx4 v[236:239], v5, s[12:15], s21 offen
  v_mfma_f32_16x16x32_bf16 v[72:75], v[128:131], v[104:107], v[72:75]
  v_mfma_f32_16x16x32_bf16 v[92:95], v[128:131], v[108:111], v[92:95]
  s_add_u32 s20, s20, 1024
  s_add_u32 s21, s21, 1024
  s_waitcnt vmcnt(18)
  v_mfma_f32_16x16x32_bf16 v[16:19], v[148:151], v[132:135], v[16:19]
  v_mfma_f32_16x16x32_bf16 v[36:39], v[148:151], v[136:139], v[36:39]
  buffer_load_dwordx4 v[96:99], v1, s[12:15], s20 offen
  v_mfma_f32_16x16x32_bf16 v[56:59], v[148:151], v[140:143], v[56:59]
  v_mfma_f32_16x16x32_bf16 v[76:79], v[148:151], v[144:147], v[76:79]
  buffer_load_dwordx4 v[100:103], v2, s[12:15], s20 offen
  v_mfma_f32_16x16x32_bf16 v[20:23], v[152:155], v[132:135], v[20:23]
  v_mfma_f32_16x16x32_bf16 v[40:43], v[152:155], v[136:139], v[40:43]
  buffer_load_dwordx4 v[104:107], v3, s[12:15], s20 offen
  v_mfma_f32_16x16x32_bf16 v[60:63], v[152:155], v[140:143], v[60:63]
  v_mfma_f32_16x16x32_bf16 v[80:83], v[152:155], v[144:147], v[80:83]
  buffer_load_dwordx4 v[108:111], v4, s[12:15], s20 offen
  v_mfma_f32_16x16x32_bf16 v[24:27], v[156:159], v[132:135], v[24:27]
  v_mfma_f32_16x16x32_bf16 v[44:47], v[156:159], v[136:139], v[44:47]
  buffer_load_dwordx4 v[112:115], v1, s[12:15], s21 offen
  v_mfma_f32_16x16x32_bf16 v[64:67], v[156:159], v[140:143], v[64:67]
  v_mfma_f32_16x16x32_bf16 v[84:87], v[156:159], v[144:147], v[84:87]
  buffer_load_dwordx4 v[116:119], v2, s[12:15], s21 offen
  v_mfma_f32_16x16x32_bf16 v[28:31], v[160:163], v[132:135], v[28:31]
  v_mfma_f32_16x16x32_bf16 v[48:51], v[160:163], v[136:139], v[48:51]
  buffer_load_dwordx4 v[120:123], v3, s[12:15], s21 offen
  v_mfma_f32_16x16x32_bf16 v[68:71], v[160:163], v[140:143], v[68:71]
  v_mfma_f32_16x16x32_bf16 v[88:91], v[160:163], v[144:147], v[88:91]
  buffer_load_dwordx4 v[124:127], v4, s[12:15], s21 offen
  v_mfma_f32_16x16x32_bf16 v[32:35], v[164:167], v[132:135], v[32:35]
  v_mfma_f32_16x16x32_bf16 v[52:55], v[164:167], v[136:139], v[52:55]
  buffer_load_dwordx4 v[128:131], v5, s[12:15], s21 offen
  v_mfma_f32_16x16x32_bf16 v[72:75], v[164:167], v[140:143], v[72:75]
  v_mfma_f32_16x16x32_bf16 v[92:95], v[164:167], v[144:147], v[92:95]
  s_add_u32 s20, s20, 1024
  s_add_u32 s21, s21, 1024
  s_waitcnt vmcnt(18)
  v_mfma_f32_16x16x32_bf16 v[16:19], v[184:187], v[168:171], v[16:19]
  v_mfma_f32_16x16x32_bf16 v[36:39], v[184:187], v[172:175], v[36:39]
  buffer_load_dwordx4 v[132:135], v1, s[12:15], s20 offen
  v_mfma_f32_16x16x32_bf16 v[56:59], v[184:187], v[176:179], v[56:59]
  v_mfma_f32_16x16x32_bf16 v[76:79], v[184:187], v[180:183], v[76:79]
  buffer_load_dwordx4 v[136:139], v2, s[12:15], s20 offen
  v_mfma_f32_16x16x32_bf16 v[20:23], v[188:191], v[168:171], v[20:23]
  v_mfma_f32_16x16x32_bf16 v[40:43], v[188:191], v[172:175], v[40:43]
  buffer_load_dwordx4 v[140:143], v3, s[12:15], s20 offen
  v_mfma_f32_16x16x32_bf16 v[60:63], v[188:191], v[176:179], v[60:63]
  v_mfma_f32_16x16x32_bf16 v[80:83], v[188:191], v[180:183], v[80:83]
  buffer_load_dwordx4 v[144:147], v4, s[12:15], s20 offen
  v_mfma_f32_16x16x32_bf16 v[24:27], v[192:195], v[168:171], v[24:27]
  v_mfma_f32_16x16x32_bf16 v[44:47], v[192:195], v[172:175], v[44:47]
  buffer_load_dwordx4 v[148:151], v1, s[12:15], s21 offen
  v_mfma_f32_16x16x32_bf16 v[64:67], v[192:195], v[176:179], v[64:67]
  v_mfma_f32_16x16x32_bf16 v[84:87], v[192:195], v[180:183], v[84:87]
  buffer_load_dwordx4 v[152:155], v2, s[12:15], s21 offen
  v_mfma_f32_16x16x32_bf16 v[28:31], v[196:199], v[168:171], v[28:31]
  v_mfma_f32_16x16x32_bf16 v[48:51], v[196:199], v[172:175], v[48:51]
  buffer_load_dwordx4 v[156:159], v3, s[12:15], s21 offen
  v_mfma_f32_16x16x32_bf16 v[68:71], v[196:199], v[176:179], v[68:71]
  v_mfma_f32_16x16x32_bf16 v[88:91], v[196:199], v[180:183], v[88:91]
  buffer_load_dwordx4 v[160:163], v4, s[12:15], s21 offen
  v_mfma_f32_16x16x32_bf16 v[32:35], v[200:203], v[168:171], v[32:35]
  v_mfma_f32_16x16x32_bf16 v[52:55], v[200:203], v[172:175], v[52:55]
  buffer_load_dwordx4 v[164:167], v5, s[12:15], s21 offen
  v_mfma_f32_16x16x32_bf16 v[72:75], v[200:203], v[176:179], v[72:75]
  v_mfma_f32_16x16x32_bf16 v[92:95], v[200:203], v[180:183], v[92:95]
  s_add_u32 s20, s20, 1024
  s_add_u32 s21, s21, 1024
  s_waitcnt vmcnt(18)
  v_mfma_f32_16x16x32_bf16 v[16:19], v[220:223], v[204:207], v[16:19]
  v_mfma_f32_16x16x32_bf16 v[36:39], v[220:223], v[208:211], v[36:39]
  buffer_load_dwordx4 v[168:171], v1, s[12:15], s20 offen
  v_mfma_f32_16x16x32_bf16 v[56:59], v[220:223], v[212:215], v[56:59]
  v_mfma_f32_16x16x32_bf16 v[76:79], v[220:223], v[216:219], v[76:79]
  buffer_load_dwordx4 v[172:175], v2, s[12:15], s20 offen
  v_mfma_f32_16x16x32_bf16 v[20:23], v[224:227], v[204:207], v[20:23]
  v_mfma_f32_16x16x32_bf16 v[40:43], v[224:227], v[208:211], v[40:43]
  buffer_load_dwordx4 v[176:179], v3, s[12:15], s20 offen
  v_mfma_f32_16x16x32_bf16 v[60:63], v[224:227], v[212:215], v[60:63]
  v_mfma_f32_16x16x32_bf16 v[80:83], v[224:227], v[216:219], v[80:83]
  buffer_load_dwordx4 v[180:183], v4, s[12:15], s20 offen
  v_mfma_f32_16x16x32_bf16 v[24:27], v[228:231], v[204:207], v[24:27]
  v_mfma_f32_16x16x32_bf16 v[44:47], v[228:231], v[208:211], v[44:47]
  buffer_load_dwordx4 v[184:187], v1, s[12:15], s21 offen
  v_mfma_f32_16x16x32_bf16 v[64:67], v[228:231], v[212:215], v[64:67]
  v_mfma_f32_16x16x32_bf16 v[84:87], v[228:231], v[216:219], v[84:87]
  buffer_load_dwordx4 v[188:191], v2, s[12:15], s21 offen
  v_mfma_f32_16x16x32_bf16 v[28:31], v[232:235], v[204:207], v[28:31]
  v_mfma_f32_16x16x32_bf16 v[48:51], v[232:235], v[208:211], v[48:51]
  buffer_load_dwordx4 v[192:195], v3, s[12:15], s21 offen
  v_mfma_f32_16x16x32_bf16 v[68:71], v[232:235], v[212:215], v[68:71]
  v_mfma_f32_16x16x32_bf16 v[88:91], v[232:235], v[216:219], v[88:91]
  buffer_load_dwordx4 v[196:199], v4, s[12:15], s21 offen
  v_mfma_f32_16x16x32_bf16 v[32:35], v[236:239], v[204:207], v[32:35]
  v_mfma_f32_16x16x32_bf16 v[52:55], v[236:239], v[208:211], v[52:55]
  buffer_load_dwordx4 v[200:203], v5, s[12:15], s21 offen
  v_mfma_f32_16x16x32_bf16 v[72:75], v[236:239], v[212:215], v[72:75]
  v_mfma_f32_16x16x32_bf16 v[92:95], v[236:239], v[216:219], v[92:95]
  s_add_u32 s20, s20, 1024
  s_add_u32 s21, s21, 1024
  s_sub_u32 s23, s23, 1
  s_cmp_lg_u32 s23, 0
  s_cbranch_scc1 B_LOOP
  s_waitcnt vmcnt(18)
  v_mfma_f32_16x16x32_bf16 v[16:19], v[112:115], v[96:99], v[16:19]
  v_mfma_f32_16x16x32_bf16 v[36:39], v[112:115], v[100:103], v[36:39]
  buffer_load_dwordx4 v[204:207], v1, s[12:15], s20 offen
  v_mfma_f32_16x16x32_bf16 v[56:59], v[112:115], v[104:107], v[56:59]
  v_mfma_f32_16x16x32_bf16 v[76:79], v[112:115], v[108:111], v[76:79]
  buffer_load_dwordx4 v[208:211], v2, s[12:15], s20 offen
  v_mfma_f32_16x16x32_bf16 v[20:23], v[116:119], v[96:99], v[20:23]
  v_mfma_f32_16x16x32_bf16 v[40:43], v[116:119], v[100:103], v[40:43]
  buffer_load_dwordx4 v[212:215], v3, s[12:15], s20 offen
  v_mfma_f32_16x16x32_bf16 v[60:63], v[116:119], v[104:107], v[60:63]
  v_mfma_f32_16x16x32_bf16 v[80:83], v[116:119], v[108:111], v[80:83]
  buffer_load_dwordx4 v[216:219], v4, s[12:15], s20 offen
  v_mfma_f32_16x16x32_bf16 v[24:27], v[120:123], v[96:99], v[24:27]
  v_mfma_f32_16x16x32_bf16 v[44:47], v[120:123], v[100:103], v[44:47]
  buffer_load_dwordx4 v[220:223], v1, s[12:15], s21 offen
  v_mfma_f32_16x16x32_bf16 v[64:67], v[120:123], v[104:107], v[64:67]
  v_mfma_f32_16x16x32_bf16 v[84:87], v[120:123], v[108:111], v[84:87]
  buffer_load_dwordx4 v[224:227], v2, s[12:15], s21 offen
  v_mfma_f32_16x16x32_bf16 v[28:31], v[124:127], v[96:99], v[28:31]
  v_mfma_f32_16x16x32_bf16 v[48:51], v[124:127], v[100:103], v[48:51]
  buffer_load_dwordx4 v[228:231], v3, s[12:15], s21 offen
  v_mfma_f32_16x16x32_bf16 v[68:71], v[124:127], v[104:107], v[68:71]
  v_mfma_f32_16x16x32_bf16 v[88:91], v[124:127], v[108:111], v[88:91]
  buffer_load_dwordx4 v[232:235], v4, s[12:15], s21 offen
  v_mfma_f32_16x16x32_bf16 v[32:35], v[128:131], v[96:99], v[32:35]
  v_mfma_f32_16x16x32_bf16 v[52:55], v[128:131], v[100:103], v[52:55]
  buffer_load_dwordx4 v[236:239], v5, s[12:15], s21 offen
  v_mfma_f32_16x16x32_bf16 v[72:75], v[128:131], v[104:107], v[72:75]
  v_mfma_f32_16x16x32_bf16 v[92:95], v[128:131], v[108:111], v[92:95]
  s_add_u32 s20, s20, 1024
  s_add_u32 s21, s21, 1024
  s_waitcnt vmcnt(18)
  v_mfma_f32_16x16x32_bf16 v[16:19], v[148:151], v[132:135], v[16:19]
  v_mfma_f32_16x16x32_bf16 v[36:39], v[148:151], v[136:139], v[36:39]
  v_mfma_f32_16x16x32_bf16 v[56:59], v[148:151], v[140:143], v[56:59]
  v_mfma_f32_16x16x32_bf16 v[76:79], v[148:151], v[144:147], v[76:79]
  v_mfma_f32_16x16x32_bf16 v[20:23], v[152:155], v[132:135], v[20:23]
  v_mfma_f32_16x16x32_bf16 v[40:43], v[152:155], v[136:139], v[40:43]
  v_mfma_f32_16x16x32_bf16 v[60:63], v[152:155], v[140:143], v[60:63]
  v_mfma_f32_16x16x32_bf16 v[80:83], v[152:155], v[144:147], v[80:83]
  v_mfma_f32_16x16x32_bf16 v[24:27], v[156:159], v[132:135], v[24:27]
  v_mfma_f32_16x16x32_bf16 v[44:47], v[156:159], v[136:139], v[44:47]
  v_mfma_f32_16x16x32_bf16 v[64:67], v[156:159], v[140:143], v[64:67]
  v_mfma_f32_16x16x32_bf16 v[84:87], v[156:159], v[144:147], v[84:87]
  v_mfma_f32_16x16x32_bf16 v[28:31], v[160:163], v[132:135], v[28:31]
  v_mfma_f32_16x16x32_bf16 v[48:51], v[160:163], v[136:139], v[48:51]
  v_mfma_f32_16x16x32_bf16 v[68:71], v[160:163], v[140:143], v[68:71]
  v_mfma_f32_16x16x32_bf16 v[88:91], v[160:163], v[144:147], v[88:91]
  v_mfma_f32_16x16x32_bf16 v[32:35], v[164:167], v[132:135], v[32:35]
  v_mfma_f32_16x16x32_bf16 v[52:55], v[164:167], v[136:139], v[52:55]
  v_mfma_f32_16x16x32_bf16 v[72:75], v[164:167], v[140:143], v[72:75]
  v_mfma_f32_16x16x32_bf16 v[92:95], v[164:167], v[144:147], v[92:95]
  s_waitcnt vmcnt(9)
  v_mfma_f32_16x16x32_bf16 v[16:19], v[184:187], v[168:171], v[16:19]
  v_mfma_f32_16x16x32_bf16 v[36:39], v[184:187], v[172:175], v[36:39]
  v_mfma_f32_16x16x32_bf16 v[56:59], v[184:187], v[176:179], v[56:59]
  v_mfma_f32_16x16x32_bf16 v[76:79], v[184:187], v[180:183], v[76:79]
  v_mfma_f32_16x16x32_bf16 v[20:23], v[188:191], v[168:171], v[20:23]
  v_mfma_f32_16x16x32_bf16 v[40:43], v[188:191], v[172:175], v[40:43]
  v_mfma_f32_16x16x32_bf16 v[60:63], v[188:191], v[176:179], v[60:63]
  v_mfma_f32_16x16x32_bf16 v[80:83], v[188:191], v[180:183], v[80:83]
  v_mfma_f32_16x16x32_bf16 v[24:27], v[192:195], v[168:171], v[24:27]
  v_mfma_f32_16x16x32_bf16 v[44:47], v[192:195], v[172:175], v[44:47]
  v_mfma_f32_16x16x32_bf16 v[64:67], v[192:195], v[176:179], v[64:67]
  v_mfma_f32_16x16x32_bf16 v[84:87], v[192:195], v[180:183], v[84:87]
  v_mfma_f32_16x16x32_bf16 v[28:31], v[196:199], v[168:171], v[28:31]
  v_mfma_f32_16x16x32_bf16 v[48:51], v[196:199], v[172:175], v[48:51]
  v_mfma_f32_16x16x32_bf16 v[68:71], v[196:199], v[176:179], v[68:71]
  v_mfma_f32_16x16x32_bf16 v[88:91], v[196:199], v[180:183], v[88:91]
  v_mfma_f32_16x16x32_bf16 v[32:35], v[200:203], v[168:171], v[32:35]
  v_mfma_f32_16x16x32_bf16 v[52:55], v[200:203], v[172:175], v[52:55]
  v_mfma_f32_16x16x32_bf16 v[72:75], v[200:203], v[176:179], v[72:75]
  v_mfma_f32_16x16x32_bf16 v[92:95], v[200:203], v[180:183], v[92:95]
  s_waitcnt vmcnt(0)
  v_mfma_f32_16x16x32_bf16 v[16:19], v[220:223], v[204:207], v[16:19]
  v_mfma_f32_16x16x32_bf16 v[36:39], v[220:223], v[208:211], v[36:39]
  v_mfma_f32_16x16x32_bf16 v[56:59], v[220:223], v[212:215], v[56:59]
  v_mfma_f32_16x16x32_bf16 v[76:79], v[220:223], v[216:219], v[76:79]
  v_mfma_f32_16x16x32_bf16 v[20:23], v[224:227], v[204:207], v[20:23]
  v_mfma_f32_16x16x32_bf16 v[40:43], v[224:227], v[208:211], v[40:43]
  v_mfma_f32_16x16x32_bf16 v[60:63], v[224:227], v[212:215], v[60:63]
  v_mfma_f32_16x16x32_bf16 v[80:83], v[224:227], v[216:219], v[80:83]
  v_mfma_f32_16x16x32_bf16 v[24:27], v[228:231], v[204:207], v[24:27]
  v_mfma_f32_16x16x32_bf16 v[44:47], v[228:231], v[208:211], v[44:47]
  v_mfma_f32_16x16x32_bf16 v[64:67], v[228:231], v[212:215], v[64:67]
  v_mfma_f32_16x16x32_bf16 v[84:87], v[228:231], v[216:219], v[84:87]
  v_mfma_f32_16x16x32_bf16 v[28:31], v[232:235], v[204:207], v[28:31]
  v_mfma_f32_16x16x32_bf16 v[48:51], v[232:235], v[208:211], v[48:51]
  v_mfma_f32_16x16x32_bf16 v[68:71], v[232:235], v[212:215], v[68:71]
  v_mfma_f32_16x16x32_bf16 v[88:91], v[232:235], v[216:219], v[88:91]
  v_mfma_f32_16x16x32_bf16 v[32:35], v[236:239], v[204:207], v[32:35]
  v_mfma_f32_16x16x32_bf16 v[52:55], v[236:239], v[208:211], v[52:55]
  v_mfma_f32_16x16x32_bf16 v[72:75], v[236:239], v[212:215], v[72:75]
  v_mfma_f32_16x16x32_bf16 v[92:95], v[236:239], v[216:219], v[92:95]
  s_nop 15
  s_mul_i32 s24, s3, 20480
  v_lshlrev_b32 v6, 4, v0
  v_add_u32 v7, s24, v6
  ds_write_b128 v7, v[16:19] offset:0
  ds_write_b128 v7, v[20:23] offset:1024
  ds_write_b128 v7, v[24:27] offset:2048
  ds_write_b128 v7, v[28:31] offset:3072
  ds_write_b128 v7, v[32:35] offset:4096
  ds_write_b128 v7, v[36:39] offset:5120
  ds_write_b128 v7, v[40:43] offset:6144
  ds_write_b128 v7, v[44:47] offset:7168
  ds_write_b128 v7, v[48:51] offset:8192
  ds_write_b128 v7, v[52:55] offset:9216
  ds_write_b128 v7, v[56:59] offset:10240
  ds_write_b128 v7, v[60:63] offset:11264
  ds_write_b128 v7, v[64:67] offset:12288
  ds_write_b128 v7, v[68:71] offset:13312
  ds_write_b128 v7, v[72:75] offset:14336
  ds_write_b128 v7, v[76:79] offset:15360
  ds_write_b128 v7, v[80:83] offset:16384
  ds_write_b128 v7, v[84:87] offset:17408
  ds_write_b128 v7, v[88:91] offset:18432
  ds_write_b128 v7, v[92:95] offset:19456
  s_waitcnt lgkmcnt(0)
  s_barrier
  s_mul_i32 s24, s3, 5120
  v_add_u32 v7, s24, v6
  v_add_u32 v8, 40960, v7
  ds_read_b128 v[96:99], v7 offset:0
  ds_read_b128 v[100:103], v7 offset:20480
  ds_read_b128 v[104:107], v8 offset:0
  ds_read_b128 v[108:111], v8 offset:20480
  ds_read_b128 v[112:115], v7 offset:1024
  ds_read_b128 v[116:119], v7 offset:21504
  ds_read_b128 v[120:123], v8 offset:1024
  ds_read_b128 v[124:127], v8 offset:21504
  ds_read_b128 v[128:131], v7 offset:2048
  ds_read_b128 v[132:135], v7 offset:22528
  ds_read_b128 v[136:139], v8 offset:2048
  ds_read_b128 v[140:143], v8 offset:22528
  ds_read_b128 v[144:147], v7 offset:3072
  ds_read_b128 v[148:151], v7 offset:23552
  ds_read_b128 v[152:155], v8 offset:3072
  ds_read_b128 v[156:159], v8 offset:23552
  ds_read_b128 v[160:163], v7 offset:4096
  ds_read_b128 v[164:167], v7 offset:24576
  ds_read_b128 v[168:171], v8 offset:4096
  ds_read_b128 v[172:175], v8 offset:24576
  s_lshl_b32 s24, s16, 6
  s_lshl_b32 s25, s3, 4
  s_add_u32 s24, s24, s25
  v_and_b32 v9, 15, v0
  v_add_u32 v9, s24, v9
  v_mul_u32_u24 v9, 1280, v9
  v_lshrrev_b32 v10, 4, v0
  v_lshl_add_u32 v9, v10, 3, v9
  s_mul_i32 s25, s17, 160
  s_waitcnt lgkmcnt(15)
  v_add_f32 v96, v96, v100
  v_add_f32 v104, v104, v108
  v_add_f32 v97, v97, v101
  v_add_f32 v105, v105, v109
  v_add_f32 v98, v98, v102
  v_add_f32 v106, v106, v110
  v_add_f32 v99, v99, v103
  v_add_f32 v107, v107, v111
  v_add_f32 v96, v96, v104
  v_add_f32 v97, v97, v105
  v_add_f32 v98, v98, v106
  v_add_f32 v99, v99, v107
  v_cvt_pk_bf16_f32 v100, v96, v97
  v_cvt_pk_bf16_f32 v101, v98, v99
  buffer_store_dwordx2 v[100:101], v9, s[8:11], s25 offen offset:0
  s_waitcnt lgkmcnt(12)
  v_add_f32 v112, v112, v116
  v_add_f32 v120, v120, v124
  v_add_f32 v113, v113, v117
  v_add_f32 v121, v121, v125
  v_add_f32 v114, v114, v118
  v_add_f32 v122, v122, v126
  v_add_f32 v115, v115, v119
  v_add_f32 v123, v123, v127
  v_add_f32 v112, v112, v120
  v_add_f32 v113, v113, v121
  v_add_f32 v114, v114, v122
  v_add_f32 v115, v115, v123
  v_cvt_pk_bf16_f32 v116, v112, v113
  v_cvt_pk_bf16_f32 v117, v114, v115
  buffer_store_dwordx2 v[116:117], v9, s[8:11], s25 offen offset:32
  s_waitcnt lgkmcnt(8)
  v_add_f32 v128, v128, v132
  v_add_f32 v136, v136, v140
  v_add_f32 v129, v129, v133
  v_add_f32 v137, v137, v141
  v_add_f32 v130, v130, v134
  v_add_f32 v138, v138, v142
  v_add_f32 v131, v131, v135
  v_add_f32 v139, v139, v143
  v_add_f32 v128, v128, v136
  v_add_f32 v129, v129, v137
  v_add_f32 v130, v130, v138
  v_add_f32 v131, v131, v139
  v_cvt_pk_bf16_f32 v132, v128, v129
  v_cvt_pk_bf16_f32 v133, v130, v131
  buffer_store_dwordx2 v[132:133], v9, s[8:11], s25 offen offset:64
  s_waitcnt lgkmcnt(4)
  v_add_f32 v144, v144, v148
  v_add_f32 v152, v152, v156
  v_add_f32 v145, v145, v149
  v_add_f32 v153, v153, v157
  v_add_f32 v146, v146, v150
  v_add_f32 v154, v154, v158
  v_add_f32 v147, v147, v151
  v_add_f32 v155, v155, v159
  v_add_f32 v144, v144, v152
  v_add_f32 v145, v145, v153
  v_add_f32 v146, v146, v154
  v_add_f32 v147, v147, v155
  v_cvt_pk_bf16_f32 v148, v144, v145
  v_cvt_pk_bf16_f32 v149, v146, v147
  buffer_store_dwordx2 v[148:149], v9, s[8:11], s25 offen offset:96
  s_waitcnt lgkmcnt(0)
  v_add_f32 v160, v160, v164
  v_add_f32 v168, v168, v172
  v_add_f32 v161, v161, v165
  v_add_f32 v169, v169, v173
  v_add_f32 v162, v162, v166
  v_add_f32 v170, v170, v174
  v_add_f32 v163, v163, v167
  v_add_f32 v171, v171, v175
  v_add_f32 v160, v160, v168
  v_add_f32 v161, v161, v169
  v_add_f32 v162, v162, v170
  v_add_f32 v163, v163, v171
  v_cvt_pk_bf16_f32 v164, v160, v161
  v_cvt_pk_bf16_f32 v165, v162, v163
  buffer_store_dwordx2 v[164:165], v9, s[8:11], s25 offen offset:128
B_END:
  s_endpgm
.section .rodata,"a"
.p2align 6
.amdhsa_kernel attn_kernel
  .amdhsa_next_free_vgpr 512
  .amdhsa_next_free_sgpr 102
  .amdhsa_accum_offset 256
  .amdhsa_group_segment_fixed_size 0
  .amdhsa_kernarg_size 64
  .amdhsa_user_sgpr_count 2
  .amdhsa_user_sgpr_kernarg_segment_ptr 1
  .amdhsa_system_sgpr_workgroup_id_x 1
.end_amdhsa_kernel
.p2align 6
.amdhsa_kernel oproj_kernel
  .amdhsa_next_free_vgpr 256
  .amdhsa_next_free_sgpr 48
  .amdhsa_accum_offset 256
  .amdhsa_group_segment_fixed_size 0
  .amdhsa_kernarg_size 64
  .amdhsa_user_sgpr_count 2
  .amdhsa_user_sgpr_kernarg_segment_ptr 1
  .amdhsa_system_sgpr_workgroup_id_x 1
.end_amdhsa_kernel
```
